```python
import torch

def _softmax(x, axis=-1):
    return torch.softmax(x, dim=axis)
def _gelu(x):
    return torch.nn.functional.gelu(x, approximate="tanh")
def _silu(x):
    return torch.nn.functional.silu(x)
def _sigmoid(x):
    return torch.sigmoid(x)
def _layernorm(x, axis=-1, eps=1e-5):
    m = x.mean(dim=axis, keepdim=True)
    v = x.var(dim=axis, keepdim=True, unbiased=False)
    return (x - m) / torch.sqrt(v + eps)
def _scatter_add(tgt, idx, src, axis=0):
    return tgt.clone().index_add_(axis, idx, src)
def _segment_sum(src, seg, n):
    out = torch.zeros((n,) + src.shape[1:], dtype=src.dtype)
    return out.index_add_(0, seg, src)
def _pad(x, pw):
    flat = tuple(v for pair in reversed(pw) for v in pair)
    return torch.nn.functional.pad(x, flat)

kernel_name = 'sequential_preLN__mha_block__dense_activation_squared_relu__prompt'

def setup_inputs():

    _w = (lambda a: (lambda t: t.to(torch.bfloat16) if t.is_floating_point() else t)(torch.as_tensor(a)))
    def _A_setup():
        B, S, D, H = 1, 2048, 640, 32
        return {
            "x": _w((lambda *s: torch.randn(*s, dtype=torch.bfloat16) * 0.05)(B, S, D)),
            "wqkv": _w((lambda *s: torch.randn(*s, dtype=torch.bfloat16) * 0.05)(D, 3 * D)),
            "wo": _w((lambda *s: torch.randn(*s, dtype=torch.bfloat16) * 0.05)(D, D)),
        }
    _A_in = _A_setup()

    def _B_setup():
        B, S, D, F = 1, 2048, 640, 1728
        return {
            "x": _w((lambda *s: torch.randn(*s, dtype=torch.bfloat16) * 0.05)(B, S, D)),
            "w1": _w((lambda *s: torch.randn(*s, dtype=torch.bfloat16) * 0.05)(D, F)),
            "b1": _w((lambda *s: torch.randn(*s, dtype=torch.bfloat16) * 0.4)(F)),
            "w2": _w((lambda *s: torch.randn(*s, dtype=torch.bfloat16) * 0.05)(F, D)),
            "b2": _w((lambda *s: torch.randn(*s, dtype=torch.bfloat16) * 3.2)(D)),
        }
    _B_in = _B_setup()

    return {
        "A_x": _A_in["x"],
        "A_wqkv": _A_in["wqkv"],
        "A_wo": _A_in["wo"],
        "B_x": _B_in["x"],
        "B_w1": _B_in["w1"],
        "B_b1": _B_in["b1"],
        "B_w2": _B_in["w2"],
        "B_b2": _B_in["b2"],
    }

def reference(A_x, A_wqkv, A_wo, B_x, B_w1, B_b1, B_w2, B_b2):
    def _A_ref(x, wqkv, wo):
        B, S, D = x.shape
        H = 32
        Dh = D // H
        qkv = (lambda x, *d: x.permute(*d))((x @ wqkv).reshape(B, S, 3, H, Dh), 2, 0, 3, 1, 4)
        q, k, v = qkv[0], qkv[1], qkv[2]
        scores = torch.einsum("bhqd,bhkd->bhqk", q, k) * (Dh ** -0.5)
        p = _softmax(scores, axis=-1)
        o = torch.einsum("bhqk,bhkd->bhqd", p, v)
        return (lambda x, *d: x.permute(*d))(o, 0, 2, 1, 3).reshape(B, S, D) @ wo

    def _B_ref(x, w1, b1, w2, b2):
        h = torch.einsum("bsd,df->bsf", x, w1) + b1
        zero = torch.zeros_like(h)
        r = torch.where(h > zero, h, zero)
        h = r * r
        out = torch.einsum("bsf,fd->bsd", h, w2) + b2
        return out

    x = A_x
    h = x + _A_ref(_layernorm(x, axis=-1), A_wqkv, A_wo)
    h2 = h + _B_ref(_layernorm(h, axis=-1), B_w1, B_b1, B_w2, B_b2)
    return h2
```

```asm
; @launch grid=(256,1,1) block=(512,1,1) lds=163840
.amdgcn_target "amdgcn-amd-amdhsa--gfx950"
.text
.globl sequential_preLN__mha_block__dense_activation_squared_relu__prompt_kernel
.p2align 8
.type sequential_preLN__mha_block__dense_activation_squared_relu__prompt_kernel,@function
sequential_preLN__mha_block__dense_activation_squared_relu__prompt_kernel:
    s_cmp_ge_u32 s2, 256
    s_cbranch_scc1 L_end
    s_load_dwordx16 s[4:19], s[0:1], 0
    s_load_dwordx4 s[20:23], s[0:1], 64
    s_load_dwordx2 s[24:25], s[0:1], 80
    s_getpc_b64 s[44:45]
L_pc_here:
    s_sub_u32 s44, s44, L_pc_here-sequential_preLN__mha_block__dense_activation_squared_relu__prompt_kernel
    s_subb_u32 s45, s45, 0
    s_mov_b32 s46, L_end-sequential_preLN__mha_block__dense_activation_squared_relu__prompt_kernel
    s_mov_b32 s47, 0x20000
    v_lshlrev_b32 v254, 7, v0
    buffer_load_dword v255, v254, s[44:47], 0 offen
    v_lshrrev_b32 v2, 6, v0
    v_and_b32 v1, 63, v0
    v_readfirstlane_b32 s3, v2
    s_and_b32 s27, s2, 7
    s_lshr_b32 s48, s2, 3
    v_mov_b32 v154, 0
    v_mov_b32 v157, 0
    v_mov_b32 v172, 0
    v_mov_b32 v173, 0
    s_lshr_b32 s63, s3, 2
    s_and_b32 s64, s3, 3
    s_and_b32 s56, s27, 3
    s_lshl_b32 s56, s56, 2
    s_and_b32 s57, s48, 3
    s_add_u32 s49, s56, s57
    s_lshr_b32 s56, s27, 2
    s_lshl_b32 s56, s56, 3
    s_lshr_b32 s58, s48, 2
    s_add_u32 s50, s56, s58
    s_lshl_b32 s57, s57, 1
    s_add_u32 s68, s57, s58
    s_and_b32 s68, s68, 7
    s_mov_b32 s51, 0
    s_cmp_lt_u32 s3, 4
    s_cbranch_scc1 L_p1_compute
    s_sub_u32 s60, s3, 4
    v_lshrrev_b32 v148, 4, v1
    s_lshl_b32 s56, s60, 2
    v_add_u32 v149, s56, v148
    v_and_b32 v149, 7, v149
    v_and_b32 v150, 7, v1
    v_xor_b32 v149, v149, v150
    v_lshlrev_b32 v149, 4, v149
    v_lshrrev_b32 v150, 3, v1
    v_mul_u32_u24 v150, 1280, v150
    v_add_u32 v2, v149, v150
    v_lshlrev_b32 v149, 2, v148
    v_and_b32 v150, 15, v1
    v_xor_b32 v149, v149, v150
    v_lshlrev_b32 v149, 4, v149
    v_mul_u32_u24 v150, 3840, v148
    v_add_u32 v3, v149, v150
    s_lshl_b32 s56, s49, 7
    s_lshl_b32 s57, s60, 3
    s_add_u32 s56, s56, s57
    s_mul_i32 s54, s56, 1280
    s_mul_i32 s56, s60, 15360
    s_lshl_b32 s57, s50, 8
    s_add_u32 s55, s56, s57
    s_lshl_b32 s62, s60, 10
    s_mov_b32 s53, 0
    s_mov_b32 s30, 2621440
    s_mov_b32 s31, 0x20000
    s_mov_b32 s34, 2457600
    s_mov_b32 s35, 0x20000
    s_add_u32 s68, s68, 2
    s_mov_b32 s52, 0
    s_cmp_ge_u32 s50, 15
    s_cbranch_scc1 L_p1_lnull0
    s_waitcnt lgkmcnt(0)
    s_mov_b32 s28, s4
    s_mov_b32 s29, s5
    s_mov_b32 s32, s6
    s_mov_b32 s33, s7
L_p1_pro:
    s_lshl_b32 s58, s51, 7
    s_add_u32 s58, s58, s54
    s_add_u32 m0, s53, s62
    s_mul_i32 s59, s51, 245760
    buffer_load_dwordx4 v2, s[28:31], s58 offen  lds
    s_add_u32 m0, m0, 4096
    s_add_u32 s58, s58, 40960
    buffer_load_dwordx4 v2, s[28:31], s58 offen  lds
    s_add_u32 m0, m0, 4096
    s_add_u32 s58, s58, 40960
    buffer_load_dwordx4 v2, s[28:31], s58 offen  lds
    s_add_u32 m0, m0, 4096
    s_add_u32 s58, s58, 40960
    buffer_load_dwordx4 v2, s[28:31], s58 offen  lds
    s_add_u32 s58, s59, s55
    s_add_u32 m0, m0, 4096
    s_nop 0
    buffer_load_dwordx4 v3, s[32:35], s58 offen lds
    s_add_u32 m0, m0, 4096
    s_add_u32 s58, s58, 61440
    buffer_load_dwordx4 v3, s[32:35], s58 offen lds
    s_add_u32 m0, m0, 4096
    s_add_u32 s58, s58, 61440
    buffer_load_dwordx4 v3, s[32:35], s58 offen lds
    s_add_u32 m0, m0, 4096
    s_add_u32 s58, s58, 61440
    buffer_load_dwordx4 v3, s[32:35], s58 offen lds
    s_add_u32 s51, s51, 1
    s_cmp_eq_u32 s51, 10
    s_cselect_b32 s51, 2, s51
    s_add_u32 s53, s53, 32768
    s_cmp_eq_u32 s53, 131072
    s_cselect_b32 s53, 0, s53
    s_add_u32 s52, s52, 1
    s_cmp_eq_u32 s52, 2
    s_cselect_b32 s51, s68, s51
    s_cmp_lt_u32 s52, 3
    s_cbranch_scc1 L_p1_pro
    s_load_dword s26, s[24:25], 0
    s_mov_b32 s40, s24
    s_mov_b32 s41, s25
    s_mov_b32 s42, 0x100000
    s_mov_b32 s43, 0x20000
    s_waitcnt vmcnt(16)
    s_barrier
    s_waitcnt lgkmcnt(0)
    s_getreg_b32 s10, hwreg(HW_REG_XCC_ID, 0, 4)
    s_mov_b32 s11, 0
    s_mul_i32 s26, s26, 0x9E3779B1
    s_add_u32 s26, s26, 0x7F4A7C15
    s_mov_b32 s52, 0
L_p1_lloop:
    s_add_u32 s52, s52, 1
    s_waitcnt vmcnt(8)
    s_barrier
    s_lshl_b32 s58, s51, 7
    s_add_u32 s58, s58, s54
    s_add_u32 m0, s53, s62
    s_mul_i32 s59, s51, 245760
    buffer_load_dwordx4 v2, s[28:31], s58 offen  lds
    s_add_u32 m0, m0, 4096
    s_add_u32 s58, s58, 40960
    buffer_load_dwordx4 v2, s[28:31], s58 offen  lds
    s_add_u32 m0, m0, 4096
    s_add_u32 s58, s58, 40960
    buffer_load_dwordx4 v2, s[28:31], s58 offen  lds
    s_add_u32 m0, m0, 4096
    s_add_u32 s58, s58, 40960
    buffer_load_dwordx4 v2, s[28:31], s58 offen  lds
    s_add_u32 s58, s59, s55
    s_add_u32 m0, m0, 4096
    s_nop 0
    buffer_load_dwordx4 v3, s[32:35], s58 offen lds
    s_add_u32 m0, m0, 4096
    s_add_u32 s58, s58, 61440
    buffer_load_dwordx4 v3, s[32:35], s58 offen lds
    s_add_u32 m0, m0, 4096
    s_add_u32 s58, s58, 61440
    buffer_load_dwordx4 v3, s[32:35], s58 offen lds
    s_add_u32 m0, m0, 4096
    s_add_u32 s58, s58, 61440
    buffer_load_dwordx4 v3, s[32:35], s58 offen lds
    s_add_u32 s51, s51, 1
    s_cmp_eq_u32 s51, 10
    s_cselect_b32 s51, 2, s51
    s_add_u32 s53, s53, 32768
    s_cmp_eq_u32 s53, 131072
    s_cselect_b32 s53, 0, s53
    s_cmp_lt_u32 s52, 7
    s_cbranch_scc1 L_p1_lloop
    s_sub_u32 s60, s3, 4
    s_lshl_b32 s56, s60, 5
    v_and_b32 v148, 31, v1
    v_add_u32 v148, s56, v148
    s_lshl_b32 s57, s49, 7
    v_add_u32 v149, s57, v148
    v_lshlrev_b32 v149, 4, v149
    v_add_u32 v149, 0x68000, v149
    buffer_load_dwordx4 v[152:155], v149, s[40:43], 0 offen sc1
    s_waitcnt vmcnt(9)
    s_barrier
    s_lshl_b32 s56, s2, 2
    s_and_b32 s61, s3, 3
    s_add_u32 s56, s56, s61
    s_cmp_lt_u32 s56, 540
    s_cselect_b32 s57, 0, 540
    s_cselect_b32 s44, s16, s8
    s_cselect_b32 s45, s17, s9
    s_mov_b32 s46, 819200
    s_cselect_b32 s46, 2211840, s46
    s_mov_b32 s47, 0x20000
    s_sub_u32 s57, s56, s57
    s_mul_hi_u32 s58, s57, 0x1999999a
    s_mul_i32 s59, s58, 10
    s_sub_u32 s59, s57, s59
    s_mul_i32 s58, s58, 40960
    s_lshl_b32 s59, s59, 7
    s_add_u32 s58, s58, s59
    s_cmp_ge_u32 s56, 740
    s_cselect_b32 s58, 0x70000000, s58
    v_lshrrev_b32 v172, 3, v1
    v_mul_u32_u24 v172, 1280, v172
    v_and_b32 v173, 7, v1
    v_lshl_add_u32 v172, v173, 4, v172
    s_lshl_b32 s59, s61, 12
    s_add_u32 m0, s59, 143360
    s_nop 0
    buffer_load_dwordx4 v172, s[44:47], s58 offen lds
    s_add_u32 m0, m0, 1024
    s_add_u32 s58, s58, 10240
    s_nop 0
    buffer_load_dwordx4 v172, s[44:47], s58 offen lds
    s_add_u32 m0, m0, 1024
    s_add_u32 s58, s58, 10240
    s_nop 0
    buffer_load_dwordx4 v172, s[44:47], s58 offen lds
    s_add_u32 m0, m0, 1024
    s_add_u32 s58, s58, 10240
    s_nop 0
    buffer_load_dwordx4 v172, s[44:47], s58 offen lds
    s_waitcnt vmcnt(5)
    s_barrier
    s_barrier
    s_waitcnt vmcnt(4)
    s_mov_b32 s56, 0
L_p1_gpoll:
    v_cmp_ne_u32 vcc, s26, v154
    v_cmp_ne_u32 s[90:91], s26, v155
    s_nop 1
    s_or_b64 vcc, vcc, s[90:91]
    s_cbranch_vccz L_p1_gok
    s_add_u32 s56, s56, 1
    s_cmp_ge_u32 s56, 0x40000
    s_cbranch_scc1 L_p1_gok
    buffer_load_dwordx4 v[152:155], v149, s[40:43], 0 offen sc1
    s_waitcnt vmcnt(0)
    s_branch L_p1_gpoll
L_p1_gok:
    v_lshlrev_b32 v148, 2, v148
    v_add_u32 v148, 131072, v148
    ds_write_b32 v148, v152 offset:9216
    ds_write_b32 v148, v153 offset:9728
    s_waitcnt lgkmcnt(0)
    s_barrier
    s_branch L_p1_lj
L_p1_lnull0:
    s_waitcnt lgkmcnt(0)
    s_load_dword s26, s[24:25], 0
L_p1_lnull:
    s_mov_b32 s40, s24
    s_mov_b32 s41, s25
    s_mov_b32 s42, 0x100000
    s_mov_b32 s43, 0x20000
    s_waitcnt lgkmcnt(0)
    s_getreg_b32 s10, hwreg(HW_REG_XCC_ID, 0, 4)
    s_mov_b32 s11, 0
    s_mul_i32 s26, s26, 0x9E3779B1
    s_add_u32 s26, s26, 0x7F4A7C15
    s_lshl_b32 s56, s2, 2
    s_and_b32 s61, s3, 3
    s_add_u32 s56, s56, s61
    s_cmp_lt_u32 s56, 540
    s_cselect_b32 s57, 0, 540
    s_cselect_b32 s44, s16, s8
    s_cselect_b32 s45, s17, s9
    s_mov_b32 s46, 819200
    s_cselect_b32 s46, 2211840, s46
    s_mov_b32 s47, 0x20000
    s_sub_u32 s57, s56, s57
    s_mul_hi_u32 s58, s57, 0x1999999a
    s_mul_i32 s59, s58, 10
    s_sub_u32 s59, s57, s59
    s_mul_i32 s58, s58, 40960
    s_lshl_b32 s59, s59, 7
    s_add_u32 s58, s58, s59
    s_cmp_ge_u32 s56, 740
    s_cselect_b32 s58, 0x70000000, s58
    v_lshrrev_b32 v148, 3, v1
    v_mul_u32_u24 v148, 1280, v148
    v_and_b32 v149, 7, v1
    v_lshl_add_u32 v148, v149, 4, v148
    s_lshl_b32 s59, s61, 12
    s_add_u32 m0, s59, 143360
    s_nop 0
    buffer_load_dwordx4 v148, s[44:47], s58 offen lds
    s_add_u32 m0, m0, 1024
    s_add_u32 s58, s58, 10240
    s_nop 0
    buffer_load_dwordx4 v148, s[44:47], s58 offen lds
    s_add_u32 m0, m0, 1024
    s_add_u32 s58, s58, 10240
    s_nop 0
    buffer_load_dwordx4 v148, s[44:47], s58 offen lds
    s_add_u32 m0, m0, 1024
    s_add_u32 s58, s58, 10240
    s_nop 0
    buffer_load_dwordx4 v148, s[44:47], s58 offen lds
L_p1_lj:
    s_waitcnt vmcnt(0)
    s_lshl_b32 s56, s2, 2
    s_and_b32 s61, s3, 3
    s_add_u32 s56, s56, s61
    s_cmp_ge_u32 s56, 740
    s_cbranch_scc1 L_rl_skip2
    s_cmp_lt_u32 s56, 540
    s_cselect_b32 s57, 0, 540
    s_mov_b32 s60, 0x1700000
    s_cselect_b32 s60, 0x1800000, s60
    s_mov_b32 s59, 0xc8000
    s_cselect_b32 s59, 0x21c000, s59
    s_mov_b32 s46, s59
    s_sub_u32 s57, s56, s57
    s_add_u32 s44, s24, s60
    s_addc_u32 s45, s25, 0
    s_mov_b32 s47, 0x20000
    s_mul_hi_u32 s58, s57, 0x1999999a
    s_mul_i32 s59, s58, 10
    s_sub_u32 s59, s57, s59
    s_mul_i32 s58, s58, 40
    s_lshl_b32 s59, s59, 2
    s_add_u32 s58, s58, s59
    s_lshl_b32 s58, s58, 10
    v_lshrrev_b32 v148, 4, v1
    v_lshlrev_b32 v148, 3, v148
    v_bfe_u32 v149, v1, 2, 2
    v_add_u32 v148, v148, v149
    v_lshlrev_b32 v148, 7, v148
    v_and_b32 v149, 3, v1
    v_lshl_add_u32 v148, v149, 3, v148
    s_lshl_b32 s59, s61, 12
    s_add_u32 s59, s59, 143360
    v_add_u32 v148, s59, v148
    v_lshlrev_b32 v149, 4, v1
    ds_read_b64_tr_b16 v[152:153], v148 offset:0
    ds_read_b64_tr_b16 v[154:155], v148 offset:512
    ds_read_b64_tr_b16 v[156:157], v148 offset:32
    ds_read_b64_tr_b16 v[158:159], v148 offset:544
    ds_read_b64_tr_b16 v[160:161], v148 offset:64
    ds_read_b64_tr_b16 v[162:163], v148 offset:576
    ds_read_b64_tr_b16 v[164:165], v148 offset:96
    ds_read_b64_tr_b16 v[166:167], v148 offset:608
    s_waitcnt lgkmcnt(0)
    buffer_store_dwordx4 v[152:155], v149, s[44:47], s58 offen offset:0 sc1
    buffer_store_dwordx4 v[156:159], v149, s[44:47], s58 offen offset:1024 sc1
    buffer_store_dwordx4 v[160:163], v149, s[44:47], s58 offen offset:2048 sc1
    buffer_store_dwordx4 v[164:167], v149, s[44:47], s58 offen offset:3072 sc1
L_rl_skip2:
    s_cmp_ge_u32 s50, 15
    s_cbranch_scc1 L_p1_nulljob
    s_branch L_p1_done
L_p1_compute:
    s_waitcnt lgkmcnt(0)
    s_load_dword s26, s[24:25], 0
    s_mov_b32 s40, s24
    s_mov_b32 s41, s25
    s_mov_b32 s42, 0x100000
    s_mov_b32 s43, 0x20000
    s_mov_b32 s36, s4
    s_mov_b32 s37, s5
    s_mov_b32 s38, 0x280000
    s_mov_b32 s39, 0x20000
    s_lshl_b32 s56, s2, 3
    s_lshl_b32 s57, s3, 1
    s_add_u32 s56, s56, s57
    v_lshrrev_b32 v148, 5, v1
    v_add_u32 v148, s56, v148
    v_mul_u32_u24 v149, 1280, v148
    v_and_b32 v150, 31, v1
    v_lshl_add_u32 v149, v150, 3, v149
    buffer_load_dwordx2 v[152:153], v149, s[36:39], 0 offen offset:0
    buffer_load_dwordx2 v[154:155], v149, s[36:39], 0 offen offset:256
    buffer_load_dwordx2 v[156:157], v149, s[36:39], 0 offen offset:512
    buffer_load_dwordx2 v[158:159], v149, s[36:39], 0 offen offset:768
    buffer_load_dwordx2 v[160:161], v149, s[36:39], 0 offen offset:1024
    s_lshl_b32 s56, s2, 2
    s_and_b32 s61, s3, 3
    s_add_u32 s56, s56, s61
    s_cmp_lt_u32 s56, 540
    s_cselect_b32 s57, 0, 540
    s_cselect_b32 s44, s16, s8
    s_cselect_b32 s45, s17, s9
    s_mov_b32 s46, 819200
    s_cselect_b32 s46, 2211840, s46
    s_mov_b32 s47, 0x20000
    s_sub_u32 s57, s56, s57
    s_mul_hi_u32 s58, s57, 0x1999999a
    s_mul_i32 s59, s58, 10
    s_sub_u32 s59, s57, s59
    s_mul_i32 s58, s58, 40960
    s_lshl_b32 s59, s59, 7
    s_add_u32 s58, s58, s59
    s_cmp_ge_u32 s56, 740
    s_cselect_b32 s58, 0x70000000, s58
    s_mov_b32 s62, s58
    s_mov_b32 s53, 0x70000000
    v_mul_u32_u24 v252, 1280, v1
    v_cmp_gt_u32 vcc, 32, v1
    v_mov_b32 v251, 0x7f000000
    s_nop 0
    v_cndmask_b32 v252, v251, v252, vcc
    v_mov_b32 v164, 0
    v_mov_b32 v165, 0
    s_waitcnt vmcnt(0)
    v_lshlrev_b32 v166, 16, v152
    v_and_b32 v167, 0xffff0000, v152
    v_add_f32 v164, v164, v166
    v_fmac_f32 v165, v166, v166
    v_add_f32 v164, v164, v167
    v_fmac_f32 v165, v167, v167
    v_lshlrev_b32 v166, 16, v153
    v_and_b32 v167, 0xffff0000, v153
    v_add_f32 v164, v164, v166
    v_fmac_f32 v165, v166, v166
    v_add_f32 v164, v164, v167
    v_fmac_f32 v165, v167, v167
    v_lshlrev_b32 v166, 16, v154
    v_and_b32 v167, 0xffff0000, v154
    v_add_f32 v164, v164, v166
    v_fmac_f32 v165, v166, v166
    v_add_f32 v164, v164, v167
    v_fmac_f32 v165, v167, v167
    v_lshlrev_b32 v166, 16, v155
    v_and_b32 v167, 0xffff0000, v155
    v_add_f32 v164, v164, v166
    v_fmac_f32 v165, v166, v166
    v_add_f32 v164, v164, v167
    v_fmac_f32 v165, v167, v167
    v_lshlrev_b32 v166, 16, v156
    v_and_b32 v167, 0xffff0000, v156
    v_add_f32 v164, v164, v166
    v_fmac_f32 v165, v166, v166
    v_add_f32 v164, v164, v167
    v_fmac_f32 v165, v167, v167
    v_lshlrev_b32 v166, 16, v157
    v_and_b32 v167, 0xffff0000, v157
    v_add_f32 v164, v164, v166
    v_fmac_f32 v165, v166, v166
    v_add_f32 v164, v164, v167
    v_fmac_f32 v165, v167, v167
    v_lshlrev_b32 v166, 16, v158
    v_and_b32 v167, 0xffff0000, v158
    v_add_f32 v164, v164, v166
    v_fmac_f32 v165, v166, v166
    v_add_f32 v164, v164, v167
    v_fmac_f32 v165, v167, v167
    v_lshlrev_b32 v166, 16, v159
    v_and_b32 v167, 0xffff0000, v159
    v_add_f32 v164, v164, v166
    v_fmac_f32 v165, v166, v166
    v_add_f32 v164, v164, v167
    v_fmac_f32 v165, v167, v167
    v_lshlrev_b32 v166, 16, v160
    v_and_b32 v167, 0xffff0000, v160
    v_add_f32 v164, v164, v166
    v_fmac_f32 v165, v166, v166
    v_add_f32 v164, v164, v167
    v_fmac_f32 v165, v167, v167
    v_lshlrev_b32 v166, 16, v161
    v_and_b32 v167, 0xffff0000, v161
    v_add_f32 v164, v164, v166
    v_fmac_f32 v165, v166, v166
    v_add_f32 v164, v164, v167
    v_fmac_f32 v165, v167, v167
    s_nop 1
    v_add_f32_dpp v164, v164, v164 row_shr:1 row_mask:0xf bank_mask:0xf bound_ctrl:0
    v_add_f32_dpp v165, v165, v165 row_shr:1 row_mask:0xf bank_mask:0xf bound_ctrl:0
    s_nop 1
    v_add_f32_dpp v164, v164, v164 row_shr:2 row_mask:0xf bank_mask:0xf bound_ctrl:0
    v_add_f32_dpp v165, v165, v165 row_shr:2 row_mask:0xf bank_mask:0xf bound_ctrl:0
    s_nop 1
    v_add_f32_dpp v164, v164, v164 row_shr:4 row_mask:0xf bank_mask:0xf bound_ctrl:0
    v_add_f32_dpp v165, v165, v165 row_shr:4 row_mask:0xf bank_mask:0xf bound_ctrl:0
    s_nop 1
    v_add_f32_dpp v164, v164, v164 row_shr:8 row_mask:0xf bank_mask:0xf bound_ctrl:0
    v_add_f32_dpp v165, v165, v165 row_shr:8 row_mask:0xf bank_mask:0xf bound_ctrl:0
    s_nop 1
    v_add_f32_dpp v164, v164, v164 row_bcast:15 row_mask:0xa bank_mask:0xf
    v_add_f32_dpp v165, v165, v165 row_bcast:15 row_mask:0xa bank_mask:0xf
    s_nop 1
    v_mul_f32 v169, 0x3acccccd, v164
    v_mul_f32 v170, 0x3acccccd, v165
    v_fma_f32 v170, -v169, v169, v170
    v_max_f32 v170, 0, v170
    v_add_f32 v170, 0x3727c5ac, v170
    v_rsq_f32 v170, v170
    s_nop 0
    v_mul_f32 v169, v169, v170
    v_sub_f32 v169, 0, v169
    v_mov_b32 v172, v170
    v_mov_b32 v173, v169
    s_waitcnt lgkmcnt(0)
    s_getreg_b32 s10, hwreg(HW_REG_XCC_ID, 0, 4)
    s_mov_b32 s11, 0
    s_mul_i32 s26, s26, 0x9E3779B1
    s_add_u32 s26, s26, 0x7F4A7C15
    v_mov_b32 v174, s26
    v_mov_b32 v175, s26
    v_lshlrev_b32 v148, 4, v148
    v_add_u32 v148, 0x68000, v148
    s_mov_b32 exec_lo, 0x80000000
    s_mov_b32 exec_hi, 0x80000000
    buffer_store_dwordx4 v[172:175], v148, s[40:43], 0 offen sc1
    s_mov_b64 exec, -1
    s_cmp_ge_u32 s50, 15
    s_cbranch_scc1 L_p1_nulljob
    s_cmp_ge_u32 s50, 10
    s_cbranch_scc1 L_p1_N
    s_lshr_b32 s63, s3, 1
    s_and_b32 s64, s3, 1
    v_and_b32 v172, 31, v1
    v_lshrrev_b32 v178, 5, v1
    s_lshl_b32 s56, s63, 6
    v_add_u32 v173, s56, v172
    v_lshlrev_b32 v173, 2, v173
    v_add_u32 v168, 131072, v173
    s_lshl_b32 s56, s64, 8
    s_lshl_b32 s57, s63, 7
    s_add_u32 s56, s56, s57
    s_add_u32 s56, s56, 141312
    v_lshlrev_b32 v179, 4, v178
    v_add_u32 v169, s56, v179
    v_xor_b32 v170, 128, v169
    s_cmp_lt_u32 s50, 5
    s_cselect_b32 s6, 0x3ea52b5c, 1.0
    s_mov_b32 s57, 163840
    s_cselect_b32 s57, 81920, s57
    s_mov_b32 s58, 2560
    s_cselect_b32 s58, 1280, s58
    s_cselect_b32 s59, 0, 5
    s_mov_b32 s60, 0x400000
    s_cselect_b32 s60, 0x100000, s60
    s_mov_b32 s61, 0x500000
    s_cselect_b32 s61, 0x280000, s61
    s_add_u32 s36, s24, s60
    s_addc_u32 s37, s25, 0
    s_mov_b32 s38, s61
    s_mov_b32 s39, 0x20000
    s_sub_u32 s59, s50, s59
    s_lshl_b32 s59, s59, 5
    s_lshl_b32 s60, s64, 4
    s_add_u32 s59, s59, s60
    s_lshl_b32 s60, s63, 3
    s_add_u32 s61, s59, s60
    s_add_u32 s61, s61, 0
    v_add_u32 v180, s61, v178
    v_mul_u32_u24 v181, 52429, v180
    v_lshrrev_b32 v181, 18, v181
    v_mul_u32_u24 v182, 5, v181
    v_sub_u32 v182, v180, v182
    v_mul_lo_u32 v181, v181, s57
    v_lshlrev_b32 v182, 8, v182
    v_add_u32 v181, v181, v182
    v_lshl_add_u32 v160, v172, 3, v181
    s_add_u32 s61, s59, s60
    s_add_u32 s61, s61, 2
    v_add_u32 v180, s61, v178
    v_mul_u32_u24 v181, 52429, v180
    v_lshrrev_b32 v181, 18, v181
    v_mul_u32_u24 v182, 5, v181
    v_sub_u32 v182, v180, v182
    v_mul_lo_u32 v181, v181, s57
    v_lshlrev_b32 v182, 8, v182
    v_add_u32 v181, v181, v182
    v_lshl_add_u32 v161, v172, 3, v181
    s_add_u32 s61, s59, s60
    s_add_u32 s61, s61, 4
    v_add_u32 v180, s61, v178
    v_mul_u32_u24 v181, 52429, v180
    v_lshrrev_b32 v181, 18, v181
    v_mul_u32_u24 v182, 5, v181
    v_sub_u32 v182, v180, v182
    v_mul_lo_u32 v181, v181, s57
    v_lshlrev_b32 v182, 8, v182
    v_add_u32 v181, v181, v182
    v_lshl_add_u32 v162, v172, 3, v181
    s_add_u32 s61, s59, s60
    s_add_u32 s61, s61, 6
    v_add_u32 v180, s61, v178
    v_mul_u32_u24 v181, 52429, v180
    v_lshrrev_b32 v181, 18, v181
    v_mul_u32_u24 v182, 5, v181
    v_sub_u32 v182, v180, v182
    v_mul_lo_u32 v181, v181, s57
    v_lshlrev_b32 v182, 8, v182
    v_add_u32 v181, v181, v182
    v_lshl_add_u32 v163, v172, 3, v181
    s_xor_b32 s61, s60, 8
    s_add_u32 s61, s61, s59
    s_add_u32 s61, s61, 0
    v_add_u32 v180, s61, v178
    v_mul_u32_u24 v181, 52429, v180
    v_lshrrev_b32 v181, 18, v181
    v_mul_u32_u24 v182, 5, v181
    v_sub_u32 v182, v180, v182
    v_mul_lo_u32 v181, v181, s57
    v_lshlrev_b32 v182, 8, v182
    v_add_u32 v181, v181, v182
    v_lshl_add_u32 v164, v172, 3, v181
    s_xor_b32 s61, s60, 8
    s_add_u32 s61, s61, s59
    s_add_u32 s61, s61, 2
    v_add_u32 v180, s61, v178
    v_mul_u32_u24 v181, 52429, v180
    v_lshrrev_b32 v181, 18, v181
    v_mul_u32_u24 v182, 5, v181
    v_sub_u32 v182, v180, v182
    v_mul_lo_u32 v181, v181, s57
    v_lshlrev_b32 v182, 8, v182
    v_add_u32 v181, v181, v182
    v_lshl_add_u32 v165, v172, 3, v181
    s_xor_b32 s61, s60, 8
    s_add_u32 s61, s61, s59
    s_add_u32 s61, s61, 4
    v_add_u32 v180, s61, v178
    v_mul_u32_u24 v181, 52429, v180
    v_lshrrev_b32 v181, 18, v181
    v_mul_u32_u24 v182, 5, v181
    v_sub_u32 v182, v180, v182
    v_mul_lo_u32 v181, v181, s57
    v_lshlrev_b32 v182, 8, v182
    v_add_u32 v181, v181, v182
    v_lshl_add_u32 v166, v172, 3, v181
    s_xor_b32 s61, s60, 8
    s_add_u32 s61, s61, s59
    s_add_u32 s61, s61, 6
    v_add_u32 v180, s61, v178
    v_mul_u32_u24 v181, 52429, v180
    v_lshrrev_b32 v181, 18, v181
    v_mul_u32_u24 v182, 5, v181
    v_sub_u32 v182, v180, v182
    v_mul_lo_u32 v181, v181, s57
    v_lshlrev_b32 v182, 8, v182
    v_add_u32 v181, v181, v182
    v_lshl_add_u32 v167, v172, 3, v181
    s_lshl_b32 s60, s49, 2
    s_lshl_b32 s61, s63, 1
    s_add_u32 s60, s60, s61
    s_mul_i32 s7, s60, s58
    s_add_u32 s8, s7, s58
    s_lshr_b32 s63, s3, 1
    s_and_b32 s64, s3, 1
    v_and_b32 v16, 31, v1
    s_lshl_b32 s56, s63, 6
    v_add_u32 v17, s56, v16
    v_lshlrev_b32 v17, 7, v17
    v_bfe_u32 v18, v16, 1, 3
    v_lshrrev_b32 v19, 5, v1
    v_xor_b32 v18, v18, v19
    v_xor_b32 v2, 0, v18
    v_lshlrev_b32 v2, 4, v2
    v_add_u32 v2, v2, v17
    v_xor_b32 v3, 2, v18
    v_lshlrev_b32 v3, 4, v3
    v_add_u32 v3, v3, v17
    v_xor_b32 v4, 4, v18
    v_lshlrev_b32 v4, 4, v4
    v_add_u32 v4, v4, v17
    v_xor_b32 v5, 6, v18
    v_lshlrev_b32 v5, 4, v5
    v_add_u32 v5, v5, v17
    v_and_b32 v20, 15, v1
    v_lshrrev_b32 v21, 2, v20
    v_lshlrev_b32 v22, 3, v19
    v_add_u32 v22, v22, v21
    v_lshlrev_b32 v22, 8, v22
    v_bfe_u32 v23, v1, 4, 1
    v_lshlrev_b32 v23, 1, v23
    v_bfe_u32 v24, v1, 1, 1
    v_add_u32 v23, v23, v24
    s_lshl_b32 s56, s64, 3
    s_lshl_b32 s57, s63, 2
    s_add_u32 s56, s56, s57
    v_add_u32 v23, s56, v23
    v_lshlrev_b32 v21, 2, v21
    v_xor_b32 v23, v23, v21
    v_lshlrev_b32 v23, 4, v23
    v_and_b32 v24, 1, v1
    v_lshlrev_b32 v24, 3, v24
    v_add_u32 v22, v22, v23
    v_add_u32 v22, v22, v24
    v_add_u32 v6, 16384, v22
    v_xor_b32 v7, 64, v6
    v_and_b32 v16, 15, v1
    v_bfe_u32 v17, v1, 4, 1
    v_cmp_eq_u32 vcc, v16, v17
    v_mov_b32 v18, 0x3f803f80
    s_nop 1
    v_cndmask_b32 v8, 0, v18, vcc
    v_mov_b32 v9, v8
    v_mov_b32 v10, v8
    v_mov_b32 v11, v8
    v_mov_b32 v12, 0
    v_mov_b32 v13, 0
    v_mov_b32 v14, 0
    v_mov_b32 v15, 0
    v_mov_b32 v80, 0
    v_mov_b32 v81, 0
    v_mov_b32 v82, 0
    v_mov_b32 v83, 0
    v_mov_b32 v84, 0
    v_mov_b32 v85, 0
    v_mov_b32 v86, 0
    v_mov_b32 v87, 0
    v_mov_b32 v88, 0
    v_mov_b32 v89, 0
    v_mov_b32 v90, 0
    v_mov_b32 v91, 0
    v_mov_b32 v92, 0
    v_mov_b32 v93, 0
    v_mov_b32 v94, 0
    v_mov_b32 v95, 0
    v_mov_b32 v96, 0
    v_mov_b32 v97, 0
    v_mov_b32 v98, 0
    v_mov_b32 v99, 0
    v_mov_b32 v100, 0
    v_mov_b32 v101, 0
    v_mov_b32 v102, 0
    v_mov_b32 v103, 0
    v_mov_b32 v104, 0
    v_mov_b32 v105, 0
    v_mov_b32 v106, 0
    v_mov_b32 v107, 0
    v_mov_b32 v108, 0
    v_mov_b32 v109, 0
    v_mov_b32 v110, 0
    v_mov_b32 v111, 0
    v_mov_b32 v112, 0
    v_mov_b32 v113, 0
    v_mov_b32 v114, 0
    v_mov_b32 v115, 0
    v_mov_b32 v116, 0
    v_mov_b32 v117, 0
    v_mov_b32 v118, 0
    v_mov_b32 v119, 0
    v_mov_b32 v120, 0
    v_mov_b32 v121, 0
    v_mov_b32 v122, 0
    v_mov_b32 v123, 0
    v_mov_b32 v124, 0
    v_mov_b32 v125, 0
    v_mov_b32 v126, 0
    v_mov_b32 v127, 0
    v_mov_b32 v128, 0
    v_mov_b32 v129, 0
    v_mov_b32 v130, 0
    v_mov_b32 v131, 0
    v_mov_b32 v132, 0
    v_mov_b32 v133, 0
    v_mov_b32 v134, 0
    v_mov_b32 v135, 0
    v_mov_b32 v136, 0
    v_mov_b32 v137, 0
    v_mov_b32 v138, 0
    v_mov_b32 v139, 0
    v_mov_b32 v140, 0
    v_mov_b32 v141, 0
    v_mov_b32 v142, 0
    v_mov_b32 v143, 0
    v_mov_b32 v0, v6
    v_mov_b32 v1, v7
    s_barrier
    ds_read_b64_tr_b16 v[24:25], v6 offset:0
    ds_read_b64_tr_b16 v[26:27], v6 offset:1024
    ds_read_b128 v[16:19], v2
    ds_read_b128 v[20:23], v2 offset:4096
    ds_read_b64_tr_b16 v[28:29], v7 offset:0
    ds_read_b64_tr_b16 v[30:31], v7 offset:1024
    ds_read_b64_tr_b16 v[40:41], v6 offset:4096
    ds_read_b64_tr_b16 v[42:43], v6 offset:5120
    ds_read_b128 v[32:35], v3
    ds_read_b128 v[36:39], v3 offset:4096
    ds_read_b64_tr_b16 v[44:45], v7 offset:4096
    ds_read_b64_tr_b16 v[46:47], v7 offset:5120
    ds_read_b64_tr_b16 v[56:57], v6 offset:8192
    ds_read_b64_tr_b16 v[58:59], v6 offset:9216
    ds_read_b128 v[48:51], v4
    ds_read_b128 v[52:55], v4 offset:4096
    ds_read_b64_tr_b16 v[60:61], v7 offset:8192
    ds_read_b64_tr_b16 v[62:63], v7 offset:9216
    s_mov_b32 s52, 0
    s_mov_b32 s69, 1
    s_mov_b32 s65, 32768
    v_add_u32 v2, s65, v2
    v_add_u32 v3, s65, v3
.p2align 5
L_p1T_cloop:
    s_waitcnt lgkmcnt(12)
    v_mfma_f32_32x32x16_bf16 v[80:95], v[24:27], v[16:19], v[80:95]
    v_mfma_f32_16x16x32_bf16 v[12:15], v[8:11], v[24:27], v[12:15]
    ds_read_b64_tr_b16 v[72:73], v0 offset:12288
    ds_read_b64_tr_b16 v[74:75], v0 offset:13312
    v_add_u32 v4, s65, v4
    v_mfma_f32_32x32x16_bf16 v[112:127], v[24:27], v[20:23], v[112:127]
    ds_read_b128 v[64:67], v5
    v_add_u32 v6, s65, v6
    v_mfma_f32_32x32x16_bf16 v[96:111], v[28:31], v[16:19], v[96:111]
    ds_read_b128 v[68:71], v5 offset:4096
    v_add_u32 v7, s65, v7
    v_mfma_f32_32x32x16_bf16 v[128:143], v[28:31], v[20:23], v[128:143]
    ds_read_b64_tr_b16 v[76:77], v1 offset:12288
    ds_read_b64_tr_b16 v[78:79], v1 offset:13312
    s_barrier
    s_waitcnt lgkmcnt(12)
    v_mfma_f32_32x32x16_bf16 v[80:95], v[40:43], v[32:35], v[80:95]
    v_mfma_f32_16x16x32_bf16 v[12:15], v[8:11], v[40:43], v[12:15]
    ds_read_b64_tr_b16 v[24:25], v6 offset:0
    ds_read_b64_tr_b16 v[26:27], v6 offset:1024
    v_add_u32 v5, s65, v5
    s_cmp_eq_u32 s69, 3
    v_mfma_f32_32x32x16_bf16 v[112:127], v[40:43], v[36:39], v[112:127]
    ds_read_b128 v[16:19], v2
    s_mov_b32 s61, 32768
    s_cselect_b32 s61, 0xfffe8000, s61
    v_mfma_f32_32x32x16_bf16 v[96:111], v[44:47], v[32:35], v[96:111]
    ds_read_b128 v[20:23], v2 offset:4096
    v_mov_b32 v0, v6
    s_cselect_b32 s69, -1, s69
    v_mfma_f32_32x32x16_bf16 v[128:143], v[44:47], v[36:39], v[128:143]
    ds_read_b64_tr_b16 v[28:29], v7 offset:0
    ds_read_b64_tr_b16 v[30:31], v7 offset:1024
    v_mov_b32 v1, v7
    s_add_u32 s69, s69, 1
    s_waitcnt lgkmcnt(12)
    v_mfma_f32_32x32x16_bf16 v[80:95], v[56:59], v[48:51], v[80:95]
    v_mfma_f32_16x16x32_bf16 v[12:15], v[8:11], v[56:59], v[12:15]
    ds_read_b64_tr_b16 v[40:41], v6 offset:4096
    ds_read_b64_tr_b16 v[42:43], v6 offset:5120
    v_add_u32 v2, s61, v2
    v_mfma_f32_32x32x16_bf16 v[112:127], v[56:59], v[52:55], v[112:127]
    ds_read_b128 v[32:35], v3
    s_add_u32 s52, s52, 1
    v_mfma_f32_32x32x16_bf16 v[96:111], v[60:63], v[48:51], v[96:111]
    ds_read_b128 v[36:39], v3 offset:4096
    s_cmp_eq_u32 s52, 3
    s_cselect_b32 s54, s62, s53
    buffer_load_dword v253, v252, s[44:47], s54 offen
    v_mfma_f32_32x32x16_bf16 v[128:143], v[60:63], v[52:55], v[128:143]
    ds_read_b64_tr_b16 v[44:45], v7 offset:4096
    ds_read_b64_tr_b16 v[46:47], v7 offset:5120
    s_waitcnt lgkmcnt(12)
    v_mfma_f32_32x32x16_bf16 v[80:95], v[72:75], v[64:67], v[80:95]
    v_mfma_f32_16x16x32_bf16 v[12:15], v[8:11], v[72:75], v[12:15]
    ds_read_b64_tr_b16 v[56:57], v6 offset:8192
    ds_read_b64_tr_b16 v[58:59], v6 offset:9216
    v_add_u32 v3, s61, v3
    v_mfma_f32_32x32x16_bf16 v[112:127], v[72:75], v[68:71], v[112:127]
    ds_read_b128 v[48:51], v4
    s_mov_b32 s65, s61
    v_mfma_f32_32x32x16_bf16 v[96:111], v[76:79], v[64:67], v[96:111]
    ds_read_b128 v[52:55], v4 offset:4096
    s_cmp_lt_u32 s52, 10
    v_mfma_f32_32x32x16_bf16 v[128:143], v[76:79], v[68:71], v[128:143]
    ds_read_b64_tr_b16 v[60:61], v7 offset:8192
    ds_read_b64_tr_b16 v[62:63], v7 offset:9216
    s_cbranch_scc1 L_p1T_cloop
    s_waitcnt lgkmcnt(0)
    v_mbcnt_lo_u32_b32 v1, -1, 0
    v_mbcnt_hi_u32_b32 v1, -1, v1
    s_lshl_b32 s56, s64, 8
    s_lshl_b32 s57, s63, 7
    s_add_u32 s56, s56, s57
    s_add_u32 s56, s56, 141312
    v_lshlrev_b32 v16, 2, v1
    v_add_u32 v16, s56, v16
    s_nop 4
    s_mov_b64 exec, 0xffff
    ds_write_b32 v16, v12
    ds_write_b32 v16, v13 offset:64
    s_mov_b64 exec, -1
    s_waitcnt lgkmcnt(0)
    s_barrier
    ds_read_b32 v150, v168 offset:9216
    ds_read_b32 v151, v168 offset:9728
    ds_read_b32 v152, v168 offset:9344
    ds_read_b32 v153, v168 offset:9856
    ds_read_b128 v[16:19], v169 offset:0
    ds_read_b128 v[20:23], v169 offset:32
    ds_read_b128 v[24:27], v169 offset:64
    ds_read_b128 v[28:31], v169 offset:96
    ds_read_b128 v[32:35], v170 offset:0
    ds_read_b128 v[36:39], v170 offset:32
    ds_read_b128 v[40:43], v170 offset:64
    ds_read_b128 v[44:47], v170 offset:96
    s_waitcnt lgkmcnt(8)
    v_mul_f32 v150, s6, v150
    v_mul_f32 v151, s6, v151
    v_mul_f32 v152, s6, v152
    v_mul_f32 v153, s6, v153
    s_waitcnt lgkmcnt(0)
    v_pk_mul_f32 v[80:81], v[80:81], v[150:151] op_sel:[0,0] op_sel_hi:[1,0]
    v_pk_fma_f32 v[80:81], v[16:17], v[150:151], v[80:81] op_sel:[0,1,0] op_sel_hi:[1,1,1]
    v_pk_mul_f32 v[82:83], v[82:83], v[150:151] op_sel:[0,0] op_sel_hi:[1,0]
    v_pk_fma_f32 v[82:83], v[18:19], v[150:151], v[82:83] op_sel:[0,1,0] op_sel_hi:[1,1,1]
    v_cvt_pk_bf16_f32 v80, v80, v81
    v_cvt_pk_bf16_f32 v81, v82, v83
    buffer_store_dwordx2 v[80:81], v160, s[36:39], s7 offen sc1
    v_pk_mul_f32 v[84:85], v[84:85], v[150:151] op_sel:[0,0] op_sel_hi:[1,0]
    v_pk_fma_f32 v[84:85], v[20:21], v[150:151], v[84:85] op_sel:[0,1,0] op_sel_hi:[1,1,1]
    v_pk_mul_f32 v[86:87], v[86:87], v[150:151] op_sel:[0,0] op_sel_hi:[1,0]
    v_pk_fma_f32 v[86:87], v[22:23], v[150:151], v[86:87] op_sel:[0,1,0] op_sel_hi:[1,1,1]
    v_cvt_pk_bf16_f32 v84, v84, v85
    v_cvt_pk_bf16_f32 v85, v86, v87
    buffer_store_dwordx2 v[84:85], v161, s[36:39], s7 offen sc1
    v_pk_mul_f32 v[88:89], v[88:89], v[150:151] op_sel:[0,0] op_sel_hi:[1,0]
    v_pk_fma_f32 v[88:89], v[24:25], v[150:151], v[88:89] op_sel:[0,1,0] op_sel_hi:[1,1,1]
    v_pk_mul_f32 v[90:91], v[90:91], v[150:151] op_sel:[0,0] op_sel_hi:[1,0]
    v_pk_fma_f32 v[90:91], v[26:27], v[150:151], v[90:91] op_sel:[0,1,0] op_sel_hi:[1,1,1]
    v_cvt_pk_bf16_f32 v88, v88, v89
    v_cvt_pk_bf16_f32 v89, v90, v91
    buffer_store_dwordx2 v[88:89], v162, s[36:39], s7 offen sc1
    v_pk_mul_f32 v[92:93], v[92:93], v[150:151] op_sel:[0,0] op_sel_hi:[1,0]
    v_pk_fma_f32 v[92:93], v[28:29], v[150:151], v[92:93] op_sel:[0,1,0] op_sel_hi:[1,1,1]
    v_pk_mul_f32 v[94:95], v[94:95], v[150:151] op_sel:[0,0] op_sel_hi:[1,0]
    v_pk_fma_f32 v[94:95], v[30:31], v[150:151], v[94:95] op_sel:[0,1,0] op_sel_hi:[1,1,1]
    v_cvt_pk_bf16_f32 v92, v92, v93
    v_cvt_pk_bf16_f32 v93, v94, v95
    buffer_store_dwordx2 v[92:93], v163, s[36:39], s7 offen sc1
    v_pk_mul_f32 v[96:97], v[96:97], v[150:151] op_sel:[0,0] op_sel_hi:[1,0]
    v_pk_fma_f32 v[96:97], v[32:33], v[150:151], v[96:97] op_sel:[0,1,0] op_sel_hi:[1,1,1]
    v_pk_mul_f32 v[98:99], v[98:99], v[150:151] op_sel:[0,0] op_sel_hi:[1,0]
    v_pk_fma_f32 v[98:99], v[34:35], v[150:151], v[98:99] op_sel:[0,1,0] op_sel_hi:[1,1,1]
    v_cvt_pk_bf16_f32 v96, v96, v97
    v_cvt_pk_bf16_f32 v97, v98, v99
    buffer_store_dwordx2 v[96:97], v164, s[36:39], s7 offen sc1
    v_pk_mul_f32 v[100:101], v[100:101], v[150:151] op_sel:[0,0] op_sel_hi:[1,0]
    v_pk_fma_f32 v[100:101], v[36:37], v[150:151], v[100:101] op_sel:[0,1,0] op_sel_hi:[1,1,1]
    v_pk_mul_f32 v[102:103], v[102:103], v[150:151] op_sel:[0,0] op_sel_hi:[1,0]
    v_pk_fma_f32 v[102:103], v[38:39], v[150:151], v[102:103] op_sel:[0,1,0] op_sel_hi:[1,1,1]
    v_cvt_pk_bf16_f32 v100, v100, v101
    v_cvt_pk_bf16_f32 v101, v102, v103
    buffer_store_dwordx2 v[100:101], v165, s[36:39], s7 offen sc1
    v_pk_mul_f32 v[104:105], v[104:105], v[150:151] op_sel:[0,0] op_sel_hi:[1,0]
    v_pk_fma_f32 v[104:105], v[40:41], v[150:151], v[104:105] op_sel:[0,1,0] op_sel_hi:[1,1,1]
    v_pk_mul_f32 v[106:107], v[106:107], v[150:151] op_sel:[0,0] op_sel_hi:[1,0]
    v_pk_fma_f32 v[106:107], v[42:43], v[150:151], v[106:107] op_sel:[0,1,0] op_sel_hi:[1,1,1]
    v_cvt_pk_bf16_f32 v104, v104, v105
    v_cvt_pk_bf16_f32 v105, v106, v107
    buffer_store_dwordx2 v[104:105], v166, s[36:39], s7 offen sc1
    v_pk_mul_f32 v[108:109], v[108:109], v[150:151] op_sel:[0,0] op_sel_hi:[1,0]
    v_pk_fma_f32 v[108:109], v[44:45], v[150:151], v[108:109] op_sel:[0,1,0] op_sel_hi:[1,1,1]
    v_pk_mul_f32 v[110:111], v[110:111], v[150:151] op_sel:[0,0] op_sel_hi:[1,0]
    v_pk_fma_f32 v[110:111], v[46:47], v[150:151], v[110:111] op_sel:[0,1,0] op_sel_hi:[1,1,1]
    v_cvt_pk_bf16_f32 v108, v108, v109
    v_cvt_pk_bf16_f32 v109, v110, v111
    buffer_store_dwordx2 v[108:109], v167, s[36:39], s7 offen sc1
    v_pk_mul_f32 v[112:113], v[112:113], v[152:153] op_sel:[0,0] op_sel_hi:[1,0]
    v_pk_fma_f32 v[112:113], v[16:17], v[152:153], v[112:113] op_sel:[0,1,0] op_sel_hi:[1,1,1]
    v_pk_mul_f32 v[114:115], v[114:115], v[152:153] op_sel:[0,0] op_sel_hi:[1,0]
    v_pk_fma_f32 v[114:115], v[18:19], v[152:153], v[114:115] op_sel:[0,1,0] op_sel_hi:[1,1,1]
    v_cvt_pk_bf16_f32 v112, v112, v113
    v_cvt_pk_bf16_f32 v113, v114, v115
    buffer_store_dwordx2 v[112:113], v160, s[36:39], s8 offen sc1
    v_pk_mul_f32 v[116:117], v[116:117], v[152:153] op_sel:[0,0] op_sel_hi:[1,0]
    v_pk_fma_f32 v[116:117], v[20:21], v[152:153], v[116:117] op_sel:[0,1,0] op_sel_hi:[1,1,1]
    v_pk_mul_f32 v[118:119], v[118:119], v[152:153] op_sel:[0,0] op_sel_hi:[1,0]
    v_pk_fma_f32 v[118:119], v[22:23], v[152:153], v[118:119] op_sel:[0,1,0] op_sel_hi:[1,1,1]
    v_cvt_pk_bf16_f32 v116, v116, v117
    v_cvt_pk_bf16_f32 v117, v118, v119
    buffer_store_dwordx2 v[116:117], v161, s[36:39], s8 offen sc1
    v_pk_mul_f32 v[120:121], v[120:121], v[152:153] op_sel:[0,0] op_sel_hi:[1,0]
    v_pk_fma_f32 v[120:121], v[24:25], v[152:153], v[120:121] op_sel:[0,1,0] op_sel_hi:[1,1,1]
    v_pk_mul_f32 v[122:123], v[122:123], v[152:153] op_sel:[0,0] op_sel_hi:[1,0]
    v_pk_fma_f32 v[122:123], v[26:27], v[152:153], v[122:123] op_sel:[0,1,0] op_sel_hi:[1,1,1]
    v_cvt_pk_bf16_f32 v120, v120, v121
    v_cvt_pk_bf16_f32 v121, v122, v123
    buffer_store_dwordx2 v[120:121], v162, s[36:39], s8 offen sc1
    v_pk_mul_f32 v[124:125], v[124:125], v[152:153] op_sel:[0,0] op_sel_hi:[1,0]
    v_pk_fma_f32 v[124:125], v[28:29], v[152:153], v[124:125] op_sel:[0,1,0] op_sel_hi:[1,1,1]
    v_pk_mul_f32 v[126:127], v[126:127], v[152:153] op_sel:[0,0] op_sel_hi:[1,0]
    v_pk_fma_f32 v[126:127], v[30:31], v[152:153], v[126:127] op_sel:[0,1,0] op_sel_hi:[1,1,1]
    v_cvt_pk_bf16_f32 v124, v124, v125
    v_cvt_pk_bf16_f32 v125, v126, v127
    buffer_store_dwordx2 v[124:125], v163, s[36:39], s8 offen sc1
    v_pk_mul_f32 v[128:129], v[128:129], v[152:153] op_sel:[0,0] op_sel_hi:[1,0]
    v_pk_fma_f32 v[128:129], v[32:33], v[152:153], v[128:129] op_sel:[0,1,0] op_sel_hi:[1,1,1]
    v_pk_mul_f32 v[130:131], v[130:131], v[152:153] op_sel:[0,0] op_sel_hi:[1,0]
    v_pk_fma_f32 v[130:131], v[34:35], v[152:153], v[130:131] op_sel:[0,1,0] op_sel_hi:[1,1,1]
    v_cvt_pk_bf16_f32 v128, v128, v129
    v_cvt_pk_bf16_f32 v129, v130, v131
    buffer_store_dwordx2 v[128:129], v164, s[36:39], s8 offen sc1
    v_pk_mul_f32 v[132:133], v[132:133], v[152:153] op_sel:[0,0] op_sel_hi:[1,0]
    v_pk_fma_f32 v[132:133], v[36:37], v[152:153], v[132:133] op_sel:[0,1,0] op_sel_hi:[1,1,1]
    v_pk_mul_f32 v[134:135], v[134:135], v[152:153] op_sel:[0,0] op_sel_hi:[1,0]
    v_pk_fma_f32 v[134:135], v[38:39], v[152:153], v[134:135] op_sel:[0,1,0] op_sel_hi:[1,1,1]
    v_cvt_pk_bf16_f32 v132, v132, v133
    v_cvt_pk_bf16_f32 v133, v134, v135
    buffer_store_dwordx2 v[132:133], v165, s[36:39], s8 offen sc1
    v_pk_mul_f32 v[136:137], v[136:137], v[152:153] op_sel:[0,0] op_sel_hi:[1,0]
    v_pk_fma_f32 v[136:137], v[40:41], v[152:153], v[136:137] op_sel:[0,1,0] op_sel_hi:[1,1,1]
    v_pk_mul_f32 v[138:139], v[138:139], v[152:153] op_sel:[0,0] op_sel_hi:[1,0]
    v_pk_fma_f32 v[138:139], v[42:43], v[152:153], v[138:139] op_sel:[0,1,0] op_sel_hi:[1,1,1]
    v_cvt_pk_bf16_f32 v136, v136, v137
    v_cvt_pk_bf16_f32 v137, v138, v139
    buffer_store_dwordx2 v[136:137], v166, s[36:39], s8 offen sc1
    v_pk_mul_f32 v[140:141], v[140:141], v[152:153] op_sel:[0,0] op_sel_hi:[1,0]
    v_pk_fma_f32 v[140:141], v[44:45], v[152:153], v[140:141] op_sel:[0,1,0] op_sel_hi:[1,1,1]
    v_pk_mul_f32 v[142:143], v[142:143], v[152:153] op_sel:[0,0] op_sel_hi:[1,0]
    v_pk_fma_f32 v[142:143], v[46:47], v[152:153], v[142:143] op_sel:[0,1,0] op_sel_hi:[1,1,1]
    v_cvt_pk_bf16_f32 v140, v140, v141
    v_cvt_pk_bf16_f32 v141, v142, v143
    buffer_store_dwordx2 v[140:141], v167, s[36:39], s8 offen sc1
    s_branch L_p1_done
L_p1_N:
    s_lshr_b32 s63, s3, 1
    s_and_b32 s64, s3, 1
    v_and_b32 v172, 31, v1
    v_lshrrev_b32 v178, 5, v1
    s_lshl_b32 s56, s63, 8
    v_lshlrev_b32 v176, 4, v178
    v_add_u32 v176, s56, v176
    v_add_u32 v168, 131072, v176
    s_mov_b32 s58, 163840
    s_xor_b32 s56, s63, 0
    s_lshl_b32 s56, s56, 5
    s_lshl_b32 s57, s64, 6
    s_add_u32 s56, s56, s57
    v_add_u32 v173, s56, v172
    v_lshlrev_b32 v174, 2, v173
    v_add_u32 v169, 141312, v174
    s_sub_u32 s57, s50, 10
    s_lshl_b32 s57, s57, 7
    v_add_u32 v179, s57, v173
    v_mul_u32_u24 v180, 52429, v179
    v_lshrrev_b32 v180, 20, v180
    v_mul_u32_u24 v181, 20, v180
    v_sub_u32 v181, v179, v181
    v_mul_lo_u32 v180, v180, s58
    v_lshlrev_b32 v181, 4, v181
    v_add_u32 v180, v180, v181
    v_mul_u32_u24 v181, 320, v178
    v_add_u32 v180, v180, v181
    v_add_u32 v160, 1280, v180
    s_xor_b32 s56, s63, 1
    s_lshl_b32 s56, s56, 5
    s_lshl_b32 s57, s64, 6
    s_add_u32 s56, s56, s57
    v_add_u32 v173, s56, v172
    v_lshlrev_b32 v174, 2, v173
    v_add_u32 v170, 141312, v174
    s_sub_u32 s57, s50, 10
    s_lshl_b32 s57, s57, 7
    v_add_u32 v179, s57, v173
    v_mul_u32_u24 v180, 52429, v179
    v_lshrrev_b32 v180, 20, v180
    v_mul_u32_u24 v181, 20, v180
    v_sub_u32 v181, v179, v181
    v_mul_lo_u32 v180, v180, s58
    v_lshlrev_b32 v181, 4, v181
    v_add_u32 v180, v180, v181
    v_mul_u32_u24 v181, 320, v178
    v_add_u32 v180, v180, v181
    v_add_u32 v161, 1280, v180
    s_add_u32 s36, s24, 0x400000
    s_addc_u32 s37, s25, 0
    s_mov_b32 s38, 0x500000
    s_mov_b32 s39, 0x20000
    s_lshl_b32 s60, s49, 2
    s_lshl_b32 s61, s63, 1
    s_add_u32 s60, s60, s61
    s_mul_i32 s7, s60, 2560
    s_add_u32 s8, s7, 2560
    s_lshr_b32 s63, s3, 1
    s_and_b32 s64, s3, 1
    v_and_b32 v16, 31, v1
    s_lshl_b32 s56, s63, 6
    v_add_u32 v17, s56, v16
    v_lshlrev_b32 v17, 7, v17
    v_bfe_u32 v18, v16, 1, 3
    v_lshrrev_b32 v19, 5, v1
    v_xor_b32 v18, v18, v19
    v_xor_b32 v2, 0, v18
    v_lshlrev_b32 v2, 4, v2
    v_add_u32 v2, v2, v17
    v_xor_b32 v3, 2, v18
    v_lshlrev_b32 v3, 4, v3
    v_add_u32 v3, v3, v17
    v_xor_b32 v4, 4, v18
    v_lshlrev_b32 v4, 4, v4
    v_add_u32 v4, v4, v17
    v_xor_b32 v5, 6, v18
    v_lshlrev_b32 v5, 4, v5
    v_add_u32 v5, v5, v17
    v_and_b32 v20, 15, v1
    v_lshrrev_b32 v21, 2, v20
    v_lshlrev_b32 v22, 3, v19
    v_add_u32 v22, v22, v21
    v_lshlrev_b32 v22, 8, v22
    v_bfe_u32 v23, v1, 4, 1
    v_lshlrev_b32 v23, 1, v23
    v_bfe_u32 v24, v1, 1, 1
    v_add_u32 v23, v23, v24
    s_lshl_b32 s56, s64, 3
    s_lshl_b32 s57, s63, 2
    s_add_u32 s56, s56, s57
    v_add_u32 v23, s56, v23
    v_lshlrev_b32 v21, 2, v21
    v_xor_b32 v23, v23, v21
    v_lshlrev_b32 v23, 4, v23
    v_and_b32 v24, 1, v1
    v_lshlrev_b32 v24, 3, v24
    v_add_u32 v22, v22, v23
    v_add_u32 v22, v22, v24
    v_add_u32 v6, 16384, v22
    v_xor_b32 v7, 64, v6
    v_and_b32 v16, 15, v1
    v_bfe_u32 v17, v1, 4, 1
    v_cmp_eq_u32 vcc, v16, v17
    v_mov_b32 v18, 0x3f803f80
    s_nop 1
    v_cndmask_b32 v8, 0, v18, vcc
    v_mov_b32 v9, v8
    v_mov_b32 v10, v8
    v_mov_b32 v11, v8
    v_mov_b32 v12, 0
    v_mov_b32 v13, 0
    v_mov_b32 v14, 0
    v_mov_b32 v15, 0
    v_mov_b32 v80, 0
    v_mov_b32 v81, 0
    v_mov_b32 v82, 0
    v_mov_b32 v83, 0
    v_mov_b32 v84, 0
    v_mov_b32 v85, 0
    v_mov_b32 v86, 0
    v_mov_b32 v87, 0
    v_mov_b32 v88, 0
    v_mov_b32 v89, 0
    v_mov_b32 v90, 0
    v_mov_b32 v91, 0
    v_mov_b32 v92, 0
    v_mov_b32 v93, 0
    v_mov_b32 v94, 0
    v_mov_b32 v95, 0
    v_mov_b32 v96, 0
    v_mov_b32 v97, 0
    v_mov_b32 v98, 0
    v_mov_b32 v99, 0
    v_mov_b32 v100, 0
    v_mov_b32 v101, 0
    v_mov_b32 v102, 0
    v_mov_b32 v103, 0
    v_mov_b32 v104, 0
    v_mov_b32 v105, 0
    v_mov_b32 v106, 0
    v_mov_b32 v107, 0
    v_mov_b32 v108, 0
    v_mov_b32 v109, 0
    v_mov_b32 v110, 0
    v_mov_b32 v111, 0
    v_mov_b32 v112, 0
    v_mov_b32 v113, 0
    v_mov_b32 v114, 0
    v_mov_b32 v115, 0
    v_mov_b32 v116, 0
    v_mov_b32 v117, 0
    v_mov_b32 v118, 0
    v_mov_b32 v119, 0
    v_mov_b32 v120, 0
    v_mov_b32 v121, 0
    v_mov_b32 v122, 0
    v_mov_b32 v123, 0
    v_mov_b32 v124, 0
    v_mov_b32 v125, 0
    v_mov_b32 v126, 0
    v_mov_b32 v127, 0
    v_mov_b32 v128, 0
    v_mov_b32 v129, 0
    v_mov_b32 v130, 0
    v_mov_b32 v131, 0
    v_mov_b32 v132, 0
    v_mov_b32 v133, 0
    v_mov_b32 v134, 0
    v_mov_b32 v135, 0
    v_mov_b32 v136, 0
    v_mov_b32 v137, 0
    v_mov_b32 v138, 0
    v_mov_b32 v139, 0
    v_mov_b32 v140, 0
    v_mov_b32 v141, 0
    v_mov_b32 v142, 0
    v_mov_b32 v143, 0
    v_mov_b32 v0, v6
    v_mov_b32 v1, v7
    s_barrier
    ds_read_b64_tr_b16 v[24:25], v6 offset:0
    ds_read_b64_tr_b16 v[26:27], v6 offset:1024
    ds_read_b128 v[16:19], v2
    ds_read_b128 v[20:23], v2 offset:4096
    ds_read_b64_tr_b16 v[28:29], v7 offset:0
    ds_read_b64_tr_b16 v[30:31], v7 offset:1024
    ds_read_b64_tr_b16 v[40:41], v6 offset:4096
    ds_read_b64_tr_b16 v[42:43], v6 offset:5120
    ds_read_b128 v[32:35], v3
    ds_read_b128 v[36:39], v3 offset:4096
    ds_read_b64_tr_b16 v[44:45], v7 offset:4096
    ds_read_b64_tr_b16 v[46:47], v7 offset:5120
    ds_read_b64_tr_b16 v[56:57], v6 offset:8192
    ds_read_b64_tr_b16 v[58:59], v6 offset:9216
    ds_read_b128 v[48:51], v4
    ds_read_b128 v[52:55], v4 offset:4096
    ds_read_b64_tr_b16 v[60:61], v7 offset:8192
    ds_read_b64_tr_b16 v[62:63], v7 offset:9216
    s_mov_b32 s52, 0
    s_mov_b32 s69, 1
    s_mov_b32 s65, 32768
    v_add_u32 v2, s65, v2
    v_add_u32 v3, s65, v3
.p2align 5
L_p1N_cloop:
    s_waitcnt lgkmcnt(12)
    v_mfma_f32_32x32x16_bf16 v[80:95], v[16:19], v[24:27], v[80:95]
    v_mfma_f32_16x16x32_bf16 v[12:15], v[8:11], v[24:27], v[12:15]
    ds_read_b64_tr_b16 v[72:73], v0 offset:12288
    ds_read_b64_tr_b16 v[74:75], v0 offset:13312
    v_add_u32 v4, s65, v4
    v_mfma_f32_32x32x16_bf16 v[112:127], v[20:23], v[24:27], v[112:127]
    ds_read_b128 v[64:67], v5
    v_add_u32 v6, s65, v6
    v_mfma_f32_32x32x16_bf16 v[96:111], v[16:19], v[28:31], v[96:111]
    ds_read_b128 v[68:71], v5 offset:4096
    v_add_u32 v7, s65, v7
    v_mfma_f32_32x32x16_bf16 v[128:143], v[20:23], v[28:31], v[128:143]
    ds_read_b64_tr_b16 v[76:77], v1 offset:12288
    ds_read_b64_tr_b16 v[78:79], v1 offset:13312
    s_barrier
    s_waitcnt lgkmcnt(12)
    v_mfma_f32_32x32x16_bf16 v[80:95], v[32:35], v[40:43], v[80:95]
    v_mfma_f32_16x16x32_bf16 v[12:15], v[8:11], v[40:43], v[12:15]
    ds_read_b64_tr_b16 v[24:25], v6 offset:0
    ds_read_b64_tr_b16 v[26:27], v6 offset:1024
    v_add_u32 v5, s65, v5
    s_cmp_eq_u32 s69, 3
    v_mfma_f32_32x32x16_bf16 v[112:127], v[36:39], v[40:43], v[112:127]
    ds_read_b128 v[16:19], v2
    s_mov_b32 s61, 32768
    s_cselect_b32 s61, 0xfffe8000, s61
    v_mfma_f32_32x32x16_bf16 v[96:111], v[32:35], v[44:47], v[96:111]
    ds_read_b128 v[20:23], v2 offset:4096
    v_mov_b32 v0, v6
    s_cselect_b32 s69, -1, s69
    v_mfma_f32_32x32x16_bf16 v[128:143], v[36:39], v[44:47], v[128:143]
    ds_read_b64_tr_b16 v[28:29], v7 offset:0
    ds_read_b64_tr_b16 v[30:31], v7 offset:1024
    v_mov_b32 v1, v7
    s_add_u32 s69, s69, 1
    s_waitcnt lgkmcnt(12)
    v_mfma_f32_32x32x16_bf16 v[80:95], v[48:51], v[56:59], v[80:95]
    v_mfma_f32_16x16x32_bf16 v[12:15], v[8:11], v[56:59], v[12:15]
    ds_read_b64_tr_b16 v[40:41], v6 offset:4096
    ds_read_b64_tr_b16 v[42:43], v6 offset:5120
    v_add_u32 v2, s61, v2
    v_mfma_f32_32x32x16_bf16 v[112:127], v[52:55], v[56:59], v[112:127]
    ds_read_b128 v[32:35], v3
    s_add_u32 s52, s52, 1
    v_mfma_f32_32x32x16_bf16 v[96:111], v[48:51], v[60:63], v[96:111]
    ds_read_b128 v[36:39], v3 offset:4096
    s_cmp_eq_u32 s52, 3
    s_cselect_b32 s54, s62, s53
    buffer_load_dword v253, v252, s[44:47], s54 offen
    v_mfma_f32_32x32x16_bf16 v[128:143], v[52:55], v[60:63], v[128:143]
    ds_read_b64_tr_b16 v[44:45], v7 offset:4096
    ds_read_b64_tr_b16 v[46:47], v7 offset:5120
    s_waitcnt lgkmcnt(12)
    v_mfma_f32_32x32x16_bf16 v[80:95], v[64:67], v[72:75], v[80:95]
    v_mfma_f32_16x16x32_bf16 v[12:15], v[8:11], v[72:75], v[12:15]
    ds_read_b64_tr_b16 v[56:57], v6 offset:8192
    ds_read_b64_tr_b16 v[58:59], v6 offset:9216
    v_add_u32 v3, s61, v3
    v_mfma_f32_32x32x16_bf16 v[112:127], v[68:71], v[72:75], v[112:127]
    ds_read_b128 v[48:51], v4
    s_mov_b32 s65, s61
    v_mfma_f32_32x32x16_bf16 v[96:111], v[64:67], v[76:79], v[96:111]
    ds_read_b128 v[52:55], v4 offset:4096
    s_cmp_lt_u32 s52, 10
    v_mfma_f32_32x32x16_bf16 v[128:143], v[68:71], v[76:79], v[128:143]
    ds_read_b64_tr_b16 v[60:61], v7 offset:8192
    ds_read_b64_tr_b16 v[62:63], v7 offset:9216
    s_cbranch_scc1 L_p1N_cloop
    s_waitcnt lgkmcnt(0)
    v_mbcnt_lo_u32_b32 v1, -1, 0
    v_mbcnt_hi_u32_b32 v1, -1, v1
    s_lshl_b32 s56, s64, 8
    s_lshl_b32 s57, s63, 7
    s_add_u32 s56, s56, s57
    s_add_u32 s56, s56, 141312
    v_lshlrev_b32 v16, 2, v1
    v_add_u32 v16, s56, v16
    s_nop 4
    s_mov_b64 exec, 0xffff
    ds_write_b32 v16, v12
    ds_write_b32 v16, v13 offset:64
    s_mov_b64 exec, -1
    s_waitcnt lgkmcnt(0)
    s_barrier
    ds_read_b32 v158, v169
    ds_read_b32 v159, v170
    ds_read_b128 v[16:19], v168 offset:9216
    ds_read_b128 v[32:35], v168 offset:9728
    ds_read_b128 v[20:23], v168 offset:9248
    ds_read_b128 v[36:39], v168 offset:9760
    ds_read_b128 v[24:27], v168 offset:9280
    ds_read_b128 v[40:43], v168 offset:9792
    ds_read_b128 v[28:31], v168 offset:9312
    ds_read_b128 v[44:47], v168 offset:9824
    ds_read_b128 v[48:51], v168 offset:9344
    ds_read_b128 v[64:67], v168 offset:9856
    ds_read_b128 v[52:55], v168 offset:9376
    ds_read_b128 v[68:71], v168 offset:9888
    ds_read_b128 v[56:59], v168 offset:9408
    ds_read_b128 v[72:75], v168 offset:9920
    ds_read_b128 v[60:63], v168 offset:9440
    ds_read_b128 v[76:79], v168 offset:9952
    s_waitcnt lgkmcnt(8)
    v_pk_mul_f32 v[80:81], v[80:81], v[16:17]
    v_pk_fma_f32 v[80:81], v[32:33], v[158:159], v[80:81] op_sel:[0,0,0] op_sel_hi:[1,0,1]
    v_pk_mul_f32 v[82:83], v[82:83], v[18:19]
    v_pk_fma_f32 v[82:83], v[34:35], v[158:159], v[82:83] op_sel:[0,0,0] op_sel_hi:[1,0,1]
    v_pk_mul_f32 v[84:85], v[84:85], v[20:21]
    v_pk_fma_f32 v[84:85], v[36:37], v[158:159], v[84:85] op_sel:[0,0,0] op_sel_hi:[1,0,1]
    v_pk_mul_f32 v[86:87], v[86:87], v[22:23]
    v_pk_fma_f32 v[86:87], v[38:39], v[158:159], v[86:87] op_sel:[0,0,0] op_sel_hi:[1,0,1]
    v_pk_mul_f32 v[88:89], v[88:89], v[24:25]
    v_pk_fma_f32 v[88:89], v[40:41], v[158:159], v[88:89] op_sel:[0,0,0] op_sel_hi:[1,0,1]
    v_pk_mul_f32 v[90:91], v[90:91], v[26:27]
    v_pk_fma_f32 v[90:91], v[42:43], v[158:159], v[90:91] op_sel:[0,0,0] op_sel_hi:[1,0,1]
    v_pk_mul_f32 v[92:93], v[92:93], v[28:29]
    v_pk_fma_f32 v[92:93], v[44:45], v[158:159], v[92:93] op_sel:[0,0,0] op_sel_hi:[1,0,1]
    v_pk_mul_f32 v[94:95], v[94:95], v[30:31]
    v_pk_fma_f32 v[94:95], v[46:47], v[158:159], v[94:95] op_sel:[0,0,0] op_sel_hi:[1,0,1]
    v_cvt_pk_bf16_f32 v80, v80, v81
    v_cvt_pk_bf16_f32 v81, v82, v83
    v_cvt_pk_bf16_f32 v82, v84, v85
    v_cvt_pk_bf16_f32 v83, v86, v87
    buffer_store_dwordx4 v[80:83], v160, s[36:39], s7 offen offset:0 sc1
    v_cvt_pk_bf16_f32 v88, v88, v89
    v_cvt_pk_bf16_f32 v89, v90, v91
    v_cvt_pk_bf16_f32 v90, v92, v93
    v_cvt_pk_bf16_f32 v91, v94, v95
    buffer_store_dwordx4 v[88:91], v160, s[36:39], s7 offen offset:640 sc1
    v_pk_mul_f32 v[96:97], v[96:97], v[16:17]
    v_pk_fma_f32 v[96:97], v[32:33], v[158:159], v[96:97] op_sel:[0,1,0] op_sel_hi:[1,1,1]
    v_pk_mul_f32 v[98:99], v[98:99], v[18:19]
    v_pk_fma_f32 v[98:99], v[34:35], v[158:159], v[98:99] op_sel:[0,1,0] op_sel_hi:[1,1,1]
    v_pk_mul_f32 v[100:101], v[100:101], v[20:21]
    v_pk_fma_f32 v[100:101], v[36:37], v[158:159], v[100:101] op_sel:[0,1,0] op_sel_hi:[1,1,1]
    v_pk_mul_f32 v[102:103], v[102:103], v[22:23]
    v_pk_fma_f32 v[102:103], v[38:39], v[158:159], v[102:103] op_sel:[0,1,0] op_sel_hi:[1,1,1]
    v_pk_mul_f32 v[104:105], v[104:105], v[24:25]
    v_pk_fma_f32 v[104:105], v[40:41], v[158:159], v[104:105] op_sel:[0,1,0] op_sel_hi:[1,1,1]
    v_pk_mul_f32 v[106:107], v[106:107], v[26:27]
    v_pk_fma_f32 v[106:107], v[42:43], v[158:159], v[106:107] op_sel:[0,1,0] op_sel_hi:[1,1,1]
    v_pk_mul_f32 v[108:109], v[108:109], v[28:29]
    v_pk_fma_f32 v[108:109], v[44:45], v[158:159], v[108:109] op_sel:[0,1,0] op_sel_hi:[1,1,1]
    v_pk_mul_f32 v[110:111], v[110:111], v[30:31]
    v_pk_fma_f32 v[110:111], v[46:47], v[158:159], v[110:111] op_sel:[0,1,0] op_sel_hi:[1,1,1]
    v_cvt_pk_bf16_f32 v96, v96, v97
    v_cvt_pk_bf16_f32 v97, v98, v99
    v_cvt_pk_bf16_f32 v98, v100, v101
    v_cvt_pk_bf16_f32 v99, v102, v103
    buffer_store_dwordx4 v[96:99], v161, s[36:39], s7 offen offset:0 sc1
    v_cvt_pk_bf16_f32 v104, v104, v105
    v_cvt_pk_bf16_f32 v105, v106, v107
    v_cvt_pk_bf16_f32 v106, v108, v109
    v_cvt_pk_bf16_f32 v107, v110, v111
    buffer_store_dwordx4 v[104:107], v161, s[36:39], s7 offen offset:640 sc1
    s_waitcnt lgkmcnt(0)
    v_pk_mul_f32 v[112:113], v[112:113], v[48:49]
    v_pk_fma_f32 v[112:113], v[64:65], v[158:159], v[112:113] op_sel:[0,0,0] op_sel_hi:[1,0,1]
    v_pk_mul_f32 v[114:115], v[114:115], v[50:51]
    v_pk_fma_f32 v[114:115], v[66:67], v[158:159], v[114:115] op_sel:[0,0,0] op_sel_hi:[1,0,1]
    v_pk_mul_f32 v[116:117], v[116:117], v[52:53]
    v_pk_fma_f32 v[116:117], v[68:69], v[158:159], v[116:117] op_sel:[0,0,0] op_sel_hi:[1,0,1]
    v_pk_mul_f32 v[118:119], v[118:119], v[54:55]
    v_pk_fma_f32 v[118:119], v[70:71], v[158:159], v[118:119] op_sel:[0,0,0] op_sel_hi:[1,0,1]
    v_pk_mul_f32 v[120:121], v[120:121], v[56:57]
    v_pk_fma_f32 v[120:121], v[72:73], v[158:159], v[120:121] op_sel:[0,0,0] op_sel_hi:[1,0,1]
    v_pk_mul_f32 v[122:123], v[122:123], v[58:59]
    v_pk_fma_f32 v[122:123], v[74:75], v[158:159], v[122:123] op_sel:[0,0,0] op_sel_hi:[1,0,1]
    v_pk_mul_f32 v[124:125], v[124:125], v[60:61]
    v_pk_fma_f32 v[124:125], v[76:77], v[158:159], v[124:125] op_sel:[0,0,0] op_sel_hi:[1,0,1]
    v_pk_mul_f32 v[126:127], v[126:127], v[62:63]
    v_pk_fma_f32 v[126:127], v[78:79], v[158:159], v[126:127] op_sel:[0,0,0] op_sel_hi:[1,0,1]
    v_cvt_pk_bf16_f32 v112, v112, v113
    v_cvt_pk_bf16_f32 v113, v114, v115
    v_cvt_pk_bf16_f32 v114, v116, v117
    v_cvt_pk_bf16_f32 v115, v118, v119
    buffer_store_dwordx4 v[112:115], v160, s[36:39], s8 offen offset:0 sc1
    v_cvt_pk_bf16_f32 v120, v120, v121
    v_cvt_pk_bf16_f32 v121, v122, v123
    v_cvt_pk_bf16_f32 v122, v124, v125
    v_cvt_pk_bf16_f32 v123, v126, v127
    buffer_store_dwordx4 v[120:123], v160, s[36:39], s8 offen offset:640 sc1
    v_pk_mul_f32 v[128:129], v[128:129], v[48:49]
    v_pk_fma_f32 v[128:129], v[64:65], v[158:159], v[128:129] op_sel:[0,1,0] op_sel_hi:[1,1,1]
    v_pk_mul_f32 v[130:131], v[130:131], v[50:51]
    v_pk_fma_f32 v[130:131], v[66:67], v[158:159], v[130:131] op_sel:[0,1,0] op_sel_hi:[1,1,1]
    v_pk_mul_f32 v[132:133], v[132:133], v[52:53]
    v_pk_fma_f32 v[132:133], v[68:69], v[158:159], v[132:133] op_sel:[0,1,0] op_sel_hi:[1,1,1]
    v_pk_mul_f32 v[134:135], v[134:135], v[54:55]
    v_pk_fma_f32 v[134:135], v[70:71], v[158:159], v[134:135] op_sel:[0,1,0] op_sel_hi:[1,1,1]
    v_pk_mul_f32 v[136:137], v[136:137], v[56:57]
    v_pk_fma_f32 v[136:137], v[72:73], v[158:159], v[136:137] op_sel:[0,1,0] op_sel_hi:[1,1,1]
    v_pk_mul_f32 v[138:139], v[138:139], v[58:59]
    v_pk_fma_f32 v[138:139], v[74:75], v[158:159], v[138:139] op_sel:[0,1,0] op_sel_hi:[1,1,1]
    v_pk_mul_f32 v[140:141], v[140:141], v[60:61]
    v_pk_fma_f32 v[140:141], v[76:77], v[158:159], v[140:141] op_sel:[0,1,0] op_sel_hi:[1,1,1]
    v_pk_mul_f32 v[142:143], v[142:143], v[62:63]
    v_pk_fma_f32 v[142:143], v[78:79], v[158:159], v[142:143] op_sel:[0,1,0] op_sel_hi:[1,1,1]
    v_cvt_pk_bf16_f32 v128, v128, v129
    v_cvt_pk_bf16_f32 v129, v130, v131
    v_cvt_pk_bf16_f32 v130, v132, v133
    v_cvt_pk_bf16_f32 v131, v134, v135
    buffer_store_dwordx4 v[128:131], v161, s[36:39], s8 offen offset:0 sc1
    v_cvt_pk_bf16_f32 v136, v136, v137
    v_cvt_pk_bf16_f32 v137, v138, v139
    v_cvt_pk_bf16_f32 v138, v140, v141
    v_cvt_pk_bf16_f32 v139, v142, v143
    buffer_store_dwordx4 v[136:139], v161, s[36:39], s8 offen offset:640 sc1
    s_branch L_p1_done
L_p1_nulljob:
    s_mov_b32 s44, s12
    s_mov_b32 s45, s13
    s_mov_b32 s46, 0x21c000
    s_mov_b32 s47, 0x20000
    s_lshl_b32 s56, s3, 6
    v_add_u32 v16, s56, v1
    v_mul_u32_u24 v17, 19419, v16
    v_lshrrev_b32 v17, 20, v17
    v_mul_u32_u24 v18, 54, v17
    v_sub_u32 v18, v16, v18
    v_mul_u32_u24 v19, 3456, v17
    v_lshl_add_u32 v19, v18, 2, v19
    s_mul_i32 s56, s49, 216
    v_add_u32 v19, s56, v19
    v_cmp_gt_u32 vcc, 9, v17
    v_mov_b32 v20, 0x7f000000
    s_nop 0
    v_cndmask_b32 v19, v20, v19, vcc
    v_mov_b32 v22, 0
    v_mov_b32 v23, 0
    s_mov_b32 s57, 0
L_nj_loop:
    s_add_u32 s58, s57, 0
    buffer_load_dword v24, v19, s[44:47], s58 offen
    s_add_u32 s58, s57, 31104
    buffer_load_dword v25, v19, s[44:47], s58 offen
    s_add_u32 s58, s57, 62208
    buffer_load_dword v26, v19, s[44:47], s58 offen
    s_add_u32 s58, s57, 93312
    buffer_load_dword v27, v19, s[44:47], s58 offen
    s_add_u32 s58, s57, 124416
    buffer_load_dword v28, v19, s[44:47], s58 offen
    s_add_u32 s58, s57, 155520
    buffer_load_dword v29, v19, s[44:47], s58 offen
    s_add_u32 s58, s57, 186624
    buffer_load_dword v30, v19, s[44:47], s58 offen
    s_add_u32 s58, s57, 217728
    buffer_load_dword v31, v19, s[44:47], s58 offen
    s_add_u32 s58, s57, 248832
    buffer_load_dword v32, v19, s[44:47], s58 offen
    s_add_u32 s58, s57, 279936
    buffer_load_dword v33, v19, s[44:47], s58 offen
    s_add_u32 s58, s57, 311040
    buffer_load_dword v34, v19, s[44:47], s58 offen
    s_add_u32 s58, s57, 342144
    buffer_load_dword v35, v19, s[44:47], s58 offen
    s_add_u32 s58, s57, 373248
    buffer_load_dword v36, v19, s[44:47], s58 offen
    s_add_u32 s58, s57, 404352
    buffer_load_dword v37, v19, s[44:47], s58 offen
    s_add_u32 s58, s57, 435456
    buffer_load_dword v38, v19, s[44:47], s58 offen
    s_add_u32 s58, s57, 466560
    buffer_load_dword v39, v19, s[44:47], s58 offen
    s_add_u32 s58, s57, 497664
    buffer_load_dword v40, v19, s[44:47], s58 offen
    s_add_u32 s58, s57, 528768
    buffer_load_dword v41, v19, s[44:47], s58 offen
    s_add_u32 s58, s57, 559872
    buffer_load_dword v42, v19, s[44:47], s58 offen
    s_add_u32 s58, s57, 590976
    buffer_load_dword v43, v19, s[44:47], s58 offen
    s_add_u32 s58, s57, 622080
    buffer_load_dword v44, v19, s[44:47], s58 offen
    s_add_u32 s58, s57, 653184
    buffer_load_dword v45, v19, s[44:47], s58 offen
    s_add_u32 s58, s57, 684288
    buffer_load_dword v46, v19, s[44:47], s58 offen
    s_add_u32 s58, s57, 715392
    buffer_load_dword v47, v19, s[44:47], s58 offen
    s_waitcnt vmcnt(23)
    v_lshlrev_b32 v48, 16, v24
    v_and_b32 v49, 0xffff0000, v24
    v_add_f32 v22, v22, v48
    v_add_f32 v23, v23, v49
    s_waitcnt vmcnt(22)
    v_lshlrev_b32 v48, 16, v25
    v_and_b32 v49, 0xffff0000, v25
    v_add_f32 v22, v22, v48
    v_add_f32 v23, v23, v49
    s_waitcnt vmcnt(21)
    v_lshlrev_b32 v48, 16, v26
    v_and_b32 v49, 0xffff0000, v26
    v_add_f32 v22, v22, v48
    v_add_f32 v23, v23, v49
    s_waitcnt vmcnt(20)
    v_lshlrev_b32 v48, 16, v27
    v_and_b32 v49, 0xffff0000, v27
    v_add_f32 v22, v22, v48
    v_add_f32 v23, v23, v49
    s_waitcnt vmcnt(19)
    v_lshlrev_b32 v48, 16, v28
    v_and_b32 v49, 0xffff0000, v28
    v_add_f32 v22, v22, v48
    v_add_f32 v23, v23, v49
    s_waitcnt vmcnt(18)
    v_lshlrev_b32 v48, 16, v29
    v_and_b32 v49, 0xffff0000, v29
    v_add_f32 v22, v22, v48
    v_add_f32 v23, v23, v49
    s_waitcnt vmcnt(17)
    v_lshlrev_b32 v48, 16, v30
    v_and_b32 v49, 0xffff0000, v30
    v_add_f32 v22, v22, v48
    v_add_f32 v23, v23, v49
    s_waitcnt vmcnt(16)
    v_lshlrev_b32 v48, 16, v31
    v_and_b32 v49, 0xffff0000, v31
    v_add_f32 v22, v22, v48
    v_add_f32 v23, v23, v49
    s_waitcnt vmcnt(15)
    v_lshlrev_b32 v48, 16, v32
    v_and_b32 v49, 0xffff0000, v32
    v_add_f32 v22, v22, v48
    v_add_f32 v23, v23, v49
    s_waitcnt vmcnt(14)
    v_lshlrev_b32 v48, 16, v33
    v_and_b32 v49, 0xffff0000, v33
    v_add_f32 v22, v22, v48
    v_add_f32 v23, v23, v49
    s_waitcnt vmcnt(13)
    v_lshlrev_b32 v48, 16, v34
    v_and_b32 v49, 0xffff0000, v34
    v_add_f32 v22, v22, v48
    v_add_f32 v23, v23, v49
    s_waitcnt vmcnt(12)
    v_lshlrev_b32 v48, 16, v35
    v_and_b32 v49, 0xffff0000, v35
    v_add_f32 v22, v22, v48
    v_add_f32 v23, v23, v49
    s_waitcnt vmcnt(11)
    v_lshlrev_b32 v48, 16, v36
    v_and_b32 v49, 0xffff0000, v36
    v_add_f32 v22, v22, v48
    v_add_f32 v23, v23, v49
    s_waitcnt vmcnt(10)
    v_lshlrev_b32 v48, 16, v37
    v_and_b32 v49, 0xffff0000, v37
    v_add_f32 v22, v22, v48
    v_add_f32 v23, v23, v49
    s_waitcnt vmcnt(9)
    v_lshlrev_b32 v48, 16, v38
    v_and_b32 v49, 0xffff0000, v38
    v_add_f32 v22, v22, v48
    v_add_f32 v23, v23, v49
    s_waitcnt vmcnt(8)
    v_lshlrev_b32 v48, 16, v39
    v_and_b32 v49, 0xffff0000, v39
    v_add_f32 v22, v22, v48
    v_add_f32 v23, v23, v49
    s_waitcnt vmcnt(7)
    v_lshlrev_b32 v48, 16, v40
    v_and_b32 v49, 0xffff0000, v40
    v_add_f32 v22, v22, v48
    v_add_f32 v23, v23, v49
    s_waitcnt vmcnt(6)
    v_lshlrev_b32 v48, 16, v41
    v_and_b32 v49, 0xffff0000, v41
    v_add_f32 v22, v22, v48
    v_add_f32 v23, v23, v49
    s_waitcnt vmcnt(5)
    v_lshlrev_b32 v48, 16, v42
    v_and_b32 v49, 0xffff0000, v42
    v_add_f32 v22, v22, v48
    v_add_f32 v23, v23, v49
    s_waitcnt vmcnt(4)
    v_lshlrev_b32 v48, 16, v43
    v_and_b32 v49, 0xffff0000, v43
    v_add_f32 v22, v22, v48
    v_add_f32 v23, v23, v49
    s_waitcnt vmcnt(3)
    v_lshlrev_b32 v48, 16, v44
    v_and_b32 v49, 0xffff0000, v44
    v_add_f32 v22, v22, v48
    v_add_f32 v23, v23, v49
    s_waitcnt vmcnt(2)
    v_lshlrev_b32 v48, 16, v45
    v_and_b32 v49, 0xffff0000, v45
    v_add_f32 v22, v22, v48
    v_add_f32 v23, v23, v49
    s_waitcnt vmcnt(1)
    v_lshlrev_b32 v48, 16, v46
    v_and_b32 v49, 0xffff0000, v46
    v_add_f32 v22, v22, v48
    v_add_f32 v23, v23, v49
    s_waitcnt vmcnt(0)
    v_lshlrev_b32 v48, 16, v47
    v_and_b32 v49, 0xffff0000, v47
    v_add_f32 v22, v22, v48
    v_add_f32 v23, v23, v49
    s_add_u32 s57, s57, 746496
    s_cmp_lt_u32 s57, 2239488
    s_cbranch_scc1 L_nj_loop
    v_lshlrev_b32 v20, 3, v16
    ds_write_b64 v20, v[22:23]
    s_waitcnt lgkmcnt(0)
    s_barrier
    s_cmp_lg_u32 s3, 0
    s_cbranch_scc1 L_nj_done
    v_lshlrev_b32 v20, 3, v1
    ds_read_b64 v[24:25], v20 offset:0
    ds_read_b64 v[26:27], v20 offset:432
    ds_read_b64 v[28:29], v20 offset:864
    ds_read_b64 v[30:31], v20 offset:1296
    ds_read_b64 v[32:33], v20 offset:1728
    ds_read_b64 v[34:35], v20 offset:2160
    ds_read_b64 v[36:37], v20 offset:2592
    ds_read_b64 v[38:39], v20 offset:3024
    ds_read_b64 v[40:41], v20 offset:3456
    s_waitcnt lgkmcnt(0)
    v_add_f32 v24, v24, v26
    v_add_f32 v25, v25, v27
    v_add_f32 v24, v24, v28
    v_add_f32 v25, v25, v29
    v_add_f32 v24, v24, v30
    v_add_f32 v25, v25, v31
    v_add_f32 v24, v24, v32
    v_add_f32 v25, v25, v33
    v_add_f32 v24, v24, v34
    v_add_f32 v25, v25, v35
    v_add_f32 v24, v24, v36
    v_add_f32 v25, v25, v37
    v_add_f32 v24, v24, v38
    v_add_f32 v25, v25, v39
    v_add_f32 v24, v24, v40
    v_add_f32 v25, v25, v41
    s_mul_i32 s56, s49, 432
    s_add_u32 s56, s56, 0x70000
    v_add_u32 v20, s56, v20
    s_mov_b32 exec_lo, 0xffffffff
    s_mov_b32 exec_hi, 0x3fffff
    buffer_store_dwordx2 v[24:25], v20, s[40:43], 0 offen sc1
    s_mov_b64 exec, -1
L_nj_done:
L_p1_done:
    s_lshl_b32 s66, s27, 2
    s_and_b32 s56, s48, 3
    s_add_u32 s66, s66, s56
    s_lshr_b32 s67, s48, 2
    s_mul_i32 s56, s66, 163840
    s_add_u32 s56, s56, 0x400000
    s_add_u32 s28, s24, s56
    s_addc_u32 s29, s25, 0
    s_mov_b32 s30, 163840
    s_mov_b32 s31, 0x20000
    s_lshl_b32 s56, s66, 6
    s_lshl_b32 s57, s67, 3
    s_add_u32 s56, s56, s57
    s_and_b32 s57, s3, 3
    s_lshl_b32 s57, s57, 1
    s_add_u32 s56, s56, s57
    s_mul_i32 s56, s56, 1280
    s_add_u32 s56, s56, 0x100000
    s_add_u32 s32, s24, s56
    s_addc_u32 s33, s25, 0
    s_mov_b32 s34, 2560
    s_mov_b32 s35, 0x20000
    v_and_b32 v120, 31, v1
    v_lshrrev_b32 v121, 5, v1
    v_lshlrev_b32 v122, 3, v120
    v_lshl_add_u32 v124, v121, 9, v122
    v_lshlrev_b32 v123, 12, v121
    v_add_u32 v123, v123, v122
    v_lshlrev_b32 v118, 4, v1
    v_add_u32 v119, 4096, v118
    s_lshr_b32 s56, s3, 2
    s_mul_i32 s56, s56, 81920
    s_and_b32 s57, s3, 3
    s_lshl_b32 s57, s57, 10
    s_add_u32 s95, s56, s57
    v_mov_b32 v10, 0
    v_mov_b32 v11, 0
    v_mov_b32 v18, 0
    v_mov_b32 v19, 0
    v_mov_b32 v26, 0
    v_mov_b32 v27, 0
    v_mov_b32 v34, 0
    v_mov_b32 v35, 0
    v_cmp_eq_u32 vcc, 20, v120
    v_mov_b32 v125, 0x3f803f80
    v_mul_u32_u24 v126, 320, v121
    v_cndmask_b32 v36, 0, v125, vcc
    v_mov_b32 v37, v36
    v_mov_b32 v38, v36
    v_mov_b32 v39, v36
    v_mov_b32 v40, v36
    v_mov_b32 v41, v36
    v_mov_b32 v42, v36
    v_mov_b32 v43, v36
    v_mov_b32 v128, v36
    v_mov_b32 v129, v36
    v_mov_b32 v130, v36
    v_mov_b32 v131, v36
    v_lshl_add_u32 v117, v120, 4, v126
    v_add_u32 v117, 1280, v117
    v_add_u32 v116, s56, v124
    v_add_u32 v117, s56, v117
    s_mov_b32 s92, 0xfffff
    s_mov_b32 s93, 0xfffff
    v_mov_b32 v84, 0
    v_mov_b32 v100, 0
    v_mov_b32 v85, 0
    v_mov_b32 v101, 0
    v_mov_b32 v86, 0
    v_mov_b32 v102, 0
    v_mov_b32 v87, 0
    v_mov_b32 v103, 0
    v_mov_b32 v88, 0
    v_mov_b32 v104, 0
    v_mov_b32 v89, 0
    v_mov_b32 v105, 0
    v_mov_b32 v90, 0
    v_mov_b32 v106, 0
    v_mov_b32 v91, 0
    v_mov_b32 v107, 0
    v_mov_b32 v92, 0
    v_mov_b32 v108, 0
    v_mov_b32 v93, 0
    v_mov_b32 v109, 0
    v_mov_b32 v94, 0
    v_mov_b32 v110, 0
    v_mov_b32 v95, 0
    v_mov_b32 v111, 0
    v_mov_b32 v96, 0
    v_mov_b32 v112, 0
    v_mov_b32 v97, 0
    v_mov_b32 v113, 0
    v_mov_b32 v98, 0
    v_mov_b32 v114, 0
    v_mov_b32 v99, 0
    v_mov_b32 v115, 0
    v_mov_b32 v76, 0
    v_mov_b32 v77, 0
    v_mov_b32 v78, 0
    v_mov_b32 v79, 0
    v_mov_b32 v80, 0
    v_mov_b32 v81, 0
    v_mov_b32 v82, 0
    v_mov_b32 v83, 0
    v_mov_b32 v72, 0
    v_mov_b32 v73, 0
    v_mov_b32 v74, 0
    v_mov_b32 v75, 0
    s_and_b32 s58, s3, 3
    s_lshr_b32 s59, s3, 2
    s_lshl_b32 s56, s67, 2
    s_add_u32 s56, s56, s58
    s_mul_i32 s56, s56, 81920
    s_lshl_b32 s57, s59, 11
    s_add_u32 s52, s56, s57
    v_bfe_u32 v127, v1, 4, 1
    v_lshlrev_b32 v127, 10, v127
    v_and_b32 v126, 15, v1
    v_lshl_add_u32 v127, v126, 4, v127
    s_mul_i32 s57, s66, 20
    v_lshlrev_b32 v126, 2, v121
    s_add_u32 s58, s57, 0
    v_add_u32 v126, s58, v126
    v_lshrrev_b32 v140, 5, v126
    v_lshlrev_b32 v140, 12, v140
    v_bfe_u32 v125, v126, 3, 2
    v_lshl_add_u32 v140, v125, 8, v140
    v_and_b32 v125, 7, v126
    v_lshl_add_u32 v140, v125, 1, v140
    v_add_u32 v140, v140, v127
    v_lshlrev_b32 v126, 2, v121
    s_add_u32 s58, s57, 8
    v_add_u32 v126, s58, v126
    v_lshrrev_b32 v141, 5, v126
    v_lshlrev_b32 v141, 12, v141
    v_bfe_u32 v125, v126, 3, 2
    v_lshl_add_u32 v141, v125, 8, v141
    v_and_b32 v125, 7, v126
    v_lshl_add_u32 v141, v125, 1, v141
    v_add_u32 v141, v141, v127
    v_lshlrev_b32 v126, 2, v121
    s_add_u32 s58, s57, 16
    v_add_u32 v126, s58, v126
    v_lshrrev_b32 v142, 5, v126
    v_lshlrev_b32 v142, 12, v142
    v_bfe_u32 v125, v126, 3, 2
    v_lshl_add_u32 v142, v125, 8, v142
    v_and_b32 v125, 7, v126
    v_lshl_add_u32 v142, v125, 1, v142
    v_add_u32 v142, v142, v127
    s_cmp_lg_u32 s3, 0
    s_cbranch_scc1 L_p2w_skip
    s_mul_i32 s57, s66, 20
    v_bfe_u32 v168, v1, 4, 1
    v_mul_u32_u24 v168, 19, v168
    v_add_u32 v168, s57, v168
    v_lshrrev_b32 v168, 7, v168
    v_lshrrev_b32 v169, 5, v1
    v_mul_u32_u24 v169, 5, v169
    v_add_u32 v170, v168, v169
    v_add_u32 v170, 5, v170
    v_and_b32 v171, 15, v1
    v_and_b32 v172, 3, v171
    v_and_b32 v178, 7, v170
    v_lshl_add_u32 v172, v178, 2, v172
    v_lshlrev_b32 v172, 3, v172
    v_lshrrev_b32 v178, 2, v171
    v_add_u32 v172, v172, v178
    v_lshrrev_b32 v178, 3, v170
    v_lshl_add_u32 v172, v178, 2, v172
    v_bfe_u32 v168, v1, 1, 1
    v_mul_u32_u24 v168, 19, v168
    v_add_u32 v168, s57, v168
    v_lshrrev_b32 v170, 7, v168
    v_and_b32 v171, 1, v1
    s_lshl_b32 s58, s67, 1
    v_add_u32 v171, s58, v171
    v_cmp_eq_u32 vcc, 4, v1
    s_and_b32 s58, s66, 15
    v_mov_b32 v174, s58
    v_mov_b32 v175, 15
    v_cndmask_b32 v171, v171, v174, vcc
    v_cndmask_b32 v170, v170, v175, vcc
    v_and_b32 v173, 3, v171
    v_and_b32 v178, 7, v170
    v_lshl_add_u32 v173, v178, 2, v173
    v_lshlrev_b32 v173, 3, v173
    v_lshrrev_b32 v178, 2, v171
    v_add_u32 v173, v173, v178
    v_lshrrev_b32 v178, 3, v170
    v_lshl_add_u32 v173, v178, 2, v173
    s_lshl_b32 s58, s2, 10
    s_add_u32 s58, s58, 65536
    v_lshlrev_b32 v172, 2, v172
    v_add_u32 v172, s58, v172
    v_lshlrev_b32 v173, 2, v173
    v_add_u32 v173, s58, v173
L_p2w_skip:
    s_cmp_lg_u32 s3, 7
    s_cbranch_scc1 L_p1sig_skipp
    v_lshrrev_b32 v152, 3, v1
    v_and_b32 v153, 7, v1
    s_cmp_eq_u32 s50, 15
    s_cbranch_scc1 L_p1sig_null
    s_cmp_ge_u32 s50, 10
    s_cselect_b32 s56, 10, 5
    s_cmp_lt_u32 s50, 5
    s_cselect_b32 s56, 0, s56
    s_sub_u32 s56, s50, s56
    s_lshl_b32 s56, s56, 7
    s_mul_i32 s57, s56, 52429
    s_lshr_b32 s57, s57, 20
    s_add_u32 s58, s56, 127
    s_mul_i32 s58, s58, 52429
    s_lshr_b32 s58, s58, 20
    s_min_u32 s58, s58, 31
    v_add_u32 v154, s57, v152
    v_cmp_ge_u32 vcc, s58, v154
    s_mov_b64 s[90:91], vcc
    s_cmp_lt_u32 s50, 5
    s_cbranch_scc0 L_p1sig_join
    s_lshr_b32 s59, s49, 1
    v_cmp_eq_u32 vcc, s59, v153
    s_and_b64 s[90:91], s[90:91], vcc
    s_branch L_p1sig_join
L_p1sig_null:
    v_lshlrev_b32 v154, 4, v152
    v_add_u32 v154, s49, v154
    v_cmp_gt_u32 vcc, 2, v152
    s_mov_b64 s[90:91], vcc
L_p1sig_join:
    v_and_b32 v156, 3, v154
    v_lshl_add_u32 v156, v153, 2, v156
    v_lshrrev_b32 v154, 2, v154
    v_lshl_add_u32 v154, v156, 3, v154
    v_lshlrev_b32 v154, 10, v154
    s_lshl_b32 s56, s2, 2
    s_add_u32 s56, s56, 65536
    v_add_u32 v154, s56, v154
    v_mov_b32 v155, s26
    s_lshl_b32 s56, s2, 2
    s_add_u32 s56, s56, 4096
    v_mov_b32 v157, s56
    s_add_u32 s57, s26, s10
    v_mov_b32 v158, s57
L_p1sig_skipp:
    s_waitcnt vmcnt(0) lgkmcnt(0)
    s_barrier
    s_cmp_lg_u32 s3, 7
    s_cbranch_scc1 L_p1sig_skip
    s_mov_b64 exec, s[90:91]
    buffer_store_dword v155, v154, s[40:43], 0 offen sc1
    s_mov_b64 exec, 1
    buffer_store_dword v158, v157, s[40:43], 0 offen sc1
    s_mov_b64 exec, -1
L_p1sig_skip:
    s_cmp_lg_u32 s3, 0
    s_cbranch_scc1 L_p2w_skip2
    s_mov_b32 s56, 0
L_p2w_poll:
    s_mov_b64 exec, -1
    buffer_load_dword v180, v172, s[40:43], 0 offen sc1
    s_mov_b64 exec, 0x1f
    buffer_load_dword v181, v173, s[40:43], 0 offen sc1
    s_waitcnt vmcnt(0)
    s_mov_b64 s[90:91], 0
    s_mov_b64 exec, -1
    v_cmp_ne_u32 vcc, s26, v180
    s_or_b64 s[90:91], s[90:91], vcc
    s_mov_b64 exec, 0x1f
    v_cmp_ne_u32 vcc, s26, v181
    s_or_b64 s[90:91], s[90:91], vcc
    s_mov_b64 exec, -1
    s_cmp_eq_u64 s[90:91], 0
    s_cbranch_scc1 L_p2w_pollok
    s_add_u32 s56, s56, 1
    s_cmp_lt_u32 s56, 0x40000
    s_cbranch_scc1 L_p2w_poll
L_p2w_pollok:
L_p2w_skip2:
    s_barrier
    s_mov_b32 m0, s95
    s_nop 0
    buffer_load_dwordx4 v118, s[28:31], s95 offen sc1 lds
    s_add_u32 s95, s95, 4096
    s_mov_b32 m0, s95
    s_nop 0
    buffer_load_dwordx4 v118, s[28:31], s95 offen sc1 lds
    s_add_u32 s95, s95, 4096
    buffer_load_dwordx2 v[4:5], v124, s[32:35], 0 offen offset:0 sc1
    buffer_load_dwordx2 v[6:7], v124, s[32:35], 0 offen offset:256 sc1
    buffer_load_dwordx2 v[8:9], v123, s[32:35], 0 offen offset:1024 sc1
    buffer_load_dwordx2 v[12:13], v124, s[32:35], 0 offen offset:1280 sc1
    buffer_load_dwordx2 v[14:15], v124, s[32:35], 0 offen offset:1536 sc1
    buffer_load_dwordx2 v[16:17], v123, s[32:35], 0 offen offset:2304 sc1
    s_mov_b32 m0, s95
    s_nop 0
    buffer_load_dwordx4 v118, s[28:31], s95 offen sc1 lds
    s_add_u32 s95, s95, 4096
    s_mov_b32 m0, s95
    s_nop 0
    buffer_load_dwordx4 v118, s[28:31], s95 offen sc1 lds
    s_add_u32 s95, s95, 4096
    buffer_load_dwordx4 v[132:135], v119, s[40:43], 0 offen sc1
    s_mov_b32 m0, s95
    s_nop 0
    buffer_load_dwordx4 v118, s[28:31], s95 offen sc1 lds
    s_add_u32 s95, s95, 4096
    s_mov_b32 m0, s95
    s_nop 0
    buffer_load_dwordx4 v118, s[28:31], s95 offen sc1 lds
    s_add_u32 s95, s95, 4096
    s_mov_b32 m0, s95
    s_nop 0
    buffer_load_dwordx4 v118, s[28:31], s95 offen sc1 lds
    s_add_u32 s95, s95, 4096
    s_mov_b32 m0, s95
    s_nop 0
    buffer_load_dwordx4 v118, s[28:31], s95 offen sc1 lds
    s_add_u32 s95, s95, 4096
    s_waitcnt vmcnt(5)
    s_barrier
    s_mov_b32 m0, s95
    s_nop 0
    buffer_load_dwordx4 v118, s[28:31], s95 offen sc1 lds
    s_add_u32 s95, s95, 4096
    ds_read_b64 v[20:21], v116 offset:0
    ds_read_b64 v[22:23], v116 offset:256
    ds_read_b64 v[24:25], v116 offset:1024
    ds_read_b64 v[28:29], v116 offset:2560
    ds_read_b64 v[30:31], v116 offset:2816
    ds_read_b64 v[32:33], v116 offset:3584
    s_mov_b64 exec, s[92:93]
    ds_read_b128 v[36:39], v117 offset:0
    s_mov_b64 exec, -1
    s_mov_b64 exec, s[92:93]
    ds_read_b128 v[40:43], v117 offset:640
    s_mov_b64 exec, -1
    s_waitcnt lgkmcnt(0)
    v_mfma_f32_32x32x16_bf16 v[44:59], v[20:23], v[4:7], 0
    v_mfma_f32_32x32x8bf16_1k v[44:59], v[24:25], v[8:9], v[44:59]
    s_setprio 1
    s_cmp_ge_u32 s3, 4
    s_cbranch_scc1 L_p2_prinit
    s_setprio 2
L_p2_prinit:
    s_nop 7
    s_nop 3
    v_exp_f32 v44, v44
    v_cvt_pk_bf16_f32 v82, v72, v73
    v_exp_f32 v45, v45
    v_exp_f32 v46, v46
    v_cvt_pk_bf16_f32 v83, v74, v75
    v_exp_f32 v47, v47
    v_mfma_f32_32x32x16_bf16 v[60:75], v[20:23], v[12:15], 0
    v_exp_f32 v48, v48
    v_cvt_pk_bf16_f32 v76, v44, v45
    v_exp_f32 v49, v49
    v_exp_f32 v50, v50
    v_cvt_pk_bf16_f32 v77, v46, v47
    v_exp_f32 v51, v51
    v_mfma_f32_32x32x8bf16_1k v[60:75], v[24:25], v[16:17], v[60:75]
    v_exp_f32 v52, v52
    v_cvt_pk_bf16_f32 v78, v48, v49
    v_exp_f32 v53, v53
    v_exp_f32 v54, v54
    v_cvt_pk_bf16_f32 v79, v50, v51
    v_exp_f32 v55, v55
    v_mfma_f32_32x32x16_bf16 v[100:115], v[128:131], v[80:83], v[100:115]
    v_exp_f32 v56, v56
    v_cvt_pk_bf16_f32 v80, v52, v53
    v_exp_f32 v57, v57
    v_exp_f32 v58, v58
    v_cvt_pk_bf16_f32 v81, v54, v55
    v_exp_f32 v59, v59
    s_waitcnt lgkmcnt(0)
    v_mfma_f32_32x32x16_bf16 v[84:99], v[36:39], v[76:79], v[84:99]
    v_exp_f32 v60, v60
    v_cvt_pk_bf16_f32 v82, v56, v57
    v_exp_f32 v61, v61
    v_exp_f32 v62, v62
    v_cvt_pk_bf16_f32 v83, v58, v59
    v_exp_f32 v63, v63
    v_mfma_f32_32x32x16_bf16 v[44:59], v[28:31], v[4:7], 0
    ds_read_b64 v[20:21], v116 offset:5120
    v_exp_f32 v64, v64
    v_cvt_pk_bf16_f32 v76, v60, v61
    v_exp_f32 v65, v65
    v_exp_f32 v66, v66
    v_cvt_pk_bf16_f32 v77, v62, v63
    v_exp_f32 v67, v67
    v_mfma_f32_32x32x8bf16_1k v[44:59], v[32:33], v[8:9], v[44:59]
    ds_read_b64 v[22:23], v116 offset:5376
    v_exp_f32 v68, v68
    v_cvt_pk_bf16_f32 v78, v64, v65
    v_exp_f32 v69, v69
    v_exp_f32 v70, v70
    v_cvt_pk_bf16_f32 v79, v66, v67
    v_exp_f32 v71, v71
    v_mfma_f32_32x32x16_bf16 v[84:99], v[40:43], v[80:83], v[84:99]
    ds_read_b64 v[24:25], v116 offset:6144
    v_exp_f32 v72, v72
    v_cvt_pk_bf16_f32 v80, v68, v69
    v_exp_f32 v73, v73
    v_exp_f32 v74, v74
    v_cvt_pk_bf16_f32 v81, v70, v71
    v_exp_f32 v75, v75
    v_mfma_f32_32x32x16_bf16 v[100:115], v[36:39], v[76:79], v[100:115]
    s_mov_b64 exec, s[92:93]
    ds_read_b128 v[36:39], v117 offset:2560
    ds_read_b128 v[128:131], v117 offset:3200
    s_mov_b64 exec, -1
    v_exp_f32 v44, v44
    v_cvt_pk_bf16_f32 v82, v72, v73
    v_exp_f32 v45, v45
    v_exp_f32 v46, v46
    v_cvt_pk_bf16_f32 v83, v74, v75
    v_exp_f32 v47, v47
    v_mfma_f32_32x32x16_bf16 v[60:75], v[28:31], v[12:15], 0
    v_exp_f32 v48, v48
    v_cvt_pk_bf16_f32 v76, v44, v45
    v_exp_f32 v49, v49
    v_exp_f32 v50, v50
    v_cvt_pk_bf16_f32 v77, v46, v47
    v_exp_f32 v51, v51
    v_mfma_f32_32x32x8bf16_1k v[60:75], v[32:33], v[16:17], v[60:75]
    v_exp_f32 v52, v52
    v_cvt_pk_bf16_f32 v78, v48, v49
    v_exp_f32 v53, v53
    v_exp_f32 v54, v54
    v_cvt_pk_bf16_f32 v79, v50, v51
    v_exp_f32 v55, v55
    v_mfma_f32_32x32x16_bf16 v[100:115], v[40:43], v[80:83], v[100:115]
    v_exp_f32 v56, v56
    v_cvt_pk_bf16_f32 v80, v52, v53
    v_exp_f32 v57, v57
    v_exp_f32 v58, v58
    v_cvt_pk_bf16_f32 v81, v54, v55
    v_exp_f32 v59, v59
    s_waitcnt lgkmcnt(0)
    v_mfma_f32_32x32x16_bf16 v[84:99], v[36:39], v[76:79], v[84:99]
    v_exp_f32 v60, v60
    v_cvt_pk_bf16_f32 v82, v56, v57
    v_exp_f32 v61, v61
    v_exp_f32 v62, v62
    v_cvt_pk_bf16_f32 v83, v58, v59
    v_exp_f32 v63, v63
    v_mfma_f32_32x32x16_bf16 v[44:59], v[20:23], v[4:7], 0
    ds_read_b64 v[28:29], v116 offset:7680
    v_exp_f32 v64, v64
    v_cvt_pk_bf16_f32 v76, v60, v61
    v_exp_f32 v65, v65
    v_exp_f32 v66, v66
    v_cvt_pk_bf16_f32 v77, v62, v63
    v_exp_f32 v67, v67
    v_mfma_f32_32x32x8bf16_1k v[44:59], v[24:25], v[8:9], v[44:59]
    ds_read_b64 v[30:31], v116 offset:7936
    v_exp_f32 v68, v68
    v_cvt_pk_bf16_f32 v78, v64, v65
    v_exp_f32 v69, v69
    v_exp_f32 v70, v70
    v_cvt_pk_bf16_f32 v79, v66, v67
    v_exp_f32 v71, v71
    v_mfma_f32_32x32x16_bf16 v[84:99], v[128:131], v[80:83], v[84:99]
    ds_read_b64 v[32:33], v116 offset:8704
    v_exp_f32 v72, v72
    v_cvt_pk_bf16_f32 v80, v68, v69
    v_exp_f32 v73, v73
    v_exp_f32 v74, v74
    v_cvt_pk_bf16_f32 v81, v70, v71
    v_exp_f32 v75, v75
    v_mfma_f32_32x32x16_bf16 v[100:115], v[36:39], v[76:79], v[100:115]
    s_mov_b64 exec, s[92:93]
    ds_read_b128 v[36:39], v117 offset:5120
    ds_read_b128 v[40:43], v117 offset:5760
    s_mov_b64 exec, -1
    v_exp_f32 v44, v44
    v_cvt_pk_bf16_f32 v82, v72, v73
    v_exp_f32 v45, v45
    v_exp_f32 v46, v46
    v_cvt_pk_bf16_f32 v83, v74, v75
    v_exp_f32 v47, v47
    v_mfma_f32_32x32x16_bf16 v[60:75], v[20:23], v[12:15], 0
    v_exp_f32 v48, v48
    v_cvt_pk_bf16_f32 v76, v44, v45
    v_exp_f32 v49, v49
    v_exp_f32 v50, v50
    v_cvt_pk_bf16_f32 v77, v46, v47
    v_exp_f32 v51, v51
    v_mfma_f32_32x32x8bf16_1k v[60:75], v[24:25], v[16:17], v[60:75]
    v_exp_f32 v52, v52
    v_cvt_pk_bf16_f32 v78, v48, v49
    v_exp_f32 v53, v53
    v_exp_f32 v54, v54
    v_cvt_pk_bf16_f32 v79, v50, v51
    v_exp_f32 v55, v55
    v_mfma_f32_32x32x16_bf16 v[100:115], v[128:131], v[80:83], v[100:115]
    v_exp_f32 v56, v56
    v_cvt_pk_bf16_f32 v80, v52, v53
    v_exp_f32 v57, v57
    v_exp_f32 v58, v58
    v_cvt_pk_bf16_f32 v81, v54, v55
    v_exp_f32 v59, v59
    s_waitcnt lgkmcnt(0)
    v_mfma_f32_32x32x16_bf16 v[84:99], v[36:39], v[76:79], v[84:99]
    v_exp_f32 v60, v60
    v_cvt_pk_bf16_f32 v82, v56, v57
    v_exp_f32 v61, v61
    v_exp_f32 v62, v62
    v_cvt_pk_bf16_f32 v83, v58, v59
    v_exp_f32 v63, v63
    v_mfma_f32_32x32x16_bf16 v[44:59], v[28:31], v[4:7], 0
    ds_read_b64 v[20:21], v116 offset:10240
    v_exp_f32 v64, v64
    v_cvt_pk_bf16_f32 v76, v60, v61
    v_exp_f32 v65, v65
    v_exp_f32 v66, v66
    v_cvt_pk_bf16_f32 v77, v62, v63
    v_exp_f32 v67, v67
    v_mfma_f32_32x32x8bf16_1k v[44:59], v[32:33], v[8:9], v[44:59]
    ds_read_b64 v[22:23], v116 offset:10496
    v_exp_f32 v68, v68
    v_cvt_pk_bf16_f32 v78, v64, v65
    v_exp_f32 v69, v69
    v_exp_f32 v70, v70
    v_cvt_pk_bf16_f32 v79, v66, v67
    v_exp_f32 v71, v71
    v_mfma_f32_32x32x16_bf16 v[84:99], v[40:43], v[80:83], v[84:99]
    ds_read_b64 v[24:25], v116 offset:11264
    v_exp_f32 v72, v72
    v_cvt_pk_bf16_f32 v80, v68, v69
    v_exp_f32 v73, v73
    v_exp_f32 v74, v74
    v_cvt_pk_bf16_f32 v81, v70, v71
    v_exp_f32 v75, v75
    v_mfma_f32_32x32x16_bf16 v[100:115], v[36:39], v[76:79], v[100:115]
    s_mov_b64 exec, s[92:93]
    ds_read_b128 v[36:39], v117 offset:7680
    ds_read_b128 v[128:131], v117 offset:8320
    s_mov_b64 exec, -1
    s_cmp_ge_u32 s3, 4
    s_cbranch_scc1 L_p2_prl3
    s_setprio 0
L_p2_prl3:
    v_exp_f32 v44, v44
    v_cvt_pk_bf16_f32 v82, v72, v73
    v_exp_f32 v45, v45
    v_exp_f32 v46, v46
    v_cvt_pk_bf16_f32 v83, v74, v75
    v_exp_f32 v47, v47
    v_mfma_f32_32x32x16_bf16 v[60:75], v[28:31], v[12:15], 0
    v_exp_f32 v48, v48
    v_cvt_pk_bf16_f32 v76, v44, v45
    v_exp_f32 v49, v49
    v_exp_f32 v50, v50
    v_cvt_pk_bf16_f32 v77, v46, v47
    v_exp_f32 v51, v51
    v_mfma_f32_32x32x8bf16_1k v[60:75], v[32:33], v[16:17], v[60:75]
    v_exp_f32 v52, v52
    v_cvt_pk_bf16_f32 v78, v48, v49
    v_exp_f32 v53, v53
    v_exp_f32 v54, v54
    v_cvt_pk_bf16_f32 v79, v50, v51
    v_exp_f32 v55, v55
    v_mfma_f32_32x32x16_bf16 v[100:115], v[40:43], v[80:83], v[100:115]
    v_exp_f32 v56, v56
    v_cvt_pk_bf16_f32 v80, v52, v53
    v_exp_f32 v57, v57
    v_exp_f32 v58, v58
    v_cvt_pk_bf16_f32 v81, v54, v55
    v_exp_f32 v59, v59
    s_waitcnt lgkmcnt(0)
    v_mfma_f32_32x32x16_bf16 v[84:99], v[36:39], v[76:79], v[84:99]
    v_exp_f32 v60, v60
    v_cvt_pk_bf16_f32 v82, v56, v57
    v_exp_f32 v61, v61
    v_exp_f32 v62, v62
    v_cvt_pk_bf16_f32 v83, v58, v59
    v_exp_f32 v63, v63
    v_mfma_f32_32x32x16_bf16 v[44:59], v[20:23], v[4:7], 0
    ds_read_b64 v[28:29], v116 offset:12800
    v_exp_f32 v64, v64
    v_cvt_pk_bf16_f32 v76, v60, v61
    v_exp_f32 v65, v65
    v_exp_f32 v66, v66
    v_cvt_pk_bf16_f32 v77, v62, v63
    v_exp_f32 v67, v67
    v_mfma_f32_32x32x8bf16_1k v[44:59], v[24:25], v[8:9], v[44:59]
    ds_read_b64 v[30:31], v116 offset:13056
    v_exp_f32 v68, v68
    v_cvt_pk_bf16_f32 v78, v64, v65
    v_exp_f32 v69, v69
    v_exp_f32 v70, v70
    v_cvt_pk_bf16_f32 v79, v66, v67
    v_exp_f32 v71, v71
    v_mfma_f32_32x32x16_bf16 v[84:99], v[128:131], v[80:83], v[84:99]
    ds_read_b64 v[32:33], v116 offset:13824
    v_exp_f32 v72, v72
    v_cvt_pk_bf16_f32 v80, v68, v69
    v_exp_f32 v73, v73
    v_exp_f32 v74, v74
    v_cvt_pk_bf16_f32 v81, v70, v71
    v_exp_f32 v75, v75
    v_mfma_f32_32x32x16_bf16 v[100:115], v[36:39], v[76:79], v[100:115]
    s_mov_b64 exec, s[92:93]
    ds_read_b128 v[36:39], v117 offset:10240
    ds_read_b128 v[40:43], v117 offset:10880
    s_mov_b64 exec, -1
    s_waitcnt vmcnt(0)
    s_mov_b32 s56, 0
L_p2_all:
    v_subrev_u32 v120, s26, v132
    v_subrev_u32 v121, s26, v133
    v_subrev_u32 v122, s26, v134
    v_subrev_u32 v123, s26, v135
    v_cmp_le_u32 vcc, 16, v120
    v_cmp_le_u32 s[90:91], 16, v121
    s_nop 0
    s_or_b64 vcc, vcc, s[90:91]
    v_cmp_le_u32 s[90:91], 16, v122
    s_nop 0
    s_or_b64 vcc, vcc, s[90:91]
    v_cmp_le_u32 s[90:91], 16, v123
    s_nop 0
    s_or_b64 vcc, vcc, s[90:91]
    s_cbranch_vccz L_p2_allok
    s_add_u32 s56, s56, 1
    s_cmp_ge_u32 s56, 0x40000
    s_cbranch_scc1 L_p2_allok
    buffer_load_dwordx4 v[132:135], v119, s[40:43], 0 offen sc1
    s_waitcnt vmcnt(0)
    s_branch L_p2_all
L_p2_allok:
    s_and_b32 s57, s27, 3
    s_cmp_eq_u32 s57, 1
    s_cselect_b64 s[90:91], -1, 0
    v_cndmask_b32 v120, v120, v121, s[90:91]
    s_cmp_eq_u32 s57, 2
    s_cselect_b64 s[90:91], -1, 0
    v_cndmask_b32 v120, v120, v122, s[90:91]
    s_cmp_eq_u32 s57, 3
    s_cselect_b64 s[90:91], -1, 0
    v_cndmask_b32 v120, v120, v123, s[90:91]
    v_cmp_ne_u32 vcc, s10, v120
    s_mov_b32 s58, 0x55555555
    s_lshr_b32 s57, s27, 2
    s_lshl_b32 s58, s58, s57
    s_and_b32 s59, vcc_lo, s58
    s_and_b32 s60, vcc_hi, s58
    s_or_b32 s59, s59, s60
    s_cmp_eq_u32 s59, 0
    s_cselect_b32 s11, 1, 0
    s_add_u32 s32, s24, 0x1800000
    s_addc_u32 s33, s25, 0
    s_mov_b32 s34, 0x21c000
    s_mov_b32 s35, 0x20000
    s_and_b32 s56, s3, 3
    s_mul_i32 s57, s56, 40
    s_and_b32 s58, s48, 7
    s_mul_i32 s58, s58, 5
    s_add_u32 s57, s57, s58
    s_cmp_lt_u32 s3, 4
    s_cselect_b32 s58, 3, 0
    s_add_u32 s57, s57, s58
    s_lshl_b32 s55, s57, 10
    v_lshlrev_b32 v119, 4, v1
    s_cmp_lt_u32 s3, 4
    s_mov_b32 s6, 161792
    s_cselect_b32 s6, 1024, s6
    s_mov_b32 s7, 1024
    s_cselect_b32 s7, 162816, s7
    s_mov_b32 s8, 1024
    s_mov_b32 s9, 161792
    s_cselect_b32 s9, 162816, s9
    s_mov_b32 s16, 1024
    s_mov_b32 s17, 1024
    s_cselect_b32 s17, 162816, s17
    s_cselect_b32 s56, 0, 657408
    s_add_u32 s55, s55, s56
    s_barrier
    s_cmp_ge_u32 s3, 4
    s_cbranch_scc1 L_p2_prh4
    s_setprio 2
L_p2_prh4:
    v_exp_f32 v44, v44
    v_cvt_pk_bf16_f32 v82, v72, v73
    v_exp_f32 v45, v45
    v_exp_f32 v46, v46
    v_cvt_pk_bf16_f32 v83, v74, v75
    v_exp_f32 v47, v47
    v_mfma_f32_32x32x16_bf16 v[60:75], v[20:23], v[12:15], 0
    v_exp_f32 v48, v48
    v_cvt_pk_bf16_f32 v76, v44, v45
    v_exp_f32 v49, v49
    v_exp_f32 v50, v50
    v_cvt_pk_bf16_f32 v77, v46, v47
    v_exp_f32 v51, v51
    v_mfma_f32_32x32x8bf16_1k v[60:75], v[24:25], v[16:17], v[60:75]
    v_exp_f32 v52, v52
    v_cvt_pk_bf16_f32 v78, v48, v49
    v_exp_f32 v53, v53
    v_exp_f32 v54, v54
    v_cvt_pk_bf16_f32 v79, v50, v51
    v_exp_f32 v55, v55
    v_mfma_f32_32x32x16_bf16 v[100:115], v[128:131], v[80:83], v[100:115]
    v_exp_f32 v56, v56
    v_cvt_pk_bf16_f32 v80, v52, v53
    v_exp_f32 v57, v57
    v_exp_f32 v58, v58
    v_cvt_pk_bf16_f32 v81, v54, v55
    v_exp_f32 v59, v59
    s_waitcnt lgkmcnt(0)
    v_mfma_f32_32x32x16_bf16 v[84:99], v[36:39], v[76:79], v[84:99]
    s_mov_b32 m0, s95
    s_nop 0
    buffer_load_dwordx4 v118, s[28:31], s95 offen sc1 lds
    s_add_u32 s95, s95, 4096
    v_exp_f32 v60, v60
    v_cvt_pk_bf16_f32 v82, v56, v57
    v_exp_f32 v61, v61
    v_exp_f32 v62, v62
    v_cvt_pk_bf16_f32 v83, v58, v59
    v_exp_f32 v63, v63
    v_mfma_f32_32x32x16_bf16 v[44:59], v[28:31], v[4:7], 0
    ds_read_b64 v[20:21], v116 offset:15360
    v_exp_f32 v64, v64
    v_cvt_pk_bf16_f32 v76, v60, v61
    v_exp_f32 v65, v65
    v_exp_f32 v66, v66
    v_cvt_pk_bf16_f32 v77, v62, v63
    v_exp_f32 v67, v67
    v_mfma_f32_32x32x8bf16_1k v[44:59], v[32:33], v[8:9], v[44:59]
    ds_read_b64 v[22:23], v116 offset:15616
    v_exp_f32 v68, v68
    v_cvt_pk_bf16_f32 v78, v64, v65
    v_exp_f32 v69, v69
    v_exp_f32 v70, v70
    v_cvt_pk_bf16_f32 v79, v66, v67
    v_exp_f32 v71, v71
    v_mfma_f32_32x32x16_bf16 v[84:99], v[40:43], v[80:83], v[84:99]
    ds_read_b64 v[24:25], v116 offset:16384
    v_exp_f32 v72, v72
    v_cvt_pk_bf16_f32 v80, v68, v69
    v_exp_f32 v73, v73
    v_exp_f32 v74, v74
    v_cvt_pk_bf16_f32 v81, v70, v71
    v_exp_f32 v75, v75
    v_mfma_f32_32x32x16_bf16 v[100:115], v[36:39], v[76:79], v[100:115]
    s_mov_b64 exec, s[92:93]
    ds_read_b128 v[36:39], v117 offset:12800
    ds_read_b128 v[128:131], v117 offset:13440
    s_mov_b64 exec, -1
    s_mov_b32 m0, s95
    s_nop 0
    buffer_load_dwordx4 v118, s[28:31], s95 offen sc1 lds
    s_add_u32 s95, s95, 4096
    v_exp_f32 v44, v44
    v_cvt_pk_bf16_f32 v82, v72, v73
    v_exp_f32 v45, v45
    v_exp_f32 v46, v46
    v_cvt_pk_bf16_f32 v83, v74, v75
    v_exp_f32 v47, v47
    v_mfma_f32_32x32x16_bf16 v[60:75], v[28:31], v[12:15], 0
    v_exp_f32 v48, v48
    v_cvt_pk_bf16_f32 v76, v44, v45
    v_exp_f32 v49, v49
    v_exp_f32 v50, v50
    v_cvt_pk_bf16_f32 v77, v46, v47
    v_exp_f32 v51, v51
    v_mfma_f32_32x32x8bf16_1k v[60:75], v[32:33], v[16:17], v[60:75]
    v_exp_f32 v52, v52
    v_cvt_pk_bf16_f32 v78, v48, v49
    v_exp_f32 v53, v53
    v_exp_f32 v54, v54
    v_cvt_pk_bf16_f32 v79, v50, v51
    v_exp_f32 v55, v55
    v_mfma_f32_32x32x16_bf16 v[100:115], v[40:43], v[80:83], v[100:115]
    v_exp_f32 v56, v56
    v_cvt_pk_bf16_f32 v80, v52, v53
    v_exp_f32 v57, v57
    v_exp_f32 v58, v58
    v_cvt_pk_bf16_f32 v81, v54, v55
    v_exp_f32 v59, v59
    s_waitcnt lgkmcnt(0)
    v_mfma_f32_32x32x16_bf16 v[84:99], v[36:39], v[76:79], v[84:99]
    s_mov_b32 m0, s95
    s_nop 0
    buffer_load_dwordx4 v118, s[28:31], s95 offen sc1 lds
    s_add_u32 s95, s95, 4096
    v_exp_f32 v60, v60
    v_cvt_pk_bf16_f32 v82, v56, v57
    v_exp_f32 v61, v61
    v_exp_f32 v62, v62
    v_cvt_pk_bf16_f32 v83, v58, v59
    v_exp_f32 v63, v63
    v_mfma_f32_32x32x16_bf16 v[44:59], v[20:23], v[4:7], 0
    ds_read_b64 v[28:29], v116 offset:17920
    v_exp_f32 v64, v64
    v_cvt_pk_bf16_f32 v76, v60, v61
    v_exp_f32 v65, v65
    v_exp_f32 v66, v66
    v_cvt_pk_bf16_f32 v77, v62, v63
    v_exp_f32 v67, v67
    v_mfma_f32_32x32x8bf16_1k v[44:59], v[24:25], v[8:9], v[44:59]
    ds_read_b64 v[30:31], v116 offset:18176
    v_exp_f32 v68, v68
    v_cvt_pk_bf16_f32 v78, v64, v65
    v_exp_f32 v69, v69
    v_exp_f32 v70, v70
    v_cvt_pk_bf16_f32 v79, v66, v67
    v_exp_f32 v71, v71
    v_mfma_f32_32x32x16_bf16 v[84:99], v[128:131], v[80:83], v[84:99]
    ds_read_b64 v[32:33], v116 offset:18944
    v_exp_f32 v72, v72
    v_cvt_pk_bf16_f32 v80, v68, v69
    v_exp_f32 v73, v73
    v_exp_f32 v74, v74
    v_cvt_pk_bf16_f32 v81, v70, v71
    v_exp_f32 v75, v75
    v_mfma_f32_32x32x16_bf16 v[100:115], v[36:39], v[76:79], v[100:115]
    s_mov_b64 exec, s[92:93]
    ds_read_b128 v[36:39], v117 offset:15360
    ds_read_b128 v[40:43], v117 offset:16000
    s_mov_b64 exec, -1
    s_mov_b32 m0, s95
    s_nop 0
    buffer_load_dwordx4 v118, s[28:31], s95 offen sc1 lds
    s_add_u32 s95, s95, 4096
    v_exp_f32 v44, v44
    v_cvt_pk_bf16_f32 v82, v72, v73
    v_exp_f32 v45, v45
    v_exp_f32 v46, v46
    v_cvt_pk_bf16_f32 v83, v74, v75
    v_exp_f32 v47, v47
    v_mfma_f32_32x32x16_bf16 v[60:75], v[20:23], v[12:15], 0
    v_exp_f32 v48, v48
    v_cvt_pk_bf16_f32 v76, v44, v45
    v_exp_f32 v49, v49
    v_exp_f32 v50, v50
    v_cvt_pk_bf16_f32 v77, v46, v47
    v_exp_f32 v51, v51
    v_mfma_f32_32x32x8bf16_1k v[60:75], v[24:25], v[16:17], v[60:75]
    v_exp_f32 v52, v52
    v_cvt_pk_bf16_f32 v78, v48, v49
    v_exp_f32 v53, v53
    v_exp_f32 v54, v54
    v_cvt_pk_bf16_f32 v79, v50, v51
    v_exp_f32 v55, v55
    v_mfma_f32_32x32x16_bf16 v[100:115], v[128:131], v[80:83], v[100:115]
    v_exp_f32 v56, v56
    v_cvt_pk_bf16_f32 v80, v52, v53
    v_exp_f32 v57, v57
    v_exp_f32 v58, v58
    v_cvt_pk_bf16_f32 v81, v54, v55
    v_exp_f32 v59, v59
    s_waitcnt lgkmcnt(0)
    v_mfma_f32_32x32x16_bf16 v[84:99], v[36:39], v[76:79], v[84:99]
    s_mov_b32 m0, s95
    s_nop 0
    buffer_load_dwordx4 v118, s[28:31], s95 offen sc1 lds
    s_add_u32 s95, s95, 4096
    v_exp_f32 v60, v60
    v_cvt_pk_bf16_f32 v82, v56, v57
    v_exp_f32 v61, v61
    v_exp_f32 v62, v62
    v_cvt_pk_bf16_f32 v83, v58, v59
    v_exp_f32 v63, v63
    v_mfma_f32_32x32x16_bf16 v[44:59], v[28:31], v[4:7], 0
    ds_read_b64 v[20:21], v116 offset:20480
    v_exp_f32 v64, v64
    v_cvt_pk_bf16_f32 v76, v60, v61
    v_exp_f32 v65, v65
    v_exp_f32 v66, v66
    v_cvt_pk_bf16_f32 v77, v62, v63
    v_exp_f32 v67, v67
    v_mfma_f32_32x32x8bf16_1k v[44:59], v[32:33], v[8:9], v[44:59]
    ds_read_b64 v[22:23], v116 offset:20736
    v_exp_f32 v68, v68
    v_cvt_pk_bf16_f32 v78, v64, v65
    v_exp_f32 v69, v69
    v_exp_f32 v70, v70
    v_cvt_pk_bf16_f32 v79, v66, v67
    v_exp_f32 v71, v71
    v_mfma_f32_32x32x16_bf16 v[84:99], v[40:43], v[80:83], v[84:99]
    ds_read_b64 v[24:25], v116 offset:21504
    v_exp_f32 v72, v72
    v_cvt_pk_bf16_f32 v80, v68, v69
    v_exp_f32 v73, v73
    v_exp_f32 v74, v74
    v_cvt_pk_bf16_f32 v81, v70, v71
    v_exp_f32 v75, v75
    v_mfma_f32_32x32x16_bf16 v[100:115], v[36:39], v[76:79], v[100:115]
    s_mov_b64 exec, s[92:93]
    ds_read_b128 v[36:39], v117 offset:17920
    ds_read_b128 v[128:131], v117 offset:18560
    s_mov_b64 exec, -1
    buffer_load_dwordx4 v[144:147], v119, s[32:35], s55 offen sc1
    s_add_u32 s55, s55, s6
    v_exp_f32 v44, v44
    v_cvt_pk_bf16_f32 v82, v72, v73
    v_exp_f32 v45, v45
    v_exp_f32 v46, v46
    v_cvt_pk_bf16_f32 v83, v74, v75
    v_exp_f32 v47, v47
    v_mfma_f32_32x32x16_bf16 v[60:75], v[28:31], v[12:15], 0
    v_exp_f32 v48, v48
    v_cvt_pk_bf16_f32 v76, v44, v45
    v_exp_f32 v49, v49
    v_exp_f32 v50, v50
    v_cvt_pk_bf16_f32 v77, v46, v47
    v_exp_f32 v51, v51
    v_mfma_f32_32x32x8bf16_1k v[60:75], v[32:33], v[16:17], v[60:75]
    v_exp_f32 v52, v52
    v_cvt_pk_bf16_f32 v78, v48, v49
    v_exp_f32 v53, v53
    v_exp_f32 v54, v54
    v_cvt_pk_bf16_f32 v79, v50, v51
    v_exp_f32 v55, v55
    v_mfma_f32_32x32x16_bf16 v[100:115], v[40:43], v[80:83], v[100:115]
    v_exp_f32 v56, v56
    v_cvt_pk_bf16_f32 v80, v52, v53
    v_exp_f32 v57, v57
    v_exp_f32 v58, v58
    v_cvt_pk_bf16_f32 v81, v54, v55
    v_exp_f32 v59, v59
    s_waitcnt lgkmcnt(0)
    v_mfma_f32_32x32x16_bf16 v[84:99], v[36:39], v[76:79], v[84:99]
    buffer_load_dwordx4 v[148:151], v119, s[32:35], s55 offen sc1
    s_add_u32 s55, s55, s7
    buffer_load_dwordx4 v[152:155], v119, s[32:35], s55 offen sc1
    s_add_u32 s55, s55, s8
    v_exp_f32 v60, v60
    v_cvt_pk_bf16_f32 v82, v56, v57
    v_exp_f32 v61, v61
    v_exp_f32 v62, v62
    v_cvt_pk_bf16_f32 v83, v58, v59
    v_exp_f32 v63, v63
    v_mfma_f32_32x32x16_bf16 v[44:59], v[20:23], v[4:7], 0
    ds_read_b64 v[28:29], v116 offset:23040
    v_exp_f32 v64, v64
    v_cvt_pk_bf16_f32 v76, v60, v61
    v_exp_f32 v65, v65
    v_exp_f32 v66, v66
    v_cvt_pk_bf16_f32 v77, v62, v63
    v_exp_f32 v67, v67
    v_mfma_f32_32x32x8bf16_1k v[44:59], v[24:25], v[8:9], v[44:59]
    ds_read_b64 v[30:31], v116 offset:23296
    v_exp_f32 v68, v68
    v_cvt_pk_bf16_f32 v78, v64, v65
    v_exp_f32 v69, v69
    v_exp_f32 v70, v70
    v_cvt_pk_bf16_f32 v79, v66, v67
    v_exp_f32 v71, v71
    v_mfma_f32_32x32x16_bf16 v[84:99], v[128:131], v[80:83], v[84:99]
    ds_read_b64 v[32:33], v116 offset:24064
    v_exp_f32 v72, v72
    v_cvt_pk_bf16_f32 v80, v68, v69
    v_exp_f32 v73, v73
    v_exp_f32 v74, v74
    v_cvt_pk_bf16_f32 v81, v70, v71
    v_exp_f32 v75, v75
    v_mfma_f32_32x32x16_bf16 v[100:115], v[36:39], v[76:79], v[100:115]
    s_mov_b64 exec, s[92:93]
    ds_read_b128 v[36:39], v117 offset:20480
    ds_read_b128 v[40:43], v117 offset:21120
    s_mov_b64 exec, -1
    buffer_load_dwordx4 v[156:159], v119, s[32:35], s55 offen sc1
    s_add_u32 s55, s55, s9
    v_exp_f32 v44, v44
    v_cvt_pk_bf16_f32 v82, v72, v73
    v_exp_f32 v45, v45
    v_exp_f32 v46, v46
    v_cvt_pk_bf16_f32 v83, v74, v75
    v_exp_f32 v47, v47
    v_mfma_f32_32x32x16_bf16 v[60:75], v[20:23], v[12:15], 0
    v_exp_f32 v48, v48
    v_cvt_pk_bf16_f32 v76, v44, v45
    v_exp_f32 v49, v49
    v_exp_f32 v50, v50
    v_cvt_pk_bf16_f32 v77, v46, v47
    v_exp_f32 v51, v51
    v_mfma_f32_32x32x8bf16_1k v[60:75], v[24:25], v[16:17], v[60:75]
    v_exp_f32 v52, v52
    v_cvt_pk_bf16_f32 v78, v48, v49
    v_exp_f32 v53, v53
    v_exp_f32 v54, v54
    v_cvt_pk_bf16_f32 v79, v50, v51
    v_exp_f32 v55, v55
    v_mfma_f32_32x32x16_bf16 v[100:115], v[128:131], v[80:83], v[100:115]
    v_exp_f32 v56, v56
    v_cvt_pk_bf16_f32 v80, v52, v53
    v_exp_f32 v57, v57
    v_exp_f32 v58, v58
    v_cvt_pk_bf16_f32 v81, v54, v55
    v_exp_f32 v59, v59
    s_waitcnt lgkmcnt(0)
    v_mfma_f32_32x32x16_bf16 v[84:99], v[36:39], v[76:79], v[84:99]
    buffer_load_dwordx4 v[160:163], v119, s[32:35], s55 offen sc1
    s_add_u32 s55, s55, s16
    v_exp_f32 v60, v60
    v_cvt_pk_bf16_f32 v82, v56, v57
    v_exp_f32 v61, v61
    v_exp_f32 v62, v62
    v_cvt_pk_bf16_f32 v83, v58, v59
    v_exp_f32 v63, v63
    v_mfma_f32_32x32x16_bf16 v[44:59], v[28:31], v[4:7], 0
    ds_read_b64 v[20:21], v116 offset:25600
    v_exp_f32 v64, v64
    v_cvt_pk_bf16_f32 v76, v60, v61
    v_exp_f32 v65, v65
    v_exp_f32 v66, v66
    v_cvt_pk_bf16_f32 v77, v62, v63
    v_exp_f32 v67, v67
    v_mfma_f32_32x32x8bf16_1k v[44:59], v[32:33], v[8:9], v[44:59]
    ds_read_b64 v[22:23], v116 offset:25856
    v_exp_f32 v68, v68
    v_cvt_pk_bf16_f32 v78, v64, v65
    v_exp_f32 v69, v69
    v_exp_f32 v70, v70
    v_cvt_pk_bf16_f32 v79, v66, v67
    v_exp_f32 v71, v71
    v_mfma_f32_32x32x16_bf16 v[84:99], v[40:43], v[80:83], v[84:99]
    ds_read_b64 v[24:25], v116 offset:26624
    v_exp_f32 v72, v72
    v_cvt_pk_bf16_f32 v80, v68, v69
    v_exp_f32 v73, v73
    v_exp_f32 v74, v74
    v_cvt_pk_bf16_f32 v81, v70, v71
    v_exp_f32 v75, v75
    v_mfma_f32_32x32x16_bf16 v[100:115], v[36:39], v[76:79], v[100:115]
    s_mov_b64 exec, s[92:93]
    ds_read_b128 v[36:39], v117 offset:23040
    ds_read_b128 v[128:131], v117 offset:23680
    s_mov_b64 exec, -1
    buffer_load_dwordx4 v[164:167], v119, s[32:35], s55 offen sc1
    s_add_u32 s55, s55, s17
    buffer_load_dwordx4 v[168:171], v119, s[32:35], s55 offen sc1
    s_add_u32 s55, s55, s6
    v_exp_f32 v44, v44
    v_cvt_pk_bf16_f32 v82, v72, v73
    v_exp_f32 v45, v45
    v_exp_f32 v46, v46
    v_cvt_pk_bf16_f32 v83, v74, v75
    v_exp_f32 v47, v47
    v_mfma_f32_32x32x16_bf16 v[60:75], v[28:31], v[12:15], 0
    v_exp_f32 v48, v48
    v_cvt_pk_bf16_f32 v76, v44, v45
    v_exp_f32 v49, v49
    v_exp_f32 v50, v50
    v_cvt_pk_bf16_f32 v77, v46, v47
    v_exp_f32 v51, v51
    v_mfma_f32_32x32x8bf16_1k v[60:75], v[32:33], v[16:17], v[60:75]
    v_exp_f32 v52, v52
    v_cvt_pk_bf16_f32 v78, v48, v49
    v_exp_f32 v53, v53
    v_exp_f32 v54, v54
    v_cvt_pk_bf16_f32 v79, v50, v51
    v_exp_f32 v55, v55
    v_mfma_f32_32x32x16_bf16 v[100:115], v[40:43], v[80:83], v[100:115]
    v_exp_f32 v56, v56
    v_cvt_pk_bf16_f32 v80, v52, v53
    v_exp_f32 v57, v57
    v_exp_f32 v58, v58
    v_cvt_pk_bf16_f32 v81, v54, v55
    v_exp_f32 v59, v59
    s_waitcnt lgkmcnt(0)
    v_mfma_f32_32x32x16_bf16 v[84:99], v[36:39], v[76:79], v[84:99]
    buffer_load_dwordx4 v[172:175], v119, s[32:35], s55 offen sc1
    s_add_u32 s55, s55, s7
    v_exp_f32 v60, v60
    v_cvt_pk_bf16_f32 v82, v56, v57
    v_exp_f32 v61, v61
    v_exp_f32 v62, v62
    v_cvt_pk_bf16_f32 v83, v58, v59
    v_exp_f32 v63, v63
    v_mfma_f32_32x32x16_bf16 v[44:59], v[20:23], v[4:7], 0
    ds_read_b64 v[28:29], v116 offset:28160
    v_exp_f32 v64, v64
    v_cvt_pk_bf16_f32 v76, v60, v61
    v_exp_f32 v65, v65
    v_exp_f32 v66, v66
    v_cvt_pk_bf16_f32 v77, v62, v63
    v_exp_f32 v67, v67
    v_mfma_f32_32x32x8bf16_1k v[44:59], v[24:25], v[8:9], v[44:59]
    ds_read_b64 v[30:31], v116 offset:28416
    v_exp_f32 v68, v68
    v_cvt_pk_bf16_f32 v78, v64, v65
    v_exp_f32 v69, v69
    v_exp_f32 v70, v70
    v_cvt_pk_bf16_f32 v79, v66, v67
    v_exp_f32 v71, v71
    v_mfma_f32_32x32x16_bf16 v[84:99], v[128:131], v[80:83], v[84:99]
    ds_read_b64 v[32:33], v116 offset:29184
    v_exp_f32 v72, v72
    v_cvt_pk_bf16_f32 v80, v68, v69
    v_exp_f32 v73, v73
    v_exp_f32 v74, v74
    v_cvt_pk_bf16_f32 v81, v70, v71
    v_exp_f32 v75, v75
    v_mfma_f32_32x32x16_bf16 v[100:115], v[36:39], v[76:79], v[100:115]
    s_mov_b64 exec, s[92:93]
    ds_read_b128 v[36:39], v117 offset:25600
    ds_read_b128 v[40:43], v117 offset:26240
    s_mov_b64 exec, -1
    buffer_load_dwordx4 v[176:179], v119, s[32:35], s55 offen sc1
    s_add_u32 s55, s55, s8
    s_cmp_ge_u32 s3, 4
    s_cbranch_scc1 L_p2_prl10
    s_setprio 0
L_p2_prl10:
    v_exp_f32 v44, v44
    v_cvt_pk_bf16_f32 v82, v72, v73
    v_exp_f32 v45, v45
    v_exp_f32 v46, v46
    v_cvt_pk_bf16_f32 v83, v74, v75
    v_exp_f32 v47, v47
    v_mfma_f32_32x32x16_bf16 v[60:75], v[20:23], v[12:15], 0
    v_exp_f32 v48, v48
    v_cvt_pk_bf16_f32 v76, v44, v45
    v_exp_f32 v49, v49
    v_exp_f32 v50, v50
    v_cvt_pk_bf16_f32 v77, v46, v47
    v_exp_f32 v51, v51
    v_mfma_f32_32x32x8bf16_1k v[60:75], v[24:25], v[16:17], v[60:75]
    v_exp_f32 v52, v52
    v_cvt_pk_bf16_f32 v78, v48, v49
    v_exp_f32 v53, v53
    v_exp_f32 v54, v54
    v_cvt_pk_bf16_f32 v79, v50, v51
    v_exp_f32 v55, v55
    v_mfma_f32_32x32x16_bf16 v[100:115], v[128:131], v[80:83], v[100:115]
    v_exp_f32 v56, v56
    v_cvt_pk_bf16_f32 v80, v52, v53
    v_exp_f32 v57, v57
    v_exp_f32 v58, v58
    v_cvt_pk_bf16_f32 v81, v54, v55
    v_exp_f32 v59, v59
    s_waitcnt lgkmcnt(0)
    v_mfma_f32_32x32x16_bf16 v[84:99], v[36:39], v[76:79], v[84:99]
    buffer_load_dwordx4 v[180:183], v119, s[32:35], s55 offen sc1
    s_add_u32 s55, s55, s9
    buffer_load_dwordx4 v[184:187], v119, s[32:35], s55 offen sc1
    s_add_u32 s55, s55, s16
    v_exp_f32 v60, v60
    v_cvt_pk_bf16_f32 v82, v56, v57
    v_exp_f32 v61, v61
    v_exp_f32 v62, v62
    v_cvt_pk_bf16_f32 v83, v58, v59
    v_exp_f32 v63, v63
    v_mfma_f32_32x32x16_bf16 v[44:59], v[28:31], v[4:7], 0
    ds_read_b64 v[20:21], v116 offset:30720
    v_exp_f32 v64, v64
    v_cvt_pk_bf16_f32 v76, v60, v61
    v_exp_f32 v65, v65
    v_exp_f32 v66, v66
    v_cvt_pk_bf16_f32 v77, v62, v63
    v_exp_f32 v67, v67
    v_mfma_f32_32x32x8bf16_1k v[44:59], v[32:33], v[8:9], v[44:59]
    ds_read_b64 v[22:23], v116 offset:30976
    v_exp_f32 v68, v68
    v_cvt_pk_bf16_f32 v78, v64, v65
    v_exp_f32 v69, v69
    v_exp_f32 v70, v70
    v_cvt_pk_bf16_f32 v79, v66, v67
    v_exp_f32 v71, v71
    v_mfma_f32_32x32x16_bf16 v[84:99], v[40:43], v[80:83], v[84:99]
    ds_read_b64 v[24:25], v116 offset:31744
    v_exp_f32 v72, v72
    v_cvt_pk_bf16_f32 v80, v68, v69
    v_exp_f32 v73, v73
    v_exp_f32 v74, v74
    v_cvt_pk_bf16_f32 v81, v70, v71
    v_exp_f32 v75, v75
    v_mfma_f32_32x32x16_bf16 v[100:115], v[36:39], v[76:79], v[100:115]
    s_mov_b64 exec, s[92:93]
    ds_read_b128 v[36:39], v117 offset:28160
    ds_read_b128 v[128:131], v117 offset:28800
    s_mov_b64 exec, -1
    buffer_load_dwordx4 v[188:191], v119, s[32:35], s55 offen sc1
    s_add_u32 s55, s55, s17
    v_exp_f32 v44, v44
    v_cvt_pk_bf16_f32 v82, v72, v73
    v_exp_f32 v45, v45
    v_exp_f32 v46, v46
    v_cvt_pk_bf16_f32 v83, v74, v75
    v_exp_f32 v47, v47
    v_mfma_f32_32x32x16_bf16 v[60:75], v[28:31], v[12:15], 0
    v_exp_f32 v48, v48
    v_cvt_pk_bf16_f32 v76, v44, v45
    v_exp_f32 v49, v49
    v_exp_f32 v50, v50
    v_cvt_pk_bf16_f32 v77, v46, v47
    v_exp_f32 v51, v51
    v_mfma_f32_32x32x8bf16_1k v[60:75], v[32:33], v[16:17], v[60:75]
    v_exp_f32 v52, v52
    v_cvt_pk_bf16_f32 v78, v48, v49
    v_exp_f32 v53, v53
    v_exp_f32 v54, v54
    v_cvt_pk_bf16_f32 v79, v50, v51
    v_exp_f32 v55, v55
    v_mfma_f32_32x32x16_bf16 v[100:115], v[40:43], v[80:83], v[100:115]
    v_exp_f32 v56, v56
    v_cvt_pk_bf16_f32 v80, v52, v53
    v_exp_f32 v57, v57
    v_exp_f32 v58, v58
    v_cvt_pk_bf16_f32 v81, v54, v55
    v_exp_f32 v59, v59
    s_waitcnt lgkmcnt(0)
    v_mfma_f32_32x32x16_bf16 v[84:99], v[36:39], v[76:79], v[84:99]
    buffer_load_dwordx4 v[192:195], v119, s[32:35], s55 offen sc1
    s_add_u32 s55, s55, s6
    v_exp_f32 v60, v60
    v_cvt_pk_bf16_f32 v82, v56, v57
    v_exp_f32 v61, v61
    v_exp_f32 v62, v62
    v_cvt_pk_bf16_f32 v83, v58, v59
    v_exp_f32 v63, v63
    v_mfma_f32_32x32x16_bf16 v[44:59], v[20:23], v[4:7], 0
    ds_read_b64 v[28:29], v116 offset:33280
    v_exp_f32 v64, v64
    v_cvt_pk_bf16_f32 v76, v60, v61
    v_exp_f32 v65, v65
    v_exp_f32 v66, v66
    v_cvt_pk_bf16_f32 v77, v62, v63
    v_exp_f32 v67, v67
    v_mfma_f32_32x32x8bf16_1k v[44:59], v[24:25], v[8:9], v[44:59]
    ds_read_b64 v[30:31], v116 offset:33536
    v_exp_f32 v68, v68
    v_cvt_pk_bf16_f32 v78, v64, v65
    v_exp_f32 v69, v69
    v_exp_f32 v70, v70
    v_cvt_pk_bf16_f32 v79, v66, v67
    v_exp_f32 v71, v71
    v_mfma_f32_32x32x16_bf16 v[84:99], v[128:131], v[80:83], v[84:99]
    ds_read_b64 v[32:33], v116 offset:34304
    v_exp_f32 v72, v72
    v_cvt_pk_bf16_f32 v80, v68, v69
    v_exp_f32 v73, v73
    v_exp_f32 v74, v74
    v_cvt_pk_bf16_f32 v81, v70, v71
    v_exp_f32 v75, v75
    v_mfma_f32_32x32x16_bf16 v[100:115], v[36:39], v[76:79], v[100:115]
    s_mov_b64 exec, s[92:93]
    ds_read_b128 v[36:39], v117 offset:30720
    ds_read_b128 v[40:43], v117 offset:31360
    s_mov_b64 exec, -1
    buffer_load_dwordx4 v[196:199], v119, s[32:35], s55 offen sc1
    s_add_u32 s55, s55, s7
    buffer_load_dwordx4 v[200:203], v119, s[32:35], s55 offen sc1
    s_add_u32 s55, s55, s8
    s_waitcnt vmcnt(15)
    s_barrier
    s_cmp_ge_u32 s3, 4
    s_cbranch_scc1 L_p2_prh12
    s_setprio 2
L_p2_prh12:
    v_exp_f32 v44, v44
    v_cvt_pk_bf16_f32 v82, v72, v73
    v_exp_f32 v45, v45
    v_exp_f32 v46, v46
    v_cvt_pk_bf16_f32 v83, v74, v75
    v_exp_f32 v47, v47
    v_mfma_f32_32x32x16_bf16 v[60:75], v[20:23], v[12:15], 0
    v_exp_f32 v48, v48
    v_cvt_pk_bf16_f32 v76, v44, v45
    v_exp_f32 v49, v49
    v_exp_f32 v50, v50
    v_cvt_pk_bf16_f32 v77, v46, v47
    v_exp_f32 v51, v51
    v_mfma_f32_32x32x8bf16_1k v[60:75], v[24:25], v[16:17], v[60:75]
    v_exp_f32 v52, v52
    v_cvt_pk_bf16_f32 v78, v48, v49
    v_exp_f32 v53, v53
    v_exp_f32 v54, v54
    v_cvt_pk_bf16_f32 v79, v50, v51
    v_exp_f32 v55, v55
    v_mfma_f32_32x32x16_bf16 v[100:115], v[128:131], v[80:83], v[100:115]
    v_exp_f32 v56, v56
    v_cvt_pk_bf16_f32 v80, v52, v53
    v_exp_f32 v57, v57
    v_exp_f32 v58, v58
    v_cvt_pk_bf16_f32 v81, v54, v55
    v_exp_f32 v59, v59
    s_waitcnt lgkmcnt(0)
    v_mfma_f32_32x32x16_bf16 v[84:99], v[36:39], v[76:79], v[84:99]
    s_mov_b32 m0, s95
    s_nop 0
    buffer_load_dwordx4 v118, s[28:31], s95 offen sc1 lds
    s_add_u32 s95, s95, 4096
    v_exp_f32 v60, v60
    v_cvt_pk_bf16_f32 v82, v56, v57
    v_exp_f32 v61, v61
    v_exp_f32 v62, v62
    v_cvt_pk_bf16_f32 v83, v58, v59
    v_exp_f32 v63, v63
    v_mfma_f32_32x32x16_bf16 v[44:59], v[28:31], v[4:7], 0
    ds_read_b64 v[20:21], v116 offset:35840
    v_exp_f32 v64, v64
    v_cvt_pk_bf16_f32 v76, v60, v61
    v_exp_f32 v65, v65
    v_exp_f32 v66, v66
    v_cvt_pk_bf16_f32 v77, v62, v63
    v_exp_f32 v67, v67
    v_mfma_f32_32x32x8bf16_1k v[44:59], v[32:33], v[8:9], v[44:59]
    ds_read_b64 v[22:23], v116 offset:36096
    v_exp_f32 v68, v68
    v_cvt_pk_bf16_f32 v78, v64, v65
    v_exp_f32 v69, v69
    v_exp_f32 v70, v70
    v_cvt_pk_bf16_f32 v79, v66, v67
    v_exp_f32 v71, v71
    v_mfma_f32_32x32x16_bf16 v[84:99], v[40:43], v[80:83], v[84:99]
    ds_read_b64 v[24:25], v116 offset:36864
    v_exp_f32 v72, v72
    v_cvt_pk_bf16_f32 v80, v68, v69
    v_exp_f32 v73, v73
    v_exp_f32 v74, v74
    v_cvt_pk_bf16_f32 v81, v70, v71
    v_exp_f32 v75, v75
    v_mfma_f32_32x32x16_bf16 v[100:115], v[36:39], v[76:79], v[100:115]
    s_mov_b64 exec, s[92:93]
    ds_read_b128 v[36:39], v117 offset:33280
    ds_read_b128 v[128:131], v117 offset:33920
    s_mov_b64 exec, -1
    s_mov_b32 m0, s95
    s_nop 0
    buffer_load_dwordx4 v118, s[28:31], s95 offen sc1 lds
    s_add_u32 s95, s95, 4096
    v_exp_f32 v44, v44
    v_cvt_pk_bf16_f32 v82, v72, v73
    v_exp_f32 v45, v45
    v_exp_f32 v46, v46
    v_cvt_pk_bf16_f32 v83, v74, v75
    v_exp_f32 v47, v47
    v_mfma_f32_32x32x16_bf16 v[60:75], v[28:31], v[12:15], 0
    v_exp_f32 v48, v48
    v_cvt_pk_bf16_f32 v76, v44, v45
    v_exp_f32 v49, v49
    v_exp_f32 v50, v50
    v_cvt_pk_bf16_f32 v77, v46, v47
    v_exp_f32 v51, v51
    v_mfma_f32_32x32x8bf16_1k v[60:75], v[32:33], v[16:17], v[60:75]
    v_exp_f32 v52, v52
    v_cvt_pk_bf16_f32 v78, v48, v49
    v_exp_f32 v53, v53
    v_exp_f32 v54, v54
    v_cvt_pk_bf16_f32 v79, v50, v51
    v_exp_f32 v55, v55
    v_mfma_f32_32x32x16_bf16 v[100:115], v[40:43], v[80:83], v[100:115]
    v_exp_f32 v56, v56
    v_cvt_pk_bf16_f32 v80, v52, v53
    v_exp_f32 v57, v57
    v_exp_f32 v58, v58
    v_cvt_pk_bf16_f32 v81, v54, v55
    v_exp_f32 v59, v59
    s_waitcnt lgkmcnt(0)
    v_mfma_f32_32x32x16_bf16 v[84:99], v[36:39], v[76:79], v[84:99]
    s_mov_b32 m0, s95
    s_nop 0
    buffer_load_dwordx4 v118, s[28:31], s95 offen sc1 lds
    s_add_u32 s95, s95, 4096
    v_exp_f32 v60, v60
    v_cvt_pk_bf16_f32 v82, v56, v57
    v_exp_f32 v61, v61
    v_exp_f32 v62, v62
    v_cvt_pk_bf16_f32 v83, v58, v59
    v_exp_f32 v63, v63
    v_mfma_f32_32x32x16_bf16 v[44:59], v[20:23], v[4:7], 0
    ds_read_b64 v[28:29], v116 offset:38400
    v_exp_f32 v64, v64
    v_cvt_pk_bf16_f32 v76, v60, v61
    v_exp_f32 v65, v65
    v_exp_f32 v66, v66
    v_cvt_pk_bf16_f32 v77, v62, v63
    v_exp_f32 v67, v67
    v_mfma_f32_32x32x8bf16_1k v[44:59], v[24:25], v[8:9], v[44:59]
    ds_read_b64 v[30:31], v116 offset:38656
    v_exp_f32 v68, v68
    v_cvt_pk_bf16_f32 v78, v64, v65
    v_exp_f32 v69, v69
    v_exp_f32 v70, v70
    v_cvt_pk_bf16_f32 v79, v66, v67
    v_exp_f32 v71, v71
    v_mfma_f32_32x32x16_bf16 v[84:99], v[128:131], v[80:83], v[84:99]
    ds_read_b64 v[32:33], v116 offset:39424
    v_exp_f32 v72, v72
    v_cvt_pk_bf16_f32 v80, v68, v69
    v_exp_f32 v73, v73
    v_exp_f32 v74, v74
    v_cvt_pk_bf16_f32 v81, v70, v71
    v_exp_f32 v75, v75
    v_mfma_f32_32x32x16_bf16 v[100:115], v[36:39], v[76:79], v[100:115]
    s_mov_b64 exec, s[92:93]
    ds_read_b128 v[36:39], v117 offset:35840
    ds_read_b128 v[40:43], v117 offset:36480
    s_mov_b64 exec, -1
    s_mov_b32 m0, s95
    s_nop 0
    buffer_load_dwordx4 v118, s[28:31], s95 offen sc1 lds
    s_add_u32 s95, s95, 4096
    v_exp_f32 v44, v44
    v_cvt_pk_bf16_f32 v82, v72, v73
    v_exp_f32 v45, v45
    v_exp_f32 v46, v46
    v_cvt_pk_bf16_f32 v83, v74, v75
    v_exp_f32 v47, v47
    v_mfma_f32_32x32x16_bf16 v[60:75], v[20:23], v[12:15], 0
    v_exp_f32 v48, v48
    v_cvt_pk_bf16_f32 v76, v44, v45
    v_exp_f32 v49, v49
    v_exp_f32 v50, v50
    v_cvt_pk_bf16_f32 v77, v46, v47
    v_exp_f32 v51, v51
    v_mfma_f32_32x32x8bf16_1k v[60:75], v[24:25], v[16:17], v[60:75]
    v_exp_f32 v52, v52
    v_cvt_pk_bf16_f32 v78, v48, v49
    v_exp_f32 v53, v53
    v_exp_f32 v54, v54
    v_cvt_pk_bf16_f32 v79, v50, v51
    v_exp_f32 v55, v55
    v_mfma_f32_32x32x16_bf16 v[100:115], v[128:131], v[80:83], v[100:115]
    v_exp_f32 v56, v56
    v_cvt_pk_bf16_f32 v80, v52, v53
    v_exp_f32 v57, v57
    v_exp_f32 v58, v58
    v_cvt_pk_bf16_f32 v81, v54, v55
    v_exp_f32 v59, v59
    s_waitcnt lgkmcnt(0)
    v_mfma_f32_32x32x16_bf16 v[84:99], v[36:39], v[76:79], v[84:99]
    s_mov_b32 m0, s95
    s_nop 0
    buffer_load_dwordx4 v118, s[28:31], s95 offen sc1 lds
    s_add_u32 s95, s95, 4096
    v_exp_f32 v60, v60
    v_cvt_pk_bf16_f32 v82, v56, v57
    v_exp_f32 v61, v61
    v_exp_f32 v62, v62
    v_cvt_pk_bf16_f32 v83, v58, v59
    v_exp_f32 v63, v63
    v_mfma_f32_32x32x16_bf16 v[44:59], v[28:31], v[4:7], 0
    ds_read_b64 v[20:21], v116 offset:40960
    v_exp_f32 v64, v64
    v_cvt_pk_bf16_f32 v76, v60, v61
    v_exp_f32 v65, v65
    v_exp_f32 v66, v66
    v_cvt_pk_bf16_f32 v77, v62, v63
    v_exp_f32 v67, v67
    v_mfma_f32_32x32x8bf16_1k v[44:59], v[32:33], v[8:9], v[44:59]
    ds_read_b64 v[22:23], v116 offset:41216
    v_exp_f32 v68, v68
    v_cvt_pk_bf16_f32 v78, v64, v65
    v_exp_f32 v69, v69
    v_exp_f32 v70, v70
    v_cvt_pk_bf16_f32 v79, v66, v67
    v_exp_f32 v71, v71
    v_mfma_f32_32x32x16_bf16 v[84:99], v[40:43], v[80:83], v[84:99]
    ds_read_b64 v[24:25], v116 offset:41984
    v_exp_f32 v72, v72
    v_cvt_pk_bf16_f32 v80, v68, v69
    v_exp_f32 v73, v73
    v_exp_f32 v74, v74
    v_cvt_pk_bf16_f32 v81, v70, v71
    v_exp_f32 v75, v75
    v_mfma_f32_32x32x16_bf16 v[100:115], v[36:39], v[76:79], v[100:115]
    s_mov_b64 exec, s[92:93]
    ds_read_b128 v[36:39], v117 offset:38400
    ds_read_b128 v[128:131], v117 offset:39040
    s_mov_b64 exec, -1
    s_mov_b32 m0, s95
    s_nop 0
    buffer_load_dwordx4 v118, s[28:31], s95 offen sc1 lds
    s_add_u32 s95, s95, 4096
    v_exp_f32 v44, v44
    v_cvt_pk_bf16_f32 v82, v72, v73
    v_exp_f32 v45, v45
    v_exp_f32 v46, v46
    v_cvt_pk_bf16_f32 v83, v74, v75
    v_exp_f32 v47, v47
    v_mfma_f32_32x32x16_bf16 v[60:75], v[28:31], v[12:15], 0
    v_exp_f32 v48, v48
    v_cvt_pk_bf16_f32 v76, v44, v45
    v_exp_f32 v49, v49
    v_exp_f32 v50, v50
    v_cvt_pk_bf16_f32 v77, v46, v47
    v_exp_f32 v51, v51
    v_mfma_f32_32x32x8bf16_1k v[60:75], v[32:33], v[16:17], v[60:75]
    v_exp_f32 v52, v52
    v_cvt_pk_bf16_f32 v78, v48, v49
    v_exp_f32 v53, v53
    v_exp_f32 v54, v54
    v_cvt_pk_bf16_f32 v79, v50, v51
    v_exp_f32 v55, v55
    v_mfma_f32_32x32x16_bf16 v[100:115], v[40:43], v[80:83], v[100:115]
    v_exp_f32 v56, v56
    v_cvt_pk_bf16_f32 v80, v52, v53
    v_exp_f32 v57, v57
    v_exp_f32 v58, v58
    v_cvt_pk_bf16_f32 v81, v54, v55
    v_exp_f32 v59, v59
    s_waitcnt lgkmcnt(0)
    v_mfma_f32_32x32x16_bf16 v[84:99], v[36:39], v[76:79], v[84:99]
    buffer_load_dwordx4 v[204:207], v119, s[32:35], s55 offen sc1
    s_add_u32 s55, s55, s9
    v_exp_f32 v60, v60
    v_cvt_pk_bf16_f32 v82, v56, v57
    v_exp_f32 v61, v61
    v_exp_f32 v62, v62
    v_cvt_pk_bf16_f32 v83, v58, v59
    v_exp_f32 v63, v63
    v_mfma_f32_32x32x16_bf16 v[44:59], v[20:23], v[4:7], 0
    ds_read_b64 v[28:29], v116 offset:43520
    v_exp_f32 v64, v64
    v_cvt_pk_bf16_f32 v76, v60, v61
    v_exp_f32 v65, v65
    v_exp_f32 v66, v66
    v_cvt_pk_bf16_f32 v77, v62, v63
    v_exp_f32 v67, v67
    v_mfma_f32_32x32x8bf16_1k v[44:59], v[24:25], v[8:9], v[44:59]
    ds_read_b64 v[30:31], v116 offset:43776
    v_exp_f32 v68, v68
    v_cvt_pk_bf16_f32 v78, v64, v65
    v_exp_f32 v69, v69
    v_exp_f32 v70, v70
    v_cvt_pk_bf16_f32 v79, v66, v67
    v_exp_f32 v71, v71
    v_mfma_f32_32x32x16_bf16 v[84:99], v[128:131], v[80:83], v[84:99]
    ds_read_b64 v[32:33], v116 offset:44544
    v_exp_f32 v72, v72
    v_cvt_pk_bf16_f32 v80, v68, v69
    v_exp_f32 v73, v73
    v_exp_f32 v74, v74
    v_cvt_pk_bf16_f32 v81, v70, v71
    v_exp_f32 v75, v75
    v_mfma_f32_32x32x16_bf16 v[100:115], v[36:39], v[76:79], v[100:115]
    s_mov_b64 exec, s[92:93]
    ds_read_b128 v[36:39], v117 offset:40960
    ds_read_b128 v[40:43], v117 offset:41600
    s_mov_b64 exec, -1
    buffer_load_dwordx4 v[208:211], v119, s[32:35], s55 offen sc1
    s_add_u32 s55, s55, s16
    v_add_u32 v116, 40960, v116
    v_add_u32 v117, 40960, v117
    v_exp_f32 v44, v44
    v_cvt_pk_bf16_f32 v82, v72, v73
    v_exp_f32 v45, v45
    v_exp_f32 v46, v46
    v_cvt_pk_bf16_f32 v83, v74, v75
    v_exp_f32 v47, v47
    v_mfma_f32_32x32x16_bf16 v[60:75], v[20:23], v[12:15], 0
    v_exp_f32 v48, v48
    v_cvt_pk_bf16_f32 v76, v44, v45
    v_exp_f32 v49, v49
    v_exp_f32 v50, v50
    v_cvt_pk_bf16_f32 v77, v46, v47
    v_exp_f32 v51, v51
    v_mfma_f32_32x32x8bf16_1k v[60:75], v[24:25], v[16:17], v[60:75]
    v_exp_f32 v52, v52
    v_cvt_pk_bf16_f32 v78, v48, v49
    v_exp_f32 v53, v53
    v_exp_f32 v54, v54
    v_cvt_pk_bf16_f32 v79, v50, v51
    v_exp_f32 v55, v55
    v_mfma_f32_32x32x16_bf16 v[100:115], v[128:131], v[80:83], v[100:115]
    v_exp_f32 v56, v56
    v_cvt_pk_bf16_f32 v80, v52, v53
    v_exp_f32 v57, v57
    v_exp_f32 v58, v58
    v_cvt_pk_bf16_f32 v81, v54, v55
    v_exp_f32 v59, v59
    s_waitcnt lgkmcnt(0)
    v_mfma_f32_32x32x16_bf16 v[84:99], v[36:39], v[76:79], v[84:99]
    buffer_load_dwordx4 v[212:215], v119, s[32:35], s55 offen sc1
    s_add_u32 s55, s55, s17
    buffer_load_dwordx4 v[216:219], v119, s[32:35], s55 offen sc1
    s_add_u32 s55, s55, s6
    v_exp_f32 v60, v60
    v_cvt_pk_bf16_f32 v82, v56, v57
    v_exp_f32 v61, v61
    v_exp_f32 v62, v62
    v_cvt_pk_bf16_f32 v83, v58, v59
    v_exp_f32 v63, v63
    v_mfma_f32_32x32x16_bf16 v[44:59], v[28:31], v[4:7], 0
    ds_read_b64 v[20:21], v116 offset:5120
    v_exp_f32 v64, v64
    v_cvt_pk_bf16_f32 v76, v60, v61
    v_exp_f32 v65, v65
    v_exp_f32 v66, v66
    v_cvt_pk_bf16_f32 v77, v62, v63
    v_exp_f32 v67, v67
    v_mfma_f32_32x32x8bf16_1k v[44:59], v[32:33], v[8:9], v[44:59]
    ds_read_b64 v[22:23], v116 offset:5376
    v_exp_f32 v68, v68
    v_cvt_pk_bf16_f32 v78, v64, v65
    v_exp_f32 v69, v69
    v_exp_f32 v70, v70
    v_cvt_pk_bf16_f32 v79, v66, v67
    v_exp_f32 v71, v71
    v_mfma_f32_32x32x16_bf16 v[84:99], v[40:43], v[80:83], v[84:99]
    ds_read_b64 v[24:25], v116 offset:6144
    v_exp_f32 v72, v72
    v_cvt_pk_bf16_f32 v80, v68, v69
    v_exp_f32 v73, v73
    v_exp_f32 v74, v74
    v_cvt_pk_bf16_f32 v81, v70, v71
    v_exp_f32 v75, v75
    v_mfma_f32_32x32x16_bf16 v[100:115], v[36:39], v[76:79], v[100:115]
    s_mov_b64 exec, s[92:93]
    ds_read_b128 v[36:39], v117 offset:2560
    ds_read_b128 v[128:131], v117 offset:3200
    s_mov_b64 exec, -1
    buffer_load_dwordx4 v[220:223], v119, s[32:35], s55 offen sc1
    s_add_u32 s55, s55, s7
    v_exp_f32 v44, v44
    v_cvt_pk_bf16_f32 v82, v72, v73
    v_exp_f32 v45, v45
    v_exp_f32 v46, v46
    v_cvt_pk_bf16_f32 v83, v74, v75
    v_exp_f32 v47, v47
    v_mfma_f32_32x32x16_bf16 v[60:75], v[28:31], v[12:15], 0
    v_exp_f32 v48, v48
    v_cvt_pk_bf16_f32 v76, v44, v45
    v_exp_f32 v49, v49
    v_exp_f32 v50, v50
    v_cvt_pk_bf16_f32 v77, v46, v47
    v_exp_f32 v51, v51
    v_mfma_f32_32x32x8bf16_1k v[60:75], v[32:33], v[16:17], v[60:75]
    v_exp_f32 v52, v52
    v_cvt_pk_bf16_f32 v78, v48, v49
    v_exp_f32 v53, v53
    v_exp_f32 v54, v54
    v_cvt_pk_bf16_f32 v79, v50, v51
    v_exp_f32 v55, v55
    v_mfma_f32_32x32x16_bf16 v[100:115], v[40:43], v[80:83], v[100:115]
    v_exp_f32 v56, v56
    v_cvt_pk_bf16_f32 v80, v52, v53
    v_exp_f32 v57, v57
    v_exp_f32 v58, v58
    v_cvt_pk_bf16_f32 v81, v54, v55
    v_exp_f32 v59, v59
    s_waitcnt lgkmcnt(0)
    v_mfma_f32_32x32x16_bf16 v[84:99], v[36:39], v[76:79], v[84:99]
    buffer_load_dwordx4 v[224:227], v119, s[32:35], s55 offen sc1
    s_add_u32 s55, s55, s8
    v_exp_f32 v60, v60
    v_cvt_pk_bf16_f32 v82, v56, v57
    v_exp_f32 v61, v61
    v_exp_f32 v62, v62
    v_cvt_pk_bf16_f32 v83, v58, v59
    v_exp_f32 v63, v63
    v_mfma_f32_32x32x16_bf16 v[44:59], v[20:23], v[4:7], 0
    ds_read_b64 v[28:29], v116 offset:7680
    v_exp_f32 v64, v64
    v_cvt_pk_bf16_f32 v76, v60, v61
    v_exp_f32 v65, v65
    v_exp_f32 v66, v66
    v_cvt_pk_bf16_f32 v77, v62, v63
    v_exp_f32 v67, v67
    v_mfma_f32_32x32x8bf16_1k v[44:59], v[24:25], v[8:9], v[44:59]
    ds_read_b64 v[30:31], v116 offset:7936
    v_exp_f32 v68, v68
    v_cvt_pk_bf16_f32 v78, v64, v65
    v_exp_f32 v69, v69
    v_exp_f32 v70, v70
    v_cvt_pk_bf16_f32 v79, v66, v67
    v_exp_f32 v71, v71
    v_mfma_f32_32x32x16_bf16 v[84:99], v[128:131], v[80:83], v[84:99]
    ds_read_b64 v[32:33], v116 offset:8704
    v_exp_f32 v72, v72
    v_cvt_pk_bf16_f32 v80, v68, v69
    v_exp_f32 v73, v73
    v_exp_f32 v74, v74
    v_cvt_pk_bf16_f32 v81, v70, v71
    v_exp_f32 v75, v75
    v_mfma_f32_32x32x16_bf16 v[100:115], v[36:39], v[76:79], v[100:115]
    s_mov_b64 exec, s[92:93]
    ds_read_b128 v[36:39], v117 offset:5120
    ds_read_b128 v[40:43], v117 offset:5760
    s_mov_b64 exec, -1
    buffer_load_dwordx4 v[228:231], v119, s[32:35], s55 offen sc1
    s_add_u32 s55, s55, s9
    buffer_load_dwordx4 v[232:235], v119, s[32:35], s55 offen sc1
    s_add_u32 s55, s55, s16
    s_cmp_ge_u32 s3, 4
    s_cbranch_scc1 L_p2_prl18
    s_setprio 0
L_p2_prl18:
    v_exp_f32 v44, v44
    v_cvt_pk_bf16_f32 v82, v72, v73
    v_exp_f32 v45, v45
    v_exp_f32 v46, v46
    v_cvt_pk_bf16_f32 v83, v74, v75
    v_exp_f32 v47, v47
    v_mfma_f32_32x32x16_bf16 v[60:75], v[20:23], v[12:15], 0
    v_exp_f32 v48, v48
    v_cvt_pk_bf16_f32 v76, v44, v45
    v_exp_f32 v49, v49
    v_exp_f32 v50, v50
    v_cvt_pk_bf16_f32 v77, v46, v47
    v_exp_f32 v51, v51
    v_mfma_f32_32x32x8bf16_1k v[60:75], v[24:25], v[16:17], v[60:75]
    v_exp_f32 v52, v52
    v_cvt_pk_bf16_f32 v78, v48, v49
    v_exp_f32 v53, v53
    v_exp_f32 v54, v54
    v_cvt_pk_bf16_f32 v79, v50, v51
    v_exp_f32 v55, v55
    v_mfma_f32_32x32x16_bf16 v[100:115], v[128:131], v[80:83], v[100:115]
    v_exp_f32 v56, v56
    v_cvt_pk_bf16_f32 v80, v52, v53
    v_exp_f32 v57, v57
    v_exp_f32 v58, v58
    v_cvt_pk_bf16_f32 v81, v54, v55
    v_exp_f32 v59, v59
    s_waitcnt lgkmcnt(0)
    v_mfma_f32_32x32x16_bf16 v[84:99], v[36:39], v[76:79], v[84:99]
    buffer_load_dwordx4 v[236:239], v119, s[32:35], s55 offen sc1
    s_add_u32 s55, s55, s17
    v_exp_f32 v60, v60
    v_cvt_pk_bf16_f32 v82, v56, v57
    v_exp_f32 v61, v61
    v_exp_f32 v62, v62
    v_cvt_pk_bf16_f32 v83, v58, v59
    v_exp_f32 v63, v63
    v_mfma_f32_32x32x16_bf16 v[44:59], v[28:31], v[4:7], 0
    ds_read_b64 v[20:21], v116 offset:10240
    v_exp_f32 v64, v64
    v_cvt_pk_bf16_f32 v76, v60, v61
    v_exp_f32 v65, v65
    v_exp_f32 v66, v66
    v_cvt_pk_bf16_f32 v77, v62, v63
    v_exp_f32 v67, v67
    v_mfma_f32_32x32x8bf16_1k v[44:59], v[32:33], v[8:9], v[44:59]
    ds_read_b64 v[22:23], v116 offset:10496
    v_exp_f32 v68, v68
    v_cvt_pk_bf16_f32 v78, v64, v65
    v_exp_f32 v69, v69
    v_exp_f32 v70, v70
    v_cvt_pk_bf16_f32 v79, v66, v67
    v_exp_f32 v71, v71
    v_mfma_f32_32x32x16_bf16 v[84:99], v[40:43], v[80:83], v[84:99]
    ds_read_b64 v[24:25], v116 offset:11264
    v_exp_f32 v72, v72
    v_cvt_pk_bf16_f32 v80, v68, v69
    v_exp_f32 v73, v73
    v_exp_f32 v74, v74
    v_cvt_pk_bf16_f32 v81, v70, v71
    v_exp_f32 v75, v75
    v_mfma_f32_32x32x16_bf16 v[100:115], v[36:39], v[76:79], v[100:115]
    s_mov_b64 exec, s[92:93]
    ds_read_b128 v[36:39], v117 offset:7680
    ds_read_b128 v[128:131], v117 offset:8320
    s_mov_b64 exec, -1
    buffer_load_dwordx4 v[240:243], v119, s[32:35], s55 offen sc1
    s_add_u32 s55, s55, s6
    v_exp_f32 v44, v44
    v_cvt_pk_bf16_f32 v82, v72, v73
    v_exp_f32 v45, v45
    v_exp_f32 v46, v46
    v_cvt_pk_bf16_f32 v83, v74, v75
    v_exp_f32 v47, v47
    v_mfma_f32_32x32x16_bf16 v[60:75], v[28:31], v[12:15], 0
    v_exp_f32 v48, v48
    v_cvt_pk_bf16_f32 v76, v44, v45
    v_exp_f32 v49, v49
    v_exp_f32 v50, v50
    v_cvt_pk_bf16_f32 v77, v46, v47
    v_exp_f32 v51, v51
    v_mfma_f32_32x32x8bf16_1k v[60:75], v[32:33], v[16:17], v[60:75]
    v_exp_f32 v52, v52
    v_cvt_pk_bf16_f32 v78, v48, v49
    v_exp_f32 v53, v53
    v_exp_f32 v54, v54
    v_cvt_pk_bf16_f32 v79, v50, v51
    v_exp_f32 v55, v55
    v_mfma_f32_32x32x16_bf16 v[100:115], v[40:43], v[80:83], v[100:115]
    v_exp_f32 v56, v56
    v_cvt_pk_bf16_f32 v80, v52, v53
    v_exp_f32 v57, v57
    v_exp_f32 v58, v58
    v_cvt_pk_bf16_f32 v81, v54, v55
    v_exp_f32 v59, v59
    s_waitcnt lgkmcnt(0)
    v_mfma_f32_32x32x16_bf16 v[84:99], v[36:39], v[76:79], v[84:99]
    buffer_load_dwordx4 v[244:247], v119, s[32:35], s55 offen sc1
    s_add_u32 s55, s55, s7
    buffer_load_dwordx4 v[248:251], v119, s[32:35], s55 offen sc1
    s_add_u32 s55, s55, s8
    v_exp_f32 v60, v60
    v_cvt_pk_bf16_f32 v82, v56, v57
    v_exp_f32 v61, v61
    v_exp_f32 v62, v62
    v_cvt_pk_bf16_f32 v83, v58, v59
    v_exp_f32 v63, v63
    v_mfma_f32_32x32x16_bf16 v[44:59], v[20:23], v[4:7], 0
    ds_read_b64 v[28:29], v116 offset:12800
    v_exp_f32 v64, v64
    v_cvt_pk_bf16_f32 v76, v60, v61
    v_exp_f32 v65, v65
    v_exp_f32 v66, v66
    v_cvt_pk_bf16_f32 v77, v62, v63
    v_exp_f32 v67, v67
    v_mfma_f32_32x32x8bf16_1k v[44:59], v[24:25], v[8:9], v[44:59]
    ds_read_b64 v[30:31], v116 offset:13056
    v_exp_f32 v68, v68
    v_cvt_pk_bf16_f32 v78, v64, v65
    v_exp_f32 v69, v69
    v_exp_f32 v70, v70
    v_cvt_pk_bf16_f32 v79, v66, v67
    v_exp_f32 v71, v71
    v_mfma_f32_32x32x16_bf16 v[84:99], v[128:131], v[80:83], v[84:99]
    ds_read_b64 v[32:33], v116 offset:13824
    v_exp_f32 v72, v72
    v_cvt_pk_bf16_f32 v80, v68, v69
    v_exp_f32 v73, v73
    v_exp_f32 v74, v74
    v_cvt_pk_bf16_f32 v81, v70, v71
    v_exp_f32 v75, v75
    v_mfma_f32_32x32x16_bf16 v[100:115], v[36:39], v[76:79], v[100:115]
    s_mov_b64 exec, s[92:93]
    ds_read_b128 v[36:39], v117 offset:10240
    ds_read_b128 v[40:43], v117 offset:10880
    s_mov_b64 exec, -1
    buffer_load_dwordx4 v[252:255], v119, s[32:35], s55 offen sc1
    s_add_u32 s55, s55, s9
    s_waitcnt vmcnt(13)
    s_barrier
    s_cmp_ge_u32 s3, 4
    s_cbranch_scc1 L_p2_prh20
    s_setprio 2
L_p2_prh20:
    s_add_u32 s44, s24, 0x1700000
    s_addc_u32 s45, s25, 0
    s_mov_b32 s46, 0xc8000
    s_mov_b32 s47, 0x20000
    s_and_b32 s56, s3, 3
    s_mul_i32 s57, s56, 40
    s_and_b32 s58, s48, 7
    s_mul_i32 s58, s58, 5
    s_add_u32 s57, s57, s58
    s_cmp_lt_u32 s3, 4
    s_cselect_b32 s58, 3, 0
    s_add_u32 s57, s57, s58
    s_lshl_b32 s54, s57, 10
    v_lshlrev_b32 v118, 4, v1
    s_sub_u32 s59, s3, 4
    s_mul_i32 s59, s59, 15360
    s_cmp_eq_u32 s3, 7
    s_cselect_b32 s59, 81920, s59
    s_mul_i32 s60, s3, 10240
    s_add_u32 s60, s60, 97280
    s_cmp_eq_u32 s3, 3
    s_cselect_b32 s60, 46080, s60
    s_cmp_lt_u32 s3, 4
    s_cselect_b32 s63, s60, s59
    s_mov_b32 s62, s63
    s_cmp_eq_u32 s3, 3
    s_cselect_b32 s64, 122880, s63
    s_mov_b32 s51, 1024
    s_cselect_b32 s53, 77824, s51
    s_cmp_lt_u32 s3, 4
    s_mov_b32 s6, 1024
    s_mov_b32 s7, 1024
    s_cselect_b32 s7, 162816, s7
    s_mov_b32 s8, 161792
    s_cselect_b32 s8, 1024, s8
    s_mov_b32 s9, 1024
    s_cselect_b32 s9, 162816, s9
    s_mov_b32 s16, 1024
    s_mov_b32 s17, 161792
    s_cselect_b32 s17, 162816, s17
    v_exp_f32 v44, v44
    v_cvt_pk_bf16_f32 v82, v72, v73
    v_exp_f32 v45, v45
    v_exp_f32 v46, v46
    v_cvt_pk_bf16_f32 v83, v74, v75
    v_exp_f32 v47, v47
    v_mfma_f32_32x32x16_bf16 v[60:75], v[20:23], v[12:15], 0
    v_exp_f32 v48, v48
    v_cvt_pk_bf16_f32 v76, v44, v45
    v_exp_f32 v49, v49
    v_exp_f32 v50, v50
    v_cvt_pk_bf16_f32 v77, v46, v47
    v_exp_f32 v51, v51
    v_mfma_f32_32x32x8bf16_1k v[60:75], v[24:25], v[16:17], v[60:75]
    v_exp_f32 v52, v52
    v_cvt_pk_bf16_f32 v78, v48, v49
    v_exp_f32 v53, v53
    v_exp_f32 v54, v54
    v_cvt_pk_bf16_f32 v79, v50, v51
    v_exp_f32 v55, v55
    v_mfma_f32_32x32x16_bf16 v[100:115], v[128:131], v[80:83], v[100:115]
    v_exp_f32 v56, v56
    v_cvt_pk_bf16_f32 v80, v52, v53
    v_exp_f32 v57, v57
    v_exp_f32 v58, v58
    v_cvt_pk_bf16_f32 v81, v54, v55
    v_exp_f32 v59, v59
    s_waitcnt lgkmcnt(0)
    v_mfma_f32_32x32x16_bf16 v[84:99], v[36:39], v[76:79], v[84:99]
    s_mov_b32 m0, s63
    s_add_u32 s63, s63, s51
    buffer_load_dwordx4 v118, s[44:47], s54 offen sc1 lds
    s_add_u32 s54, s54, s6
    s_mov_b32 m0, s63
    s_add_u32 s63, s63, s51
    buffer_load_dwordx4 v118, s[44:47], s54 offen sc1 lds
    s_add_u32 s54, s54, s7
    v_exp_f32 v60, v60
    v_cvt_pk_bf16_f32 v82, v56, v57
    v_exp_f32 v61, v61
    v_exp_f32 v62, v62
    v_cvt_pk_bf16_f32 v83, v58, v59
    v_exp_f32 v63, v63
    v_mfma_f32_32x32x16_bf16 v[44:59], v[28:31], v[4:7], 0
    ds_read_b64 v[20:21], v116 offset:15360
    v_exp_f32 v64, v64
    v_cvt_pk_bf16_f32 v76, v60, v61
    v_exp_f32 v65, v65
    v_exp_f32 v66, v66
    v_cvt_pk_bf16_f32 v77, v62, v63
    v_exp_f32 v67, v67
    v_mfma_f32_32x32x8bf16_1k v[44:59], v[32:33], v[8:9], v[44:59]
    ds_read_b64 v[22:23], v116 offset:15616
    v_exp_f32 v68, v68
    v_cvt_pk_bf16_f32 v78, v64, v65
    v_exp_f32 v69, v69
    v_exp_f32 v70, v70
    v_cvt_pk_bf16_f32 v79, v66, v67
    v_exp_f32 v71, v71
    v_mfma_f32_32x32x16_bf16 v[84:99], v[40:43], v[80:83], v[84:99]
    ds_read_b64 v[24:25], v116 offset:16384
    v_exp_f32 v72, v72
    v_cvt_pk_bf16_f32 v80, v68, v69
    v_exp_f32 v73, v73
    v_exp_f32 v74, v74
    v_cvt_pk_bf16_f32 v81, v70, v71
    v_exp_f32 v75, v75
    v_mfma_f32_32x32x16_bf16 v[100:115], v[36:39], v[76:79], v[100:115]
    s_mov_b64 exec, s[92:93]
    ds_read_b128 v[36:39], v117 offset:12800
    ds_read_b128 v[128:131], v117 offset:13440
    s_mov_b64 exec, -1
    s_mov_b32 m0, s63
    s_add_u32 s63, s63, s51
    buffer_load_dwordx4 v118, s[44:47], s54 offen sc1 lds
    s_add_u32 s54, s54, s8
    s_mov_b32 m0, s63
    s_add_u32 s63, s63, s51
    buffer_load_dwordx4 v118, s[44:47], s54 offen sc1 lds
    s_add_u32 s54, s54, s9
    v_exp_f32 v44, v44
    v_cvt_pk_bf16_f32 v82, v72, v73
    v_exp_f32 v45, v45
    v_exp_f32 v46, v46
    v_cvt_pk_bf16_f32 v83, v74, v75
    v_exp_f32 v47, v47
    v_mfma_f32_32x32x16_bf16 v[60:75], v[28:31], v[12:15], 0
    v_exp_f32 v48, v48
    v_cvt_pk_bf16_f32 v76, v44, v45
    v_exp_f32 v49, v49
    v_exp_f32 v50, v50
    v_cvt_pk_bf16_f32 v77, v46, v47
    v_exp_f32 v51, v51
    v_mfma_f32_32x32x8bf16_1k v[60:75], v[32:33], v[16:17], v[60:75]
    v_exp_f32 v52, v52
    v_cvt_pk_bf16_f32 v78, v48, v49
    v_exp_f32 v53, v53
    v_exp_f32 v54, v54
    v_cvt_pk_bf16_f32 v79, v50, v51
    v_exp_f32 v55, v55
    v_mfma_f32_32x32x16_bf16 v[100:115], v[40:43], v[80:83], v[100:115]
    v_exp_f32 v56, v56
    v_cvt_pk_bf16_f32 v80, v52, v53
    v_exp_f32 v57, v57
    v_exp_f32 v58, v58
    v_cvt_pk_bf16_f32 v81, v54, v55
    v_exp_f32 v59, v59
    s_waitcnt lgkmcnt(0)
    v_mfma_f32_32x32x16_bf16 v[84:99], v[36:39], v[76:79], v[84:99]
    s_mov_b32 m0, s63
    s_add_u32 s63, s63, s53
    buffer_load_dwordx4 v118, s[44:47], s54 offen sc1 lds
    s_add_u32 s54, s54, s16
    s_mov_b32 m0, s63
    s_add_u32 s63, s63, s51
    buffer_load_dwordx4 v118, s[44:47], s54 offen sc1 lds
    s_add_u32 s54, s54, s17
    v_exp_f32 v60, v60
    v_cvt_pk_bf16_f32 v82, v56, v57
    v_exp_f32 v61, v61
    v_exp_f32 v62, v62
    v_cvt_pk_bf16_f32 v83, v58, v59
    v_exp_f32 v63, v63
    v_mfma_f32_32x32x16_bf16 v[44:59], v[20:23], v[4:7], 0
    ds_read_b64 v[28:29], v116 offset:17920
    v_exp_f32 v64, v64
    v_cvt_pk_bf16_f32 v76, v60, v61
    v_exp_f32 v65, v65
    v_exp_f32 v66, v66
    v_cvt_pk_bf16_f32 v77, v62, v63
    v_exp_f32 v67, v67
    v_mfma_f32_32x32x8bf16_1k v[44:59], v[24:25], v[8:9], v[44:59]
    ds_read_b64 v[30:31], v116 offset:18176
    v_exp_f32 v68, v68
    v_cvt_pk_bf16_f32 v78, v64, v65
    v_exp_f32 v69, v69
    v_exp_f32 v70, v70
    v_cvt_pk_bf16_f32 v79, v66, v67
    v_exp_f32 v71, v71
    v_mfma_f32_32x32x16_bf16 v[84:99], v[128:131], v[80:83], v[84:99]
    ds_read_b64 v[32:33], v116 offset:18944
    v_exp_f32 v72, v72
    v_cvt_pk_bf16_f32 v80, v68, v69
    v_exp_f32 v73, v73
    v_exp_f32 v74, v74
    v_cvt_pk_bf16_f32 v81, v70, v71
    v_exp_f32 v75, v75
    v_mfma_f32_32x32x16_bf16 v[100:115], v[36:39], v[76:79], v[100:115]
    s_mov_b64 exec, s[92:93]
    ds_read_b128 v[36:39], v117 offset:15360
    ds_read_b128 v[40:43], v117 offset:16000
    s_mov_b64 exec, -1
    s_mov_b32 m0, s63
    s_add_u32 s63, s63, s51
    buffer_load_dwordx4 v118, s[44:47], s54 offen sc1 lds
    s_add_u32 s54, s54, s6
    s_mov_b32 m0, s63
    s_add_u32 s63, s63, s51
    buffer_load_dwordx4 v118, s[44:47], s54 offen sc1 lds
    s_add_u32 s54, s54, s7
    v_exp_f32 v44, v44
    v_cvt_pk_bf16_f32 v82, v72, v73
    v_exp_f32 v45, v45
    v_exp_f32 v46, v46
    v_cvt_pk_bf16_f32 v83, v74, v75
    v_exp_f32 v47, v47
    v_mfma_f32_32x32x16_bf16 v[60:75], v[20:23], v[12:15], 0
    v_exp_f32 v48, v48
    v_cvt_pk_bf16_f32 v76, v44, v45
    v_exp_f32 v49, v49
    v_exp_f32 v50, v50
    v_cvt_pk_bf16_f32 v77, v46, v47
    v_exp_f32 v51, v51
    v_mfma_f32_32x32x8bf16_1k v[60:75], v[24:25], v[16:17], v[60:75]
    v_exp_f32 v52, v52
    v_cvt_pk_bf16_f32 v78, v48, v49
    v_exp_f32 v53, v53
    v_exp_f32 v54, v54
    v_cvt_pk_bf16_f32 v79, v50, v51
    v_exp_f32 v55, v55
    v_mfma_f32_32x32x16_bf16 v[100:115], v[128:131], v[80:83], v[100:115]
    v_exp_f32 v56, v56
    v_cvt_pk_bf16_f32 v80, v52, v53
    v_exp_f32 v57, v57
    v_exp_f32 v58, v58
    v_cvt_pk_bf16_f32 v81, v54, v55
    v_exp_f32 v59, v59
    s_waitcnt lgkmcnt(0)
    v_mfma_f32_32x32x16_bf16 v[84:99], v[36:39], v[76:79], v[84:99]
    s_mov_b32 m0, s63
    s_add_u32 s63, s63, s51
    buffer_load_dwordx4 v118, s[44:47], s54 offen sc1 lds
    s_add_u32 s54, s54, s8
    s_mov_b32 m0, s63
    s_add_u32 s63, s63, s51
    buffer_load_dwordx4 v118, s[44:47], s54 offen sc1 lds
    s_add_u32 s54, s54, s9
    v_exp_f32 v60, v60
    v_cvt_pk_bf16_f32 v82, v56, v57
    v_exp_f32 v61, v61
    v_exp_f32 v62, v62
    v_cvt_pk_bf16_f32 v83, v58, v59
    v_exp_f32 v63, v63
    v_mfma_f32_32x32x16_bf16 v[44:59], v[28:31], v[4:7], 0
    ds_read_b64 v[20:21], v116 offset:20480
    v_exp_f32 v64, v64
    v_cvt_pk_bf16_f32 v76, v60, v61
    v_exp_f32 v65, v65
    v_exp_f32 v66, v66
    v_cvt_pk_bf16_f32 v77, v62, v63
    v_exp_f32 v67, v67
    v_mfma_f32_32x32x8bf16_1k v[44:59], v[32:33], v[8:9], v[44:59]
    ds_read_b64 v[22:23], v116 offset:20736
    v_exp_f32 v68, v68
    v_cvt_pk_bf16_f32 v78, v64, v65
    v_exp_f32 v69, v69
    v_exp_f32 v70, v70
    v_cvt_pk_bf16_f32 v79, v66, v67
    v_exp_f32 v71, v71
    v_mfma_f32_32x32x16_bf16 v[84:99], v[40:43], v[80:83], v[84:99]
    ds_read_b64 v[24:25], v116 offset:21504
    v_exp_f32 v72, v72
    v_cvt_pk_bf16_f32 v80, v68, v69
    v_exp_f32 v73, v73
    v_exp_f32 v74, v74
    v_cvt_pk_bf16_f32 v81, v70, v71
    v_exp_f32 v75, v75
    v_mfma_f32_32x32x16_bf16 v[100:115], v[36:39], v[76:79], v[100:115]
    s_mov_b64 exec, s[92:93]
    ds_read_b128 v[36:39], v117 offset:17920
    ds_read_b128 v[128:131], v117 offset:18560
    s_mov_b64 exec, -1
    s_mov_b32 m0, s63
    s_add_u32 s63, s63, s51
    s_cmp_lt_u32 s3, 4
    s_cbranch_scc1 L_wo_sk10
    buffer_load_dwordx4 v118, s[44:47], s54 offen sc1 lds
L_wo_sk10:
    s_add_u32 s54, s54, s16
    s_mov_b32 m0, s63
    s_add_u32 s63, s63, s51
    s_cmp_lt_u32 s3, 4
    s_cbranch_scc1 L_wo_sk11
    buffer_load_dwordx4 v118, s[44:47], s54 offen sc1 lds
L_wo_sk11:
    s_add_u32 s54, s54, s17
    v_exp_f32 v44, v44
    v_cvt_pk_bf16_f32 v82, v72, v73
    v_exp_f32 v45, v45
    v_exp_f32 v46, v46
    v_cvt_pk_bf16_f32 v83, v74, v75
    v_exp_f32 v47, v47
    v_mfma_f32_32x32x16_bf16 v[60:75], v[28:31], v[12:15], 0
    v_exp_f32 v48, v48
    v_cvt_pk_bf16_f32 v76, v44, v45
    v_exp_f32 v49, v49
    v_exp_f32 v50, v50
    v_cvt_pk_bf16_f32 v77, v46, v47
    v_exp_f32 v51, v51
    v_mfma_f32_32x32x8bf16_1k v[60:75], v[32:33], v[16:17], v[60:75]
    v_exp_f32 v52, v52
    v_cvt_pk_bf16_f32 v78, v48, v49
    v_exp_f32 v53, v53
    v_exp_f32 v54, v54
    v_cvt_pk_bf16_f32 v79, v50, v51
    v_exp_f32 v55, v55
    v_mfma_f32_32x32x16_bf16 v[100:115], v[40:43], v[80:83], v[100:115]
    v_exp_f32 v56, v56
    v_cvt_pk_bf16_f32 v80, v52, v53
    v_exp_f32 v57, v57
    v_exp_f32 v58, v58
    v_cvt_pk_bf16_f32 v81, v54, v55
    v_exp_f32 v59, v59
    s_waitcnt lgkmcnt(0)
    v_mfma_f32_32x32x16_bf16 v[84:99], v[36:39], v[76:79], v[84:99]
    s_mov_b32 m0, s63
    s_add_u32 s63, s63, s51
    s_cmp_lt_u32 s3, 4
    s_cbranch_scc1 L_wo_sk12
    buffer_load_dwordx4 v118, s[44:47], s54 offen sc1 lds
L_wo_sk12:
    s_add_u32 s54, s54, s6
    s_mov_b32 m0, s63
    s_add_u32 s63, s63, s51
    s_cmp_lt_u32 s3, 4
    s_cbranch_scc1 L_wo_sk13
    buffer_load_dwordx4 v118, s[44:47], s54 offen sc1 lds
L_wo_sk13:
    s_add_u32 s54, s54, s7
    v_exp_f32 v60, v60
    v_cvt_pk_bf16_f32 v82, v56, v57
    v_exp_f32 v61, v61
    v_exp_f32 v62, v62
    v_cvt_pk_bf16_f32 v83, v58, v59
    v_exp_f32 v63, v63
    v_mfma_f32_32x32x16_bf16 v[44:59], v[20:23], v[4:7], 0
    ds_read_b64 v[28:29], v116 offset:23040
    v_exp_f32 v64, v64
    v_cvt_pk_bf16_f32 v76, v60, v61
    v_exp_f32 v65, v65
    v_exp_f32 v66, v66
    v_cvt_pk_bf16_f32 v77, v62, v63
    v_exp_f32 v67, v67
    v_mfma_f32_32x32x8bf16_1k v[44:59], v[24:25], v[8:9], v[44:59]
    ds_read_b64 v[30:31], v116 offset:23296
    v_exp_f32 v68, v68
    v_cvt_pk_bf16_f32 v78, v64, v65
    v_exp_f32 v69, v69
    v_exp_f32 v70, v70
    v_cvt_pk_bf16_f32 v79, v66, v67
    v_exp_f32 v71, v71
    v_mfma_f32_32x32x16_bf16 v[84:99], v[128:131], v[80:83], v[84:99]
    ds_read_b64 v[32:33], v116 offset:24064
    v_exp_f32 v72, v72
    v_cvt_pk_bf16_f32 v80, v68, v69
    v_exp_f32 v73, v73
    v_exp_f32 v74, v74
    v_cvt_pk_bf16_f32 v81, v70, v71
    v_exp_f32 v75, v75
    v_mfma_f32_32x32x16_bf16 v[100:115], v[36:39], v[76:79], v[100:115]
    s_mov_b64 exec, s[92:93]
    ds_read_b128 v[36:39], v117 offset:20480
    ds_read_b128 v[40:43], v117 offset:21120
    s_mov_b64 exec, -1
    s_mov_b32 m0, s63
    s_add_u32 s63, s63, s51
    s_cmp_lt_u32 s3, 4
    s_cbranch_scc1 L_wo_sk14
    buffer_load_dwordx4 v118, s[44:47], s54 offen sc1 lds
L_wo_sk14:
    s_add_u32 s54, s54, s8
    v_exp_f32 v44, v44
    v_cvt_pk_bf16_f32 v82, v72, v73
    v_exp_f32 v45, v45
    v_exp_f32 v46, v46
    v_cvt_pk_bf16_f32 v83, v74, v75
    v_exp_f32 v47, v47
    v_mfma_f32_32x32x16_bf16 v[60:75], v[20:23], v[12:15], 0
    v_exp_f32 v48, v48
    v_cvt_pk_bf16_f32 v76, v44, v45
    v_exp_f32 v49, v49
    v_exp_f32 v50, v50
    v_cvt_pk_bf16_f32 v77, v46, v47
    v_exp_f32 v51, v51
    v_mfma_f32_32x32x8bf16_1k v[60:75], v[24:25], v[16:17], v[60:75]
    v_exp_f32 v52, v52
    v_cvt_pk_bf16_f32 v78, v48, v49
    v_exp_f32 v53, v53
    v_exp_f32 v54, v54
    v_cvt_pk_bf16_f32 v79, v50, v51
    v_exp_f32 v55, v55
    v_mfma_f32_32x32x16_bf16 v[100:115], v[128:131], v[80:83], v[100:115]
    v_exp_f32 v56, v56
    v_cvt_pk_bf16_f32 v80, v52, v53
    v_exp_f32 v57, v57
    v_exp_f32 v58, v58
    v_cvt_pk_bf16_f32 v81, v54, v55
    v_exp_f32 v59, v59
    s_waitcnt lgkmcnt(0)
    v_mfma_f32_32x32x16_bf16 v[84:99], v[36:39], v[76:79], v[84:99]
    s_mov_b32 s36, s12
    s_mov_b32 s37, s13
    s_mov_b32 s38, 0x21c000
    s_mov_b32 s39, 0x20000
    s_mul_i32 s56, s48, 540
    s_lshl_b32 s57, s3, 6
    s_add_u32 s56, s56, s57
    v_add_u32 v133, s56, v1
    v_lshlrev_b32 v133, 7, v133
    buffer_load_dword v134, v133, s[36:39], 0 offen
    s_cmp_lg_u32 s3, 0
    s_cbranch_scc1 L_w1w_skipu
    s_mov_b64 exec, 0xfffffff
    s_mov_b32 s57, 65536
    buffer_load_dword v134, v133, s[36:39], s57 offen
    s_mov_b64 exec, -1
    v_lshlrev_b32 v135, 7, v1
    s_mov_b32 s36, s14
    s_mov_b32 s37, s15
    s_mov_b32 s38, 0xd80
    s_mov_b32 s39, 0x20000
    buffer_load_dword v134, v135, s[36:39], 0 offen
    s_mov_b32 s36, s18
    s_mov_b32 s37, s19
    s_mov_b32 s38, 0x500
    s_mov_b32 s39, 0x20000
    buffer_load_dword v134, v135, s[36:39], 0 offen
L_w1w_skipu:
    v_exp_f32 v60, v60
    v_cvt_pk_bf16_f32 v82, v56, v57
    v_exp_f32 v61, v61
    v_exp_f32 v62, v62
    v_cvt_pk_bf16_f32 v83, v58, v59
    v_exp_f32 v63, v63
    v_mfma_f32_32x32x16_bf16 v[44:59], v[28:31], v[4:7], 0
    ds_read_b64 v[20:21], v116 offset:25600
    v_exp_f32 v64, v64
    v_cvt_pk_bf16_f32 v76, v60, v61
    v_exp_f32 v65, v65
    v_exp_f32 v66, v66
    v_cvt_pk_bf16_f32 v77, v62, v63
    v_exp_f32 v67, v67
    v_mfma_f32_32x32x8bf16_1k v[44:59], v[32:33], v[8:9], v[44:59]
    ds_read_b64 v[22:23], v116 offset:25856
    v_exp_f32 v68, v68
    v_cvt_pk_bf16_f32 v78, v64, v65
    v_exp_f32 v69, v69
    v_exp_f32 v70, v70
    v_cvt_pk_bf16_f32 v79, v66, v67
    v_exp_f32 v71, v71
    v_mfma_f32_32x32x16_bf16 v[84:99], v[40:43], v[80:83], v[84:99]
    ds_read_b64 v[24:25], v116 offset:26624
    v_exp_f32 v72, v72
    v_cvt_pk_bf16_f32 v80, v68, v69
    v_exp_f32 v73, v73
    v_exp_f32 v74, v74
    v_cvt_pk_bf16_f32 v81, v70, v71
    v_exp_f32 v75, v75
    v_mfma_f32_32x32x16_bf16 v[100:115], v[36:39], v[76:79], v[100:115]
    s_mov_b64 exec, s[92:93]
    ds_read_b128 v[36:39], v117 offset:23040
    ds_read_b128 v[128:131], v117 offset:23680
    s_mov_b64 exec, -1
    v_exp_f32 v44, v44
    v_cvt_pk_bf16_f32 v82, v72, v73
    v_exp_f32 v45, v45
    v_exp_f32 v46, v46
    v_cvt_pk_bf16_f32 v83, v74, v75
    v_exp_f32 v47, v47
    v_mfma_f32_32x32x16_bf16 v[60:75], v[28:31], v[12:15], 0
    v_exp_f32 v48, v48
    v_cvt_pk_bf16_f32 v76, v44, v45
    v_exp_f32 v49, v49
    v_exp_f32 v50, v50
    v_cvt_pk_bf16_f32 v77, v46, v47
    v_exp_f32 v51, v51
    v_mfma_f32_32x32x8bf16_1k v[60:75], v[32:33], v[16:17], v[60:75]
    v_exp_f32 v52, v52
    v_cvt_pk_bf16_f32 v78, v48, v49
    v_exp_f32 v53, v53
    v_exp_f32 v54, v54
    v_cvt_pk_bf16_f32 v79, v50, v51
    v_exp_f32 v55, v55
    v_mfma_f32_32x32x16_bf16 v[100:115], v[40:43], v[80:83], v[100:115]
    v_exp_f32 v56, v56
    v_cvt_pk_bf16_f32 v80, v52, v53
    v_exp_f32 v57, v57
    v_exp_f32 v58, v58
    v_cvt_pk_bf16_f32 v81, v54, v55
    v_exp_f32 v59, v59
    s_waitcnt lgkmcnt(0)
    v_mfma_f32_32x32x16_bf16 v[84:99], v[36:39], v[76:79], v[84:99]
    v_exp_f32 v60, v60
    v_cvt_pk_bf16_f32 v82, v56, v57
    v_exp_f32 v61, v61
    v_exp_f32 v62, v62
    v_cvt_pk_bf16_f32 v83, v58, v59
    v_exp_f32 v63, v63
    v_mfma_f32_32x32x16_bf16 v[44:59], v[20:23], v[4:7], 0
    ds_read_b64 v[28:29], v116 offset:28160
    v_exp_f32 v64, v64
    v_cvt_pk_bf16_f32 v76, v60, v61
    v_exp_f32 v65, v65
    v_exp_f32 v66, v66
    v_cvt_pk_bf16_f32 v77, v62, v63
    v_exp_f32 v67, v67
    v_mfma_f32_32x32x8bf16_1k v[44:59], v[24:25], v[8:9], v[44:59]
    ds_read_b64 v[30:31], v116 offset:28416
    v_exp_f32 v68, v68
    v_cvt_pk_bf16_f32 v78, v64, v65
    v_exp_f32 v69, v69
    v_exp_f32 v70, v70
    v_cvt_pk_bf16_f32 v79, v66, v67
    v_exp_f32 v71, v71
    v_mfma_f32_32x32x16_bf16 v[84:99], v[128:131], v[80:83], v[84:99]
    ds_read_b64 v[32:33], v116 offset:29184
    v_exp_f32 v72, v72
    v_cvt_pk_bf16_f32 v80, v68, v69
    v_exp_f32 v73, v73
    v_exp_f32 v74, v74
    v_cvt_pk_bf16_f32 v81, v70, v71
    v_exp_f32 v75, v75
    v_mfma_f32_32x32x16_bf16 v[100:115], v[36:39], v[76:79], v[100:115]
    s_mov_b64 exec, s[92:93]
    ds_read_b128 v[36:39], v117 offset:25600
    ds_read_b128 v[40:43], v117 offset:26240
    s_mov_b64 exec, -1
    v_exp_f32 v44, v44
    v_cvt_pk_bf16_f32 v82, v72, v73
    v_exp_f32 v45, v45
    v_exp_f32 v46, v46
    v_cvt_pk_bf16_f32 v83, v74, v75
    v_exp_f32 v47, v47
    v_mfma_f32_32x32x16_bf16 v[60:75], v[20:23], v[12:15], 0
    v_exp_f32 v48, v48
    v_cvt_pk_bf16_f32 v76, v44, v45
    v_exp_f32 v49, v49
    v_exp_f32 v50, v50
    v_cvt_pk_bf16_f32 v77, v46, v47
    v_exp_f32 v51, v51
    v_mfma_f32_32x32x8bf16_1k v[60:75], v[24:25], v[16:17], v[60:75]
    v_exp_f32 v52, v52
    v_cvt_pk_bf16_f32 v78, v48, v49
    v_exp_f32 v53, v53
    v_exp_f32 v54, v54
    v_cvt_pk_bf16_f32 v79, v50, v51
    v_exp_f32 v55, v55
    v_mfma_f32_32x32x16_bf16 v[100:115], v[128:131], v[80:83], v[100:115]
    v_exp_f32 v56, v56
    v_cvt_pk_bf16_f32 v80, v52, v53
    v_exp_f32 v57, v57
    v_exp_f32 v58, v58
    v_cvt_pk_bf16_f32 v81, v54, v55
    v_exp_f32 v59, v59
    s_waitcnt lgkmcnt(0)
    v_mfma_f32_32x32x16_bf16 v[84:99], v[36:39], v[76:79], v[84:99]
    s_cmp_eq_u32 s11, 0
    s_cbranch_scc1 L_dstw_skipu
    s_mov_b32 s36, s24
    s_mov_b32 s37, s25
    s_mov_b32 s38, 0x1b00000
    s_mov_b32 s39, 0x20000
    s_lshl_b32 s56, s3, 6
    v_add_u32 v133, s56, v1
    s_mul_i32 s56, s27, 2560
    s_mul_i32 s57, s48, 80
    s_add_u32 s56, s56, s57
    s_add_u32 s56, s56, 106496
    s_mul_i32 s57, s27, 6912
    s_mul_i32 s58, s48, 216
    s_add_u32 s57, s57, s58
    s_add_u32 s57, s57, 130992
    s_lshl_b32 s58, s27, 8
    s_lshl_b32 s59, s48, 3
    s_add_u32 s58, s58, s59
    s_add_u32 s58, s58, 5848
    v_mov_b32 v135, s58
    v_mov_b32 v134, s57
    v_cmp_gt_u32 vcc, 296, v133
    s_nop 1
    v_cndmask_b32 v135, v135, v134, vcc
    v_mov_b32 v134, s56
    v_cmp_gt_u32 vcc, 80, v133
    s_nop 1
    v_cndmask_b32 v135, v135, v134, vcc
    v_add_u32 v135, v135, v133
    v_lshlrev_b32 v135, 7, v135
    v_cmp_gt_u32 vcc, 304, v133
    s_and_saveexec_b64 s[90:91], vcc
    s_cbranch_execz L_dstw_skipux
    buffer_load_dword v134, v135, s[36:39], 0 offen
L_dstw_skipux:
    s_mov_b64 exec, -1
L_dstw_skipu:
    v_exp_f32 v60, v60
    v_cvt_pk_bf16_f32 v82, v56, v57
    v_exp_f32 v61, v61
    v_exp_f32 v62, v62
    v_cvt_pk_bf16_f32 v83, v58, v59
    v_exp_f32 v63, v63
    v_mfma_f32_32x32x16_bf16 v[44:59], v[28:31], v[4:7], 0
    ds_read_b64 v[20:21], v116 offset:30720
    v_exp_f32 v64, v64
    v_cvt_pk_bf16_f32 v76, v60, v61
    v_exp_f32 v65, v65
    v_exp_f32 v66, v66
    v_cvt_pk_bf16_f32 v77, v62, v63
    v_exp_f32 v67, v67
    v_mfma_f32_32x32x8bf16_1k v[44:59], v[32:33], v[8:9], v[44:59]
    ds_read_b64 v[22:23], v116 offset:30976
    v_exp_f32 v68, v68
    v_cvt_pk_bf16_f32 v78, v64, v65
    v_exp_f32 v69, v69
    v_exp_f32 v70, v70
    v_cvt_pk_bf16_f32 v79, v66, v67
    v_exp_f32 v71, v71
    v_mfma_f32_32x32x16_bf16 v[84:99], v[40:43], v[80:83], v[84:99]
    ds_read_b64 v[24:25], v116 offset:31744
    v_exp_f32 v72, v72
    v_cvt_pk_bf16_f32 v80, v68, v69
    v_exp_f32 v73, v73
    v_exp_f32 v74, v74
    v_cvt_pk_bf16_f32 v81, v70, v71
    v_exp_f32 v75, v75
    v_mfma_f32_32x32x16_bf16 v[100:115], v[36:39], v[76:79], v[100:115]
    s_mov_b64 exec, s[92:93]
    ds_read_b128 v[36:39], v117 offset:28160
    ds_read_b128 v[128:131], v117 offset:28800
    s_mov_b64 exec, -1
    v_exp_f32 v44, v44
    v_cvt_pk_bf16_f32 v82, v72, v73
    v_exp_f32 v45, v45
    v_exp_f32 v46, v46
    v_cvt_pk_bf16_f32 v83, v74, v75
    v_exp_f32 v47, v47
    v_mfma_f32_32x32x16_bf16 v[60:75], v[28:31], v[12:15], 0
    v_exp_f32 v48, v48
    v_cvt_pk_bf16_f32 v76, v44, v45
    v_exp_f32 v49, v49
    v_exp_f32 v50, v50
    v_cvt_pk_bf16_f32 v77, v46, v47
    v_exp_f32 v51, v51
    v_mfma_f32_32x32x8bf16_1k v[60:75], v[32:33], v[16:17], v[60:75]
    v_exp_f32 v52, v52
    v_cvt_pk_bf16_f32 v78, v48, v49
    v_exp_f32 v53, v53
    v_exp_f32 v54, v54
    v_cvt_pk_bf16_f32 v79, v50, v51
    v_exp_f32 v55, v55
    v_mfma_f32_32x32x16_bf16 v[100:115], v[40:43], v[80:83], v[100:115]
    v_exp_f32 v56, v56
    v_cvt_pk_bf16_f32 v80, v52, v53
    v_exp_f32 v57, v57
    v_exp_f32 v58, v58
    v_cvt_pk_bf16_f32 v81, v54, v55
    v_exp_f32 v59, v59
    s_waitcnt lgkmcnt(0)
    v_mfma_f32_32x32x16_bf16 v[84:99], v[36:39], v[76:79], v[84:99]
    v_exp_f32 v60, v60
    v_cvt_pk_bf16_f32 v82, v56, v57
    v_exp_f32 v61, v61
    v_exp_f32 v62, v62
    v_cvt_pk_bf16_f32 v83, v58, v59
    v_exp_f32 v63, v63
    v_mfma_f32_32x32x16_bf16 v[44:59], v[20:23], v[4:7], 0
    ds_read_b64 v[28:29], v116 offset:33280
    v_exp_f32 v64, v64
    v_cvt_pk_bf16_f32 v76, v60, v61
    v_exp_f32 v65, v65
    v_exp_f32 v66, v66
    v_cvt_pk_bf16_f32 v77, v62, v63
    v_exp_f32 v67, v67
    v_mfma_f32_32x32x8bf16_1k v[44:59], v[24:25], v[8:9], v[44:59]
    ds_read_b64 v[30:31], v116 offset:33536
    v_exp_f32 v68, v68
    v_cvt_pk_bf16_f32 v78, v64, v65
    v_exp_f32 v69, v69
    v_exp_f32 v70, v70
    v_cvt_pk_bf16_f32 v79, v66, v67
    v_exp_f32 v71, v71
    v_mfma_f32_32x32x16_bf16 v[84:99], v[128:131], v[80:83], v[84:99]
    ds_read_b64 v[32:33], v116 offset:34304
    v_exp_f32 v72, v72
    v_cvt_pk_bf16_f32 v80, v68, v69
    v_exp_f32 v73, v73
    v_exp_f32 v74, v74
    v_cvt_pk_bf16_f32 v81, v70, v71
    v_exp_f32 v75, v75
    v_mfma_f32_32x32x16_bf16 v[100:115], v[36:39], v[76:79], v[100:115]
    s_mov_b64 exec, s[92:93]
    ds_read_b128 v[36:39], v117 offset:30720
    ds_read_b128 v[40:43], v117 offset:31360
    s_mov_b64 exec, -1
    v_exp_f32 v44, v44
    v_cvt_pk_bf16_f32 v82, v72, v73
    v_exp_f32 v45, v45
    v_exp_f32 v46, v46
    v_cvt_pk_bf16_f32 v83, v74, v75
    v_exp_f32 v47, v47
    v_mfma_f32_32x32x16_bf16 v[60:75], v[20:23], v[12:15], 0
    v_exp_f32 v48, v48
    v_cvt_pk_bf16_f32 v76, v44, v45
    v_exp_f32 v49, v49
    v_exp_f32 v50, v50
    v_cvt_pk_bf16_f32 v77, v46, v47
    v_exp_f32 v51, v51
    v_mfma_f32_32x32x8bf16_1k v[60:75], v[24:25], v[16:17], v[60:75]
    v_exp_f32 v52, v52
    v_cvt_pk_bf16_f32 v78, v48, v49
    v_exp_f32 v53, v53
    v_exp_f32 v54, v54
    v_cvt_pk_bf16_f32 v79, v50, v51
    v_exp_f32 v55, v55
    v_mfma_f32_32x32x16_bf16 v[100:115], v[128:131], v[80:83], v[100:115]
    v_exp_f32 v56, v56
    v_cvt_pk_bf16_f32 v80, v52, v53
    v_exp_f32 v57, v57
    v_exp_f32 v58, v58
    v_cvt_pk_bf16_f32 v81, v54, v55
    v_exp_f32 v59, v59
    s_waitcnt lgkmcnt(0)
    v_mfma_f32_32x32x16_bf16 v[84:99], v[36:39], v[76:79], v[84:99]
    v_exp_f32 v60, v60
    v_cvt_pk_bf16_f32 v82, v56, v57
    v_exp_f32 v61, v61
    v_exp_f32 v62, v62
    v_cvt_pk_bf16_f32 v83, v58, v59
    v_exp_f32 v63, v63
    v_mfma_f32_32x32x16_bf16 v[44:59], v[28:31], v[4:7], 0
    ds_read_b64 v[20:21], v116 offset:35840
    v_exp_f32 v64, v64
    v_cvt_pk_bf16_f32 v76, v60, v61
    v_exp_f32 v65, v65
    v_exp_f32 v66, v66
    v_cvt_pk_bf16_f32 v77, v62, v63
    v_exp_f32 v67, v67
    v_mfma_f32_32x32x8bf16_1k v[44:59], v[32:33], v[8:9], v[44:59]
    ds_read_b64 v[22:23], v116 offset:36096
    v_exp_f32 v68, v68
    v_cvt_pk_bf16_f32 v78, v64, v65
    v_exp_f32 v69, v69
    v_exp_f32 v70, v70
    v_cvt_pk_bf16_f32 v79, v66, v67
    v_exp_f32 v71, v71
    v_mfma_f32_32x32x16_bf16 v[84:99], v[40:43], v[80:83], v[84:99]
    ds_read_b64 v[24:25], v116 offset:36864
    v_exp_f32 v72, v72
    v_cvt_pk_bf16_f32 v80, v68, v69
    v_exp_f32 v73, v73
    v_exp_f32 v74, v74
    v_cvt_pk_bf16_f32 v81, v70, v71
    v_exp_f32 v75, v75
    v_mfma_f32_32x32x16_bf16 v[100:115], v[36:39], v[76:79], v[100:115]
    s_mov_b64 exec, s[92:93]
    ds_read_b128 v[36:39], v117 offset:33280
    ds_read_b128 v[128:131], v117 offset:33920
    s_mov_b64 exec, -1
    s_cmp_ge_u32 s3, 4
    s_cbranch_scc1 L_p2_prl29
    s_setprio 0
L_p2_prl29:
    v_exp_f32 v44, v44
    v_cvt_pk_bf16_f32 v82, v72, v73
    v_exp_f32 v45, v45
    v_exp_f32 v46, v46
    v_cvt_pk_bf16_f32 v83, v74, v75
    v_exp_f32 v47, v47
    v_mfma_f32_32x32x16_bf16 v[60:75], v[28:31], v[12:15], 0
    v_exp_f32 v48, v48
    v_cvt_pk_bf16_f32 v76, v44, v45
    v_exp_f32 v49, v49
    v_exp_f32 v50, v50
    v_cvt_pk_bf16_f32 v77, v46, v47
    v_exp_f32 v51, v51
    v_mfma_f32_32x32x8bf16_1k v[60:75], v[32:33], v[16:17], v[60:75]
    v_exp_f32 v52, v52
    v_cvt_pk_bf16_f32 v78, v48, v49
    v_exp_f32 v53, v53
    v_exp_f32 v54, v54
    v_cvt_pk_bf16_f32 v79, v50, v51
    v_exp_f32 v55, v55
    v_mfma_f32_32x32x16_bf16 v[100:115], v[40:43], v[80:83], v[100:115]
    v_exp_f32 v56, v56
    v_cvt_pk_bf16_f32 v80, v52, v53
    v_exp_f32 v57, v57
    v_exp_f32 v58, v58
    v_cvt_pk_bf16_f32 v81, v54, v55
    v_exp_f32 v59, v59
    s_waitcnt lgkmcnt(0)
    v_mfma_f32_32x32x16_bf16 v[84:99], v[36:39], v[76:79], v[84:99]
    v_exp_f32 v60, v60
    v_cvt_pk_bf16_f32 v82, v56, v57
    v_exp_f32 v61, v61
    v_exp_f32 v62, v62
    v_cvt_pk_bf16_f32 v83, v58, v59
    v_exp_f32 v63, v63
    v_mfma_f32_32x32x16_bf16 v[44:59], v[20:23], v[4:7], 0
    ds_read_b64 v[28:29], v116 offset:38400
    v_exp_f32 v64, v64
    v_cvt_pk_bf16_f32 v76, v60, v61
    v_exp_f32 v65, v65
    v_exp_f32 v66, v66
    v_cvt_pk_bf16_f32 v77, v62, v63
    v_exp_f32 v67, v67
    v_mfma_f32_32x32x8bf16_1k v[44:59], v[24:25], v[8:9], v[44:59]
    ds_read_b64 v[30:31], v116 offset:38656
    v_exp_f32 v68, v68
    v_cvt_pk_bf16_f32 v78, v64, v65
    v_exp_f32 v69, v69
    v_exp_f32 v70, v70
    v_cvt_pk_bf16_f32 v79, v66, v67
    v_exp_f32 v71, v71
    v_mfma_f32_32x32x16_bf16 v[84:99], v[128:131], v[80:83], v[84:99]
    ds_read_b64 v[32:33], v116 offset:39424
    v_exp_f32 v72, v72
    v_cvt_pk_bf16_f32 v80, v68, v69
    v_exp_f32 v73, v73
    v_exp_f32 v74, v74
    v_cvt_pk_bf16_f32 v81, v70, v71
    v_exp_f32 v75, v75
    v_mfma_f32_32x32x16_bf16 v[100:115], v[36:39], v[76:79], v[100:115]
    s_mov_b64 exec, s[92:93]
    ds_read_b128 v[36:39], v117 offset:35840
    ds_read_b128 v[40:43], v117 offset:36480
    s_mov_b64 exec, -1
    v_exp_f32 v44, v44
    v_cvt_pk_bf16_f32 v82, v72, v73
    v_exp_f32 v45, v45
    v_exp_f32 v46, v46
    v_cvt_pk_bf16_f32 v83, v74, v75
    v_exp_f32 v47, v47
    v_mfma_f32_32x32x16_bf16 v[60:75], v[20:23], v[12:15], 0
    v_exp_f32 v48, v48
    v_cvt_pk_bf16_f32 v76, v44, v45
    v_exp_f32 v49, v49
    v_exp_f32 v50, v50
    v_cvt_pk_bf16_f32 v77, v46, v47
    v_exp_f32 v51, v51
    v_mfma_f32_32x32x8bf16_1k v[60:75], v[24:25], v[16:17], v[60:75]
    v_exp_f32 v52, v52
    v_cvt_pk_bf16_f32 v78, v48, v49
    v_exp_f32 v53, v53
    v_exp_f32 v54, v54
    v_cvt_pk_bf16_f32 v79, v50, v51
    v_exp_f32 v55, v55
    v_mfma_f32_32x32x16_bf16 v[100:115], v[128:131], v[80:83], v[100:115]
    v_exp_f32 v56, v56
    v_cvt_pk_bf16_f32 v80, v52, v53
    v_exp_f32 v57, v57
    v_exp_f32 v58, v58
    v_cvt_pk_bf16_f32 v81, v54, v55
    v_exp_f32 v59, v59
    s_waitcnt lgkmcnt(0)
    v_mfma_f32_32x32x16_bf16 v[84:99], v[36:39], v[76:79], v[84:99]
    v_exp_f32 v60, v60
    v_cvt_pk_bf16_f32 v82, v56, v57
    v_exp_f32 v61, v61
    v_exp_f32 v62, v62
    v_cvt_pk_bf16_f32 v83, v58, v59
    v_exp_f32 v63, v63
    v_mfma_f32_32x32x16_bf16 v[44:59], v[28:31], v[4:7], 0
    ds_read_b64 v[20:21], v116 offset:40960
    v_exp_f32 v64, v64
    v_cvt_pk_bf16_f32 v76, v60, v61
    v_exp_f32 v65, v65
    v_exp_f32 v66, v66
    v_cvt_pk_bf16_f32 v77, v62, v63
    v_exp_f32 v67, v67
    v_mfma_f32_32x32x8bf16_1k v[44:59], v[32:33], v[8:9], v[44:59]
    ds_read_b64 v[22:23], v116 offset:41216
    v_exp_f32 v68, v68
    v_cvt_pk_bf16_f32 v78, v64, v65
    v_exp_f32 v69, v69
    v_exp_f32 v70, v70
    v_cvt_pk_bf16_f32 v79, v66, v67
    v_exp_f32 v71, v71
    v_mfma_f32_32x32x16_bf16 v[84:99], v[40:43], v[80:83], v[84:99]
    ds_read_b64 v[24:25], v116 offset:41984
    v_exp_f32 v72, v72
    v_cvt_pk_bf16_f32 v80, v68, v69
    v_exp_f32 v73, v73
    v_exp_f32 v74, v74
    v_cvt_pk_bf16_f32 v81, v70, v71
    v_exp_f32 v75, v75
    v_mfma_f32_32x32x16_bf16 v[100:115], v[36:39], v[76:79], v[100:115]
    s_mov_b64 exec, s[92:93]
    ds_read_b128 v[36:39], v117 offset:38400
    ds_read_b128 v[128:131], v117 offset:39040
    s_mov_b64 exec, -1
    v_exp_f32 v44, v44
    v_cvt_pk_bf16_f32 v82, v72, v73
    v_exp_f32 v45, v45
    v_exp_f32 v46, v46
    v_cvt_pk_bf16_f32 v83, v74, v75
    v_exp_f32 v47, v47
    v_mfma_f32_32x32x16_bf16 v[60:75], v[28:31], v[12:15], 0
    v_exp_f32 v48, v48
    v_cvt_pk_bf16_f32 v76, v44, v45
    v_exp_f32 v49, v49
    v_exp_f32 v50, v50
    v_cvt_pk_bf16_f32 v77, v46, v47
    v_exp_f32 v51, v51
    v_mfma_f32_32x32x8bf16_1k v[60:75], v[32:33], v[16:17], v[60:75]
    v_exp_f32 v52, v52
    v_cvt_pk_bf16_f32 v78, v48, v49
    v_exp_f32 v53, v53
    v_exp_f32 v54, v54
    v_cvt_pk_bf16_f32 v79, v50, v51
    v_exp_f32 v55, v55
    v_mfma_f32_32x32x16_bf16 v[100:115], v[40:43], v[80:83], v[100:115]
    v_exp_f32 v56, v56
    v_cvt_pk_bf16_f32 v80, v52, v53
    v_exp_f32 v57, v57
    v_exp_f32 v58, v58
    v_cvt_pk_bf16_f32 v81, v54, v55
    v_exp_f32 v59, v59
    s_waitcnt lgkmcnt(0)
    v_mfma_f32_32x32x16_bf16 v[84:99], v[36:39], v[76:79], v[84:99]
    v_exp_f32 v60, v60
    v_cvt_pk_bf16_f32 v82, v56, v57
    v_exp_f32 v61, v61
    v_exp_f32 v62, v62
    v_cvt_pk_bf16_f32 v83, v58, v59
    v_exp_f32 v63, v63
    v_mfma_f32_32x32x16_bf16 v[44:59], v[20:23], v[4:7], 0
    ds_read_b64 v[28:29], v116 offset:43520
    v_exp_f32 v64, v64
    v_cvt_pk_bf16_f32 v76, v60, v61
    v_exp_f32 v65, v65
    v_exp_f32 v66, v66
    v_cvt_pk_bf16_f32 v77, v62, v63
    v_exp_f32 v67, v67
    v_mfma_f32_32x32x8bf16_1k v[44:59], v[24:25], v[8:9], v[44:59]
    ds_read_b64 v[30:31], v116 offset:43776
    v_exp_f32 v68, v68
    v_cvt_pk_bf16_f32 v78, v64, v65
    v_exp_f32 v69, v69
    v_exp_f32 v70, v70
    v_cvt_pk_bf16_f32 v79, v66, v67
    v_exp_f32 v71, v71
    v_mfma_f32_32x32x16_bf16 v[84:99], v[128:131], v[80:83], v[84:99]
    ds_read_b64 v[32:33], v116 offset:44544
    v_exp_f32 v72, v72
    v_cvt_pk_bf16_f32 v80, v68, v69
    v_exp_f32 v73, v73
    v_exp_f32 v74, v74
    v_cvt_pk_bf16_f32 v81, v70, v71
    v_exp_f32 v75, v75
    v_mfma_f32_32x32x16_bf16 v[100:115], v[36:39], v[76:79], v[100:115]
    s_mov_b64 exec, s[92:93]
    ds_read_b128 v[36:39], v117 offset:40960
    ds_read_b128 v[40:43], v117 offset:41600
    s_mov_b64 exec, -1
L_p2_done:
    s_setprio 0
    s_waitcnt lgkmcnt(0)
    v_cvt_pk_bf16_f32 v82, v72, v73
    v_cvt_pk_bf16_f32 v83, v74, v75
    s_nop 1
    v_mfma_f32_32x32x16_bf16 v[100:115], v[128:131], v[80:83], v[100:115]
    s_add_u32 s36, s24, 0xa00000
    s_addc_u32 s37, s25, 0
    s_mov_b32 s38, 0x280000
    s_mov_b32 s39, 0x20000
    s_mov_b32 s94, 0
    s_mov_b32 s95, 0x5d800000
    s_nop 7
    s_nop 3
    s_barrier
    s_and_b32 s56, s3, 3
    s_lshr_b32 s57, s3, 2
    s_lshl_b32 s56, s56, 1
    s_add_u32 s58, s56, s57
    s_xor_b32 s59, s58, 1
    s_mul_i32 s58, s58, 3072
    s_mul_i32 s59, s59, 3072
    s_add_u32 s58, s58, 51200
    s_add_u32 s59, s59, 51200
    v_lshlrev_b32 v120, 4, v1
    v_add_u32 v121, s58, v120
    v_add_u32 v122, s59, v120
    s_cmp_eq_u32 s57, 1
    s_cbranch_scc1 L_p2e_k1
    ds_write_b128 v121, v[100:103] offset:0
    ds_write_b128 v121, v[104:107] offset:1024
    ds_write_b128 v121, v[108:111] offset:2048
    s_branch L_p2e_j
L_p2e_k1:
    ds_write_b128 v121, v[84:87] offset:0
    ds_write_b128 v121, v[88:91] offset:1024
    ds_write_b128 v121, v[92:95] offset:2048
    v_mov_b32 v84, v100
    v_mov_b32 v85, v101
    v_mov_b32 v86, v102
    v_mov_b32 v87, v103
    v_mov_b32 v88, v104
    v_mov_b32 v89, v105
    v_mov_b32 v90, v106
    v_mov_b32 v91, v107
    v_mov_b32 v92, v108
    v_mov_b32 v93, v109
    v_mov_b32 v94, v110
    v_mov_b32 v95, v111
L_p2e_j:
    s_waitcnt lgkmcnt(0)
    s_barrier
    ds_read_b128 v[44:47], v122 offset:0
    ds_read_b128 v[48:51], v122 offset:1024
    ds_read_b128 v[52:55], v122 offset:2048
    s_waitcnt lgkmcnt(0)
    v_add_f32 v84, v84, v44
    v_add_f32 v85, v85, v45
    v_add_f32 v86, v86, v46
    v_add_f32 v87, v87, v47
    v_add_f32 v88, v88, v48
    v_add_f32 v89, v89, v49
    v_add_f32 v90, v90, v50
    v_add_f32 v91, v91, v51
    v_add_f32 v92, v92, v52
    v_add_f32 v93, v93, v53
    v_add_f32 v94, v94, v54
    v_add_f32 v95, v95, v55
L_p2_fin:
    v_mov_b32 v120, v92
    v_mov_b32 v121, v92
    s_nop 1
    v_permlane32_swap_b32 v120, v121
    v_mul_f32 v123, 0, v84
    v_fmac_f32 v123, 0, v85
    v_fmac_f32 v123, 0, v86
    v_fmac_f32 v123, 0, v87
    v_fmac_f32 v123, 0, v88
    v_fmac_f32 v123, 0, v89
    v_fmac_f32 v123, 0, v90
    v_fmac_f32 v123, 0, v91
    v_mov_b32 v124, 0
    v_fmac_f32 v124, 0, v92
    v_fmac_f32 v124, 0, v93
    v_fmac_f32 v124, 0, v94
    v_fmac_f32 v124, 0, v95
    v_cmp_le_f32 vcc, 0x21800000, v121
    v_cmp_ge_f32 s[90:91], s95, v121
    s_nop 0
    s_and_b64 vcc, vcc, s[90:91]
    v_cmp_eq_f32 s[90:91], 0, v123
    s_nop 0
    s_and_b64 vcc, vcc, s[90:91]
    v_cmp_eq_f32 s[90:91], 0, v124
    s_nop 0
    s_or_b32 s91, s91, -1
    s_and_b64 vcc, vcc, s[90:91]
    s_or_b32 vcc_lo, vcc_lo, 0
    s_cmp_eq_u32 s94, 1
    s_cbranch_scc1 L_p2_ok
    s_cmp_eq_u64 vcc, -1
    s_cbranch_scc0 L_p2_slow
L_p2_ok:
    v_rcp_f32 v122, v121
    s_nop 0
    v_mul_f32 v84, v122, v84
    v_mul_f32 v85, v122, v85
    v_mul_f32 v86, v122, v86
    v_mul_f32 v87, v122, v87
    v_mul_f32 v88, v122, v88
    v_mul_f32 v89, v122, v89
    v_mul_f32 v90, v122, v90
    v_mul_f32 v91, v122, v91
    v_mul_f32 v92, v122, v92
    v_mul_f32 v93, v122, v93
    v_mul_f32 v94, v122, v94
    v_mul_f32 v95, v122, v95
    v_cvt_pk_bf16_f32 v84, v84, v85
    v_cvt_pk_bf16_f32 v85, v86, v87
    v_cvt_pk_bf16_f32 v88, v88, v89
    v_cvt_pk_bf16_f32 v89, v90, v91
    v_cvt_pk_bf16_f32 v92, v92, v93
    v_cvt_pk_bf16_f32 v93, v94, v95
    buffer_store_dwordx2 v[84:85], v140, s[36:39], s52 offen sc1
    buffer_store_dwordx2 v[88:89], v141, s[36:39], s52 offen sc1
    s_mov_b32 exec_lo, 0xffffffff
    s_mov_b32 exec_hi, 0x0
    buffer_store_dwordx2 v[92:93], v142, s[36:39], s52 offen sc1
    s_mov_b64 exec, -1
    s_branch L_p2_end
L_p2_slow:
    s_cmp_lt_u32 s3, 4
    s_cbranch_scc1 L_p2s_q
    v_mov_b32 v4, v12
    v_mov_b32 v5, v13
    v_mov_b32 v6, v14
    v_mov_b32 v7, v15
    v_mov_b32 v8, v16
    v_mov_b32 v9, v17
    v_mov_b32 v10, v18
    v_mov_b32 v11, v19
L_p2s_q:
    v_and_b32 v120, 31, v1
    v_lshrrev_b32 v121, 5, v1
    v_lshlrev_b32 v122, 3, v120
    v_lshl_add_u32 v123, v121, 9, v122
    v_mul_u32_u24 v124, 320, v121
    v_lshl_add_u32 v124, v120, 4, v124
    v_mov_b32 v125, 0xff800000
    s_mov_b32 s57, 0
L_p2s_1:
    buffer_load_dwordx2 v[20:21], v123, s[28:31], s57 offen sc1
    buffer_load_dwordx2 v[22:23], v123, s[28:31], s57 offen offset:256 sc1
    buffer_load_dwordx2 v[24:25], v122, s[28:31], s57 offen offset:1024 sc1
    s_waitcnt vmcnt(0)
    v_mfma_f32_32x32x16_bf16 v[44:59], v[20:23], v[4:7], 0
    v_mfma_f32_32x32x16_bf16 v[44:59], v[24:27], v[8:11], v[44:59]
    s_nop 7
    s_nop 7
    v_max_f32 v125, v125, v44
    v_max_f32 v125, v125, v45
    v_max_f32 v125, v125, v46
    v_max_f32 v125, v125, v47
    v_max_f32 v125, v125, v48
    v_max_f32 v125, v125, v49
    v_max_f32 v125, v125, v50
    v_max_f32 v125, v125, v51
    v_max_f32 v125, v125, v52
    v_max_f32 v125, v125, v53
    v_max_f32 v125, v125, v54
    v_max_f32 v125, v125, v55
    v_max_f32 v125, v125, v56
    v_max_f32 v125, v125, v57
    v_max_f32 v125, v125, v58
    v_max_f32 v125, v125, v59
    s_add_u32 s57, s57, 2560
    s_cmp_lt_u32 s57, 163840
    s_cbranch_scc1 L_p2s_1
    v_mov_b32 v126, v125
    s_nop 1
    v_permlane32_swap_b32 v126, v125
    s_nop 1
    v_max_f32 v125, v125, v126
    v_mov_b32 v84, 0
    v_mov_b32 v85, 0
    v_mov_b32 v86, 0
    v_mov_b32 v87, 0
    v_mov_b32 v88, 0
    v_mov_b32 v89, 0
    v_mov_b32 v90, 0
    v_mov_b32 v91, 0
    v_mov_b32 v92, 0
    v_mov_b32 v93, 0
    v_mov_b32 v94, 0
    v_mov_b32 v95, 0
    v_mov_b32 v96, 0
    v_mov_b32 v97, 0
    v_mov_b32 v98, 0
    v_mov_b32 v99, 0
    s_mov_b32 s57, 0
L_p2s_2:
    buffer_load_dwordx2 v[20:21], v123, s[28:31], s57 offen sc1
    buffer_load_dwordx2 v[22:23], v123, s[28:31], s57 offen offset:256 sc1
    buffer_load_dwordx2 v[24:25], v122, s[28:31], s57 offen offset:1024 sc1
    s_mov_b64 exec, s[92:93]
    buffer_load_dwordx4 v[36:39], v124, s[28:31], s57 offen offset:1280 sc1
    buffer_load_dwordx4 v[40:43], v124, s[28:31], s57 offen offset:1920 sc1
    s_mov_b64 exec, -1
    s_waitcnt vmcnt(0)
    v_mfma_f32_32x32x16_bf16 v[44:59], v[20:23], v[4:7], 0
    v_mfma_f32_32x32x16_bf16 v[44:59], v[24:27], v[8:11], v[44:59]
    s_nop 7
    s_nop 7
    v_sub_f32 v44, v44, v125
    v_sub_f32 v45, v45, v125
    v_sub_f32 v46, v46, v125
    v_sub_f32 v47, v47, v125
    v_sub_f32 v48, v48, v125
    v_sub_f32 v49, v49, v125
    v_sub_f32 v50, v50, v125
    v_sub_f32 v51, v51, v125
    v_sub_f32 v52, v52, v125
    v_sub_f32 v53, v53, v125
    v_sub_f32 v54, v54, v125
    v_sub_f32 v55, v55, v125
    v_sub_f32 v56, v56, v125
    v_sub_f32 v57, v57, v125
    v_sub_f32 v58, v58, v125
    v_sub_f32 v59, v59, v125
    v_exp_f32 v44, v44
    v_exp_f32 v45, v45
    v_exp_f32 v46, v46
    v_exp_f32 v47, v47
    v_exp_f32 v48, v48
    v_exp_f32 v49, v49
    v_exp_f32 v50, v50
    v_exp_f32 v51, v51
    v_exp_f32 v52, v52
    v_exp_f32 v53, v53
    v_exp_f32 v54, v54
    v_exp_f32 v55, v55
    v_exp_f32 v56, v56
    v_exp_f32 v57, v57
    v_exp_f32 v58, v58
    v_exp_f32 v59, v59
    s_nop 0
    v_cvt_pk_bf16_f32 v76, v44, v45
    v_cvt_pk_bf16_f32 v77, v46, v47
    v_cvt_pk_bf16_f32 v78, v48, v49
    v_cvt_pk_bf16_f32 v79, v50, v51
    v_cvt_pk_bf16_f32 v80, v52, v53
    v_cvt_pk_bf16_f32 v81, v54, v55
    v_cvt_pk_bf16_f32 v82, v56, v57
    v_cvt_pk_bf16_f32 v83, v58, v59
    s_nop 1
    v_mfma_f32_32x32x16_bf16 v[84:99], v[36:39], v[76:79], v[84:99]
    v_mfma_f32_32x32x16_bf16 v[84:99], v[40:43], v[80:83], v[84:99]
    s_add_u32 s57, s57, 2560
    s_cmp_lt_u32 s57, 163840
    s_cbranch_scc1 L_p2s_2
    s_nop 7
    s_nop 7
    s_mov_b32 s94, 1
    s_branch L_p2_fin
L_p2_end:
    v_lshlrev_b32 v66, 3, v1
    v_add_u32 v66, s67, v66
    v_lshlrev_b32 v66, 7, v66
    s_lshl_b32 s57, s66, 2
    s_add_u32 s57, s57, 327680
    v_add_u32 v66, s57, v66
    v_mov_b32 v67, s26
    s_waitcnt vmcnt(0) lgkmcnt(0)
    s_barrier
    s_cmp_lg_u32 s3, 0
    s_cbranch_scc1 L_gb23_gskip0
    s_mov_b32 exec_lo, 0xffffffff
    s_mov_b32 exec_hi, 0x0
    buffer_store_dword v67, v66, s[40:43], 0 offen sc1
    s_mov_b64 exec, -1
L_gb23_gskip0:
    v_lshlrev_b32 v2, 4, v1
    v_add_u32 v84, s62, v2
    v_add_u32 v85, s64, v2
    s_cmp_ge_u32 s3, 4
    s_cbranch_scc1 L_wol_A
    ds_read_b128 v[88:91], v84 offset:0
    ds_read_b128 v[92:95], v84 offset:1024
    ds_read_b128 v[96:99], v84 offset:2048
    ds_read_b128 v[100:103], v84 offset:3072
    ds_read_b128 v[104:107], v84 offset:4096
    ds_read_b128 v[108:111], v85 offset:5120
    ds_read_b128 v[112:115], v85 offset:6144
    ds_read_b128 v[116:119], v85 offset:7168
    ds_read_b128 v[120:123], v85 offset:8192
    ds_read_b128 v[124:127], v85 offset:9216
    s_branch L_wol_J
L_wol_A:
    ds_read_b128 v[88:91], v84 offset:0
    ds_read_b128 v[92:95], v84 offset:1024
    ds_read_b128 v[96:99], v84 offset:2048
    ds_read_b128 v[100:103], v84 offset:3072
    ds_read_b128 v[104:107], v84 offset:4096
    ds_read_b128 v[108:111], v84 offset:5120
    ds_read_b128 v[112:115], v84 offset:6144
    ds_read_b128 v[116:119], v84 offset:7168
    ds_read_b128 v[120:123], v84 offset:8192
    ds_read_b128 v[124:127], v84 offset:9216
    ds_read_b128 v[128:131], v84 offset:10240
    ds_read_b128 v[132:135], v84 offset:11264
    ds_read_b128 v[136:139], v84 offset:12288
    ds_read_b128 v[140:143], v84 offset:13312
    ds_read_b128 v[144:147], v84 offset:14336
L_wol_J:
    s_waitcnt lgkmcnt(0)
    s_lshr_b32 s56, s48, 3
    s_lshl_b32 s57, s27, 2
    s_add_u32 s49, s56, s57
    s_and_b32 s50, s48, 7
    s_mul_i32 s56, s49, 81920
    s_add_u32 s56, s56, 0xa00000
    s_add_u32 s28, s24, s56
    s_addc_u32 s29, s25, 0
    s_mov_b32 s30, 81920
    s_mov_b32 s31, 0x20000
    s_lshl_b32 s62, s3, 10
    v_lshlrev_b32 v2, 4, v1
    s_and_b32 s56, s3, 3
    s_add_u32 s57, s56, 0
    s_and_b32 s57, s57, 3
    s_lshl_b32 s57, s57, 10
    s_lshl_b32 s58, s56, 12
    s_add_u32 s57, s57, s58
    v_add_u32 v84, s57, v2
    s_add_u32 s57, s56, 1
    s_and_b32 s57, s57, 3
    s_lshl_b32 s57, s57, 10
    s_lshl_b32 s58, s56, 12
    s_add_u32 s57, s57, s58
    v_add_u32 v85, s57, v2
    s_add_u32 s57, s56, 2
    s_and_b32 s57, s57, 3
    s_lshl_b32 s57, s57, 10
    s_lshl_b32 s58, s56, 12
    s_add_u32 s57, s57, s58
    v_add_u32 v86, s57, v2
    s_add_u32 s57, s56, 3
    s_and_b32 s57, s57, 3
    s_lshl_b32 s57, s57, 10
    s_lshl_b32 s58, s56, 12
    s_add_u32 s57, s57, s58
    v_add_u32 v87, s57, v2
    s_lshl_b32 s56, s49, 6
    s_and_b32 s57, s3, 3
    s_lshl_b32 s57, s57, 4
    s_add_u32 s56, s56, s57
    v_and_b32 v3, 15, v1
    v_add_u32 v3, s56, v3
    v_mul_u32_u24 v3, 1280, v3
    s_mul_i32 s56, s50, 160
    s_cmp_lt_u32 s3, 4
    s_cselect_b32 s57, 96, 0
    s_add_u32 s56, s56, s57
    v_lshrrev_b32 v64, 4, v1
    v_lshlrev_b32 v64, 3, v64
    v_add_u32 v64, s56, v64
    v_add_u32 v3, v3, v64
    s_mov_b32 s44, s4
    s_mov_b32 s45, s5
    s_mov_b32 s46, 0x280000
    s_mov_b32 s47, 0x20000
    buffer_load_dwordx2 v[52:53], v3, s[44:47], 0 offen offset:0
    buffer_load_dwordx2 v[54:55], v3, s[44:47], 0 offen offset:32
    buffer_load_dwordx2 v[56:57], v3, s[44:47], 0 offen offset:64
    v_mov_b32 v16, 0
    v_mov_b32 v17, 0
    v_mov_b32 v18, 0
    v_mov_b32 v19, 0
    v_mov_b32 v20, 0
    v_mov_b32 v21, 0
    v_mov_b32 v22, 0
    v_mov_b32 v23, 0
    v_mov_b32 v24, 0
    v_mov_b32 v25, 0
    v_mov_b32 v26, 0
    v_mov_b32 v27, 0
    v_mov_b32 v28, 0
    v_mov_b32 v29, 0
    v_mov_b32 v30, 0
    v_mov_b32 v31, 0
    v_mov_b32 v32, 0
    v_mov_b32 v33, 0
    v_mov_b32 v34, 0
    v_mov_b32 v35, 0
    v_mov_b32 v36, 0
    v_mov_b32 v37, 0
    v_mov_b32 v38, 0
    v_mov_b32 v39, 0
    v_mov_b32 v40, 0
    v_mov_b32 v41, 0
    v_mov_b32 v42, 0
    v_mov_b32 v43, 0
    v_mov_b32 v44, 0
    v_mov_b32 v45, 0
    v_mov_b32 v46, 0
    v_mov_b32 v47, 0
    v_mov_b32 v48, 0
    v_mov_b32 v49, 0
    v_mov_b32 v50, 0
    v_mov_b32 v51, 0
    s_cmp_lg_u32 s3, 0
    s_cbranch_scc1 L_gb23_gskip
    s_lshl_b32 s56, s2, 7
    s_add_u32 s56, s56, 327680
    v_lshlrev_b32 v68, 2, v1
    v_add_u32 v68, s56, v68
    s_mov_b32 s56, 0
L_gb23_poll:
    s_mov_b32 exec_lo, 0xffffffff
    s_mov_b32 exec_hi, 0x0
    buffer_load_dword v78, v68, s[40:43], 0 offen sc1
    s_waitcnt vmcnt(0)
    s_mov_b64 s[90:91], 0
    s_mov_b32 exec_lo, 0xffffffff
    s_mov_b32 exec_hi, 0x0
    v_cmp_ne_u32 vcc, s26, v78
    s_or_b64 s[90:91], s[90:91], vcc
    s_mov_b64 exec, -1
    s_cmp_eq_u64 s[90:91], 0
    s_cbranch_scc1 L_gb23_pollok
    s_add_u32 s56, s56, 1
    s_cmp_lt_u32 s56, 0x40000
    s_cbranch_scc1 L_gb23_poll
L_gb23_pollok:
L_gb23_gskip:
    s_barrier
    s_cmp_lt_u32 s3, 4
    s_cbranch_scc1 L_g2p3_n1
    s_setprio 1
    s_add_u32 m0, s62, 0
    s_add_u32 s58, s62, 0
    buffer_load_dwordx4 v2, s[28:31], s58 offen sc1 lds
    s_add_u32 m0, s62, 8192
    s_add_u32 s58, s62, 8192
    buffer_load_dwordx4 v2, s[28:31], s58 offen sc1 lds
    s_add_u32 m0, s62, 16384
    s_add_u32 s58, s62, 16384
    buffer_load_dwordx4 v2, s[28:31], s58 offen sc1 lds
    s_add_u32 m0, s62, 24576
    s_add_u32 s58, s62, 24576
    buffer_load_dwordx4 v2, s[28:31], s58 offen sc1 lds
    s_add_u32 m0, s62, 32768
    s_add_u32 s58, s62, 32768
    buffer_load_dwordx4 v2, s[28:31], s58 offen sc1 lds
    s_add_u32 m0, s62, 40960
    s_add_u32 s58, s62, 40960
    buffer_load_dwordx4 v2, s[28:31], s58 offen sc1 lds
    s_add_u32 m0, s62, 49152
    s_add_u32 s58, s62, 49152
    buffer_load_dwordx4 v2, s[28:31], s58 offen sc1 lds
    s_add_u32 m0, s62, 57344
    s_add_u32 s58, s62, 57344
    buffer_load_dwordx4 v2, s[28:31], s58 offen sc1 lds
    s_waitcnt vmcnt(8)
    v_lshlrev_b32 v4, 16, v52
    v_and_b32 v5, 0xffff0000, v52
    v_lshlrev_b32 v6, 16, v53
    v_and_b32 v7, 0xffff0000, v53
    v_lshlrev_b32 v8, 16, v54
    v_and_b32 v9, 0xffff0000, v54
    v_lshlrev_b32 v10, 16, v55
    v_and_b32 v11, 0xffff0000, v55
    v_lshlrev_b32 v12, 16, v56
    v_and_b32 v13, 0xffff0000, v56
    v_lshlrev_b32 v14, 16, v57
    v_and_b32 v15, 0xffff0000, v57
    s_waitcnt vmcnt(6)
    s_barrier
    ds_read_b128 v[52:55], v84 offset:0
    ds_read_b128 v[56:59], v85 offset:0
    ds_read_b128 v[60:63], v86 offset:0
    ds_read_b128 v[64:67], v87 offset:0
    s_add_u32 m0, s62, 65536
    s_add_u32 s58, s62, 65536
    buffer_load_dwordx4 v2, s[28:31], s58 offen sc1 lds
    s_add_u32 m0, s62, 73728
    s_add_u32 s58, s62, 73728
    buffer_load_dwordx4 v2, s[28:31], s58 offen sc1 lds
    s_add_u32 m0, s62, 81920
    s_add_u32 s58, s62, 81920
    buffer_load_dwordx4 v2, s[28:31], s58 offen sc1 lds
    s_add_u32 m0, s62, 90112
    s_add_u32 s58, s62, 90112
    buffer_load_dwordx4 v2, s[28:31], s58 offen sc1 lds
    s_waitcnt lgkmcnt(0)
    v_mfma_f32_16x16x32_bf16 v[4:7], v[88:91], v[52:55], v[4:7]
    v_mfma_f32_16x16x32_bf16 v[16:19], v[88:91], v[56:59], v[16:19]
    v_mfma_f32_16x16x32_bf16 v[28:31], v[88:91], v[60:63], v[28:31]
    v_mfma_f32_16x16x32_bf16 v[40:43], v[88:91], v[64:67], v[40:43]
    v_mfma_f32_16x16x32_bf16 v[8:11], v[92:95], v[52:55], v[8:11]
    v_mfma_f32_16x16x32_bf16 v[20:23], v[92:95], v[56:59], v[20:23]
    v_mfma_f32_16x16x32_bf16 v[32:35], v[92:95], v[60:63], v[32:35]
    v_mfma_f32_16x16x32_bf16 v[44:47], v[92:95], v[64:67], v[44:47]
    v_mfma_f32_16x16x32_bf16 v[12:15], v[96:99], v[52:55], v[12:15]
    v_mfma_f32_16x16x32_bf16 v[24:27], v[96:99], v[56:59], v[24:27]
    v_mfma_f32_16x16x32_bf16 v[36:39], v[96:99], v[60:63], v[36:39]
    v_mfma_f32_16x16x32_bf16 v[48:51], v[96:99], v[64:67], v[48:51]
    s_waitcnt vmcnt(4)
    s_barrier
    ds_read_b128 v[68:71], v84 offset:16384
    ds_read_b128 v[72:75], v85 offset:16384
    ds_read_b128 v[76:79], v86 offset:16384
    ds_read_b128 v[80:83], v87 offset:16384
    ds_read_b128 v[52:55], v84 offset:32768
    ds_read_b128 v[56:59], v85 offset:32768
    ds_read_b128 v[60:63], v86 offset:32768
    ds_read_b128 v[64:67], v87 offset:32768
    s_waitcnt lgkmcnt(4)
    v_mfma_f32_16x16x32_bf16 v[4:7], v[100:103], v[68:71], v[4:7]
    v_mfma_f32_16x16x32_bf16 v[16:19], v[100:103], v[72:75], v[16:19]
    v_mfma_f32_16x16x32_bf16 v[28:31], v[100:103], v[76:79], v[28:31]
    v_mfma_f32_16x16x32_bf16 v[40:43], v[100:103], v[80:83], v[40:43]
    v_mfma_f32_16x16x32_bf16 v[8:11], v[104:107], v[68:71], v[8:11]
    v_mfma_f32_16x16x32_bf16 v[20:23], v[104:107], v[72:75], v[20:23]
    v_mfma_f32_16x16x32_bf16 v[32:35], v[104:107], v[76:79], v[32:35]
    v_mfma_f32_16x16x32_bf16 v[44:47], v[104:107], v[80:83], v[44:47]
    v_mfma_f32_16x16x32_bf16 v[12:15], v[108:111], v[68:71], v[12:15]
    v_mfma_f32_16x16x32_bf16 v[24:27], v[108:111], v[72:75], v[24:27]
    v_mfma_f32_16x16x32_bf16 v[36:39], v[108:111], v[76:79], v[36:39]
    v_mfma_f32_16x16x32_bf16 v[48:51], v[108:111], v[80:83], v[48:51]
    s_waitcnt vmcnt(0)
    s_barrier
    ds_read_b128 v[68:71], v84 offset:49152
    ds_read_b128 v[72:75], v85 offset:49152
    ds_read_b128 v[76:79], v86 offset:49152
    ds_read_b128 v[80:83], v87 offset:49152
    s_waitcnt lgkmcnt(4)
    v_mfma_f32_16x16x32_bf16 v[4:7], v[112:115], v[52:55], v[4:7]
    v_mfma_f32_16x16x32_bf16 v[16:19], v[112:115], v[56:59], v[16:19]
    v_mfma_f32_16x16x32_bf16 v[28:31], v[112:115], v[60:63], v[28:31]
    v_mfma_f32_16x16x32_bf16 v[40:43], v[112:115], v[64:67], v[40:43]
    v_mfma_f32_16x16x32_bf16 v[8:11], v[116:119], v[52:55], v[8:11]
    v_mfma_f32_16x16x32_bf16 v[20:23], v[116:119], v[56:59], v[20:23]
    v_mfma_f32_16x16x32_bf16 v[32:35], v[116:119], v[60:63], v[32:35]
    v_mfma_f32_16x16x32_bf16 v[44:47], v[116:119], v[64:67], v[44:47]
    v_mfma_f32_16x16x32_bf16 v[12:15], v[120:123], v[52:55], v[12:15]
    v_mfma_f32_16x16x32_bf16 v[24:27], v[120:123], v[56:59], v[24:27]
    v_mfma_f32_16x16x32_bf16 v[36:39], v[120:123], v[60:63], v[36:39]
    v_mfma_f32_16x16x32_bf16 v[48:51], v[120:123], v[64:67], v[48:51]
    v_add_u32 v84, 0x10000, v84
    v_add_u32 v85, 0x10000, v85
    v_add_u32 v86, 0x10000, v86
    v_add_u32 v87, 0x10000, v87
    ds_read_b128 v[52:55], v84 offset:0
    ds_read_b128 v[56:59], v85 offset:0
    ds_read_b128 v[60:63], v86 offset:0
    ds_read_b128 v[64:67], v87 offset:0
    s_waitcnt lgkmcnt(4)
    v_mfma_f32_16x16x32_bf16 v[4:7], v[124:127], v[68:71], v[4:7]
    v_mfma_f32_16x16x32_bf16 v[16:19], v[124:127], v[72:75], v[16:19]
    v_mfma_f32_16x16x32_bf16 v[28:31], v[124:127], v[76:79], v[28:31]
    v_mfma_f32_16x16x32_bf16 v[40:43], v[124:127], v[80:83], v[40:43]
    v_mfma_f32_16x16x32_bf16 v[8:11], v[128:131], v[68:71], v[8:11]
    v_mfma_f32_16x16x32_bf16 v[20:23], v[128:131], v[72:75], v[20:23]
    v_mfma_f32_16x16x32_bf16 v[32:35], v[128:131], v[76:79], v[32:35]
    v_mfma_f32_16x16x32_bf16 v[44:47], v[128:131], v[80:83], v[44:47]
    v_mfma_f32_16x16x32_bf16 v[12:15], v[132:135], v[68:71], v[12:15]
    v_mfma_f32_16x16x32_bf16 v[24:27], v[132:135], v[72:75], v[24:27]
    v_mfma_f32_16x16x32_bf16 v[36:39], v[132:135], v[76:79], v[36:39]
    v_mfma_f32_16x16x32_bf16 v[48:51], v[132:135], v[80:83], v[48:51]
    s_waitcnt lgkmcnt(0)
    v_mfma_f32_16x16x32_bf16 v[4:7], v[136:139], v[52:55], v[4:7]
    v_mfma_f32_16x16x32_bf16 v[16:19], v[136:139], v[56:59], v[16:19]
    v_mfma_f32_16x16x32_bf16 v[28:31], v[136:139], v[60:63], v[28:31]
    v_mfma_f32_16x16x32_bf16 v[40:43], v[136:139], v[64:67], v[40:43]
    v_mfma_f32_16x16x32_bf16 v[8:11], v[140:143], v[52:55], v[8:11]
    v_mfma_f32_16x16x32_bf16 v[20:23], v[140:143], v[56:59], v[20:23]
    v_mfma_f32_16x16x32_bf16 v[32:35], v[140:143], v[60:63], v[32:35]
    v_mfma_f32_16x16x32_bf16 v[44:47], v[140:143], v[64:67], v[44:47]
    v_mfma_f32_16x16x32_bf16 v[12:15], v[144:147], v[52:55], v[12:15]
    v_mfma_f32_16x16x32_bf16 v[24:27], v[144:147], v[56:59], v[24:27]
    v_mfma_f32_16x16x32_bf16 v[36:39], v[144:147], v[60:63], v[36:39]
    v_mfma_f32_16x16x32_bf16 v[48:51], v[144:147], v[64:67], v[48:51]
    s_setprio 0
    s_nop 7
    s_and_b32 s57, s3, 3
    s_add_u32 s58, s57, 1
    s_and_b32 s58, s58, 3
    s_mul_i32 s58, s58, 9216
    s_add_u32 s58, s58, 98304
    v_add_u32 v53, s58, v2
    s_add_u32 s58, s57, 2
    s_and_b32 s58, s58, 3
    s_mul_i32 s58, s58, 9216
    s_add_u32 s58, s58, 101376
    v_add_u32 v54, s58, v2
    s_add_u32 s58, s57, 3
    s_and_b32 s58, s58, 3
    s_mul_i32 s58, s58, 9216
    s_add_u32 s58, s58, 104448
    v_add_u32 v55, s58, v2
    s_mul_i32 s58, s57, 9216
    s_add_u32 s58, s58, 98304
    v_add_u32 v52, s58, v2
    ds_write_b128 v53, v[16:19] offset:0
    ds_write_b128 v53, v[20:23] offset:1024
    ds_write_b128 v53, v[24:27] offset:2048
    ds_write_b128 v54, v[28:31] offset:0
    ds_write_b128 v54, v[32:35] offset:1024
    ds_write_b128 v54, v[36:39] offset:2048
    ds_write_b128 v55, v[40:43] offset:0
    ds_write_b128 v55, v[44:47] offset:1024
    ds_write_b128 v55, v[48:51] offset:2048
    s_waitcnt lgkmcnt(0)
    s_barrier
    ds_read_b128 v[16:19], v52 offset:0
    ds_read_b128 v[20:23], v52 offset:1024
    ds_read_b128 v[24:27], v52 offset:2048
    ds_read_b128 v[28:31], v52 offset:3072
    ds_read_b128 v[32:35], v52 offset:4096
    ds_read_b128 v[36:39], v52 offset:5120
    ds_read_b128 v[40:43], v52 offset:6144
    ds_read_b128 v[44:47], v52 offset:7168
    ds_read_b128 v[48:51], v52 offset:8192
    s_waitcnt lgkmcnt(0)
    v_add_f32 v4, v4, v16
    v_add_f32 v28, v28, v40
    v_add_f32 v5, v5, v17
    v_add_f32 v29, v29, v41
    v_add_f32 v6, v6, v18
    v_add_f32 v30, v30, v42
    v_add_f32 v7, v7, v19
    v_add_f32 v31, v31, v43
    v_add_f32 v4, v4, v28
    v_add_f32 v5, v5, v29
    v_add_f32 v6, v6, v30
    v_add_f32 v7, v7, v31
    v_add_f32 v8, v8, v20
    v_add_f32 v32, v32, v44
    v_add_f32 v9, v9, v21
    v_add_f32 v33, v33, v45
    v_add_f32 v10, v10, v22
    v_add_f32 v34, v34, v46
    v_add_f32 v11, v11, v23
    v_add_f32 v35, v35, v47
    v_add_f32 v8, v8, v32
    v_add_f32 v9, v9, v33
    v_add_f32 v10, v10, v34
    v_add_f32 v11, v11, v35
    v_add_f32 v12, v12, v24
    v_add_f32 v36, v36, v48
    v_add_f32 v13, v13, v25
    v_add_f32 v37, v37, v49
    v_add_f32 v14, v14, v26
    v_add_f32 v38, v38, v50
    v_add_f32 v15, v15, v27
    v_add_f32 v39, v39, v51
    v_add_f32 v12, v12, v36
    v_add_f32 v13, v13, v37
    v_add_f32 v14, v14, v38
    v_add_f32 v15, v15, v39
    s_add_u32 s36, s24, 0xd00000
    s_addc_u32 s37, s25, 0
    s_mov_b32 s38, 0x280000
    s_mov_b32 s39, 0x20000
    s_mov_b32 s96, s36
    s_mov_b32 s97, s37
    s_mov_b32 s99, 0x20000
    s_cmp_eq_u32 s11, 1
    s_cselect_b32 s98, s38, 0
    s_cselect_b32 s38, 0, s38
    v_cvt_pk_bf16_f32 v4, v4, v5
    v_cvt_pk_bf16_f32 v5, v6, v7
    s_lshl_b32 s56, s49, 6
    s_and_b32 s57, s3, 3
    s_lshl_b32 s57, s57, 4
    s_add_u32 s56, s56, s57
    s_lshr_b32 s57, s56, 7
    s_mul_i32 s57, s57, 163840
    s_and_b32 s56, s56, 127
    v_and_b32 v63, 15, v1
    v_add_u32 v63, s56, v63
    v_bfe_u32 v61, v63, 1, 3
    v_lshlrev_b32 v60, 7, v63
    v_add_u32 v60, s57, v60
    s_mul_i32 s56, s50, 80
    s_cmp_lt_u32 s3, 4
    s_cselect_b32 s57, 48, 0
    s_add_u32 s56, s56, s57
    v_lshrrev_b32 v62, 4, v1
    v_lshlrev_b32 v62, 2, v62
    v_add_u32 v62, s56, v62
    v_add_u32 v68, 0, v62
    v_lshrrev_b32 v64, 6, v68
    v_lshlrev_b32 v64, 14, v64
    v_add_u32 v64, v64, v60
    v_bfe_u32 v69, v68, 3, 3
    v_xor_b32 v69, v69, v61
    v_lshl_add_u32 v64, v69, 4, v64
    v_bfe_u32 v69, v68, 2, 1
    v_lshl_add_u32 v64, v69, 3, v64
    buffer_store_dwordx2 v[4:5], v64, s[36:39], 0 offen  sc1
    buffer_store_dwordx2 v[4:5], v64, s[96:99], 0 offen
    v_cvt_pk_bf16_f32 v8, v8, v9
    v_cvt_pk_bf16_f32 v9, v10, v11
    v_add_u32 v68, 16, v62
    v_lshrrev_b32 v65, 6, v68
    v_lshlrev_b32 v65, 14, v65
    v_add_u32 v65, v65, v60
    v_bfe_u32 v69, v68, 3, 3
    v_xor_b32 v69, v69, v61
    v_lshl_add_u32 v65, v69, 4, v65
    v_bfe_u32 v69, v68, 2, 1
    v_lshl_add_u32 v65, v69, 3, v65
    buffer_store_dwordx2 v[8:9], v65, s[36:39], 0 offen  sc1
    buffer_store_dwordx2 v[8:9], v65, s[96:99], 0 offen
    v_cvt_pk_bf16_f32 v12, v12, v13
    v_cvt_pk_bf16_f32 v13, v14, v15
    v_add_u32 v68, 32, v62
    v_lshrrev_b32 v66, 6, v68
    v_lshlrev_b32 v66, 14, v66
    v_add_u32 v66, v66, v60
    v_bfe_u32 v69, v68, 3, 3
    v_xor_b32 v69, v69, v61
    v_lshl_add_u32 v66, v69, 4, v66
    v_bfe_u32 v69, v68, 2, 1
    v_lshl_add_u32 v66, v69, 3, v66
    buffer_store_dwordx2 v[12:13], v66, s[36:39], 0 offen  sc1
    buffer_store_dwordx2 v[12:13], v66, s[96:99], 0 offen
    v_mov_b32 v74, 0
    v_mov_b32 v75, 0
    v_lshlrev_b32 v72, 16, v4
    v_and_b32 v73, 0xffff0000, v4
    v_add_f32 v74, v74, v72
    v_fmac_f32 v75, v72, v72
    v_add_f32 v74, v74, v73
    v_fmac_f32 v75, v73, v73
    v_lshlrev_b32 v72, 16, v5
    v_and_b32 v73, 0xffff0000, v5
    v_add_f32 v74, v74, v72
    v_fmac_f32 v75, v72, v72
    v_add_f32 v74, v74, v73
    v_fmac_f32 v75, v73, v73
    v_lshlrev_b32 v72, 16, v8
    v_and_b32 v73, 0xffff0000, v8
    v_add_f32 v74, v74, v72
    v_fmac_f32 v75, v72, v72
    v_add_f32 v74, v74, v73
    v_fmac_f32 v75, v73, v73
    v_lshlrev_b32 v72, 16, v9
    v_and_b32 v73, 0xffff0000, v9
    v_add_f32 v74, v74, v72
    v_fmac_f32 v75, v72, v72
    v_add_f32 v74, v74, v73
    v_fmac_f32 v75, v73, v73
    v_lshlrev_b32 v72, 16, v12
    v_and_b32 v73, 0xffff0000, v12
    v_add_f32 v74, v74, v72
    v_fmac_f32 v75, v72, v72
    v_add_f32 v74, v74, v73
    v_fmac_f32 v75, v73, v73
    v_lshlrev_b32 v72, 16, v13
    v_and_b32 v73, 0xffff0000, v13
    v_add_f32 v74, v74, v72
    v_fmac_f32 v75, v72, v72
    v_add_f32 v74, v74, v73
    v_fmac_f32 v75, v73, v73
    v_mov_b32 v76, v74
    v_mov_b32 v77, v75
    s_nop 1
    v_permlane32_swap_b32 v76, v74
    v_permlane32_swap_b32 v77, v75
    s_nop 1
    v_add_f32 v74, v74, v76
    v_add_f32 v75, v75, v77
    v_mov_b32 v76, v74
    v_mov_b32 v77, v75
    s_nop 1
    v_permlane16_swap_b32 v76, v74
    v_permlane16_swap_b32 v77, v75
    s_nop 1
    v_add_f32 v74, v74, v76
    v_add_f32 v75, v75, v77
    s_lshl_b32 s56, s49, 6
    s_and_b32 s57, s3, 3
    s_lshl_b32 s57, s57, 4
    s_add_u32 s56, s56, s57
    v_and_b32 v76, 15, v1
    v_add_u32 v76, s56, v76
    v_lshlrev_b32 v76, 7, v76
    s_lshl_b32 s56, s50, 4
    s_add_u32 s56, s56, 0x0
    v_add_u32 v76, s56, v76
    s_add_u32 s36, s24, 0xc0000
    s_addc_u32 s37, s25, 0
    s_mov_b32 s38, 0x40000
    s_mov_b32 s39, 0x20000
    s_mov_b32 s96, s36
    s_mov_b32 s97, s37
    s_mov_b32 s99, 0x20000
    s_cmp_eq_u32 s11, 1
    s_cselect_b32 s98, s38, 0
    s_cselect_b32 s38, 0, s38
    s_mov_b64 exec, 0xffff
    buffer_store_dwordx2 v[74:75], v76, s[36:39], 0 offen  sc1
    buffer_store_dwordx2 v[74:75], v76, s[96:99], 0 offen
    s_mov_b64 exec, -1
    s_branch L_g2p3_j
L_g2p3_n1:
    s_add_u32 m0, s62, 0
    s_add_u32 s58, s62, 0
    buffer_load_dwordx4 v2, s[28:31], s58 offen sc1 lds
    s_add_u32 m0, s62, 8192
    s_add_u32 s58, s62, 8192
    buffer_load_dwordx4 v2, s[28:31], s58 offen sc1 lds
    s_add_u32 m0, s62, 16384
    s_add_u32 s58, s62, 16384
    buffer_load_dwordx4 v2, s[28:31], s58 offen sc1 lds
    s_add_u32 m0, s62, 24576
    s_add_u32 s58, s62, 24576
    buffer_load_dwordx4 v2, s[28:31], s58 offen sc1 lds
    s_add_u32 m0, s62, 32768
    s_add_u32 s58, s62, 32768
    buffer_load_dwordx4 v2, s[28:31], s58 offen sc1 lds
    s_add_u32 m0, s62, 40960
    s_add_u32 s58, s62, 40960
    buffer_load_dwordx4 v2, s[28:31], s58 offen sc1 lds
    s_add_u32 m0, s62, 49152
    s_add_u32 s58, s62, 49152
    buffer_load_dwordx4 v2, s[28:31], s58 offen sc1 lds
    s_add_u32 m0, s62, 57344
    s_add_u32 s58, s62, 57344
    buffer_load_dwordx4 v2, s[28:31], s58 offen sc1 lds
    s_waitcnt vmcnt(8)
    v_lshlrev_b32 v4, 16, v52
    v_and_b32 v5, 0xffff0000, v52
    v_lshlrev_b32 v6, 16, v53
    v_and_b32 v7, 0xffff0000, v53
    v_lshlrev_b32 v8, 16, v54
    v_and_b32 v9, 0xffff0000, v54
    v_lshlrev_b32 v10, 16, v55
    v_and_b32 v11, 0xffff0000, v55
    s_waitcnt vmcnt(6)
    s_barrier
    ds_read_b128 v[52:55], v84 offset:0
    ds_read_b128 v[56:59], v85 offset:0
    ds_read_b128 v[60:63], v86 offset:0
    ds_read_b128 v[64:67], v87 offset:0
    s_add_u32 m0, s62, 65536
    s_add_u32 s58, s62, 65536
    buffer_load_dwordx4 v2, s[28:31], s58 offen sc1 lds
    s_add_u32 m0, s62, 73728
    s_add_u32 s58, s62, 73728
    buffer_load_dwordx4 v2, s[28:31], s58 offen sc1 lds
    s_add_u32 m0, s62, 81920
    s_add_u32 s58, s62, 81920
    buffer_load_dwordx4 v2, s[28:31], s58 offen sc1 lds
    s_add_u32 m0, s62, 90112
    s_add_u32 s58, s62, 90112
    buffer_load_dwordx4 v2, s[28:31], s58 offen sc1 lds
    s_waitcnt lgkmcnt(0)
    v_mfma_f32_16x16x32_bf16 v[4:7], v[88:91], v[52:55], v[4:7]
    v_mfma_f32_16x16x32_bf16 v[16:19], v[88:91], v[56:59], v[16:19]
    v_mfma_f32_16x16x32_bf16 v[28:31], v[88:91], v[60:63], v[28:31]
    v_mfma_f32_16x16x32_bf16 v[40:43], v[88:91], v[64:67], v[40:43]
    v_mfma_f32_16x16x32_bf16 v[8:11], v[92:95], v[52:55], v[8:11]
    v_mfma_f32_16x16x32_bf16 v[20:23], v[92:95], v[56:59], v[20:23]
    v_mfma_f32_16x16x32_bf16 v[32:35], v[92:95], v[60:63], v[32:35]
    v_mfma_f32_16x16x32_bf16 v[44:47], v[92:95], v[64:67], v[44:47]
    s_waitcnt vmcnt(4)
    s_barrier
    ds_read_b128 v[68:71], v84 offset:16384
    ds_read_b128 v[72:75], v85 offset:16384
    ds_read_b128 v[76:79], v86 offset:16384
    ds_read_b128 v[80:83], v87 offset:16384
    ds_read_b128 v[52:55], v84 offset:32768
    ds_read_b128 v[56:59], v85 offset:32768
    ds_read_b128 v[60:63], v86 offset:32768
    ds_read_b128 v[64:67], v87 offset:32768
    s_waitcnt lgkmcnt(4)
    v_mfma_f32_16x16x32_bf16 v[4:7], v[96:99], v[68:71], v[4:7]
    v_mfma_f32_16x16x32_bf16 v[16:19], v[96:99], v[72:75], v[16:19]
    v_mfma_f32_16x16x32_bf16 v[28:31], v[96:99], v[76:79], v[28:31]
    v_mfma_f32_16x16x32_bf16 v[40:43], v[96:99], v[80:83], v[40:43]
    v_mfma_f32_16x16x32_bf16 v[8:11], v[100:103], v[68:71], v[8:11]
    v_mfma_f32_16x16x32_bf16 v[20:23], v[100:103], v[72:75], v[20:23]
    v_mfma_f32_16x16x32_bf16 v[32:35], v[100:103], v[76:79], v[32:35]
    v_mfma_f32_16x16x32_bf16 v[44:47], v[100:103], v[80:83], v[44:47]
    s_waitcnt vmcnt(0)
    s_barrier
    ds_read_b128 v[68:71], v84 offset:49152
    ds_read_b128 v[72:75], v85 offset:49152
    ds_read_b128 v[76:79], v86 offset:49152
    ds_read_b128 v[80:83], v87 offset:49152
    s_waitcnt lgkmcnt(4)
    v_mfma_f32_16x16x32_bf16 v[4:7], v[104:107], v[52:55], v[4:7]
    v_mfma_f32_16x16x32_bf16 v[16:19], v[104:107], v[56:59], v[16:19]
    v_mfma_f32_16x16x32_bf16 v[28:31], v[104:107], v[60:63], v[28:31]
    v_mfma_f32_16x16x32_bf16 v[40:43], v[104:107], v[64:67], v[40:43]
    v_mfma_f32_16x16x32_bf16 v[8:11], v[108:111], v[52:55], v[8:11]
    v_mfma_f32_16x16x32_bf16 v[20:23], v[108:111], v[56:59], v[20:23]
    v_mfma_f32_16x16x32_bf16 v[32:35], v[108:111], v[60:63], v[32:35]
    v_mfma_f32_16x16x32_bf16 v[44:47], v[108:111], v[64:67], v[44:47]
    v_add_u32 v84, 0x10000, v84
    v_add_u32 v85, 0x10000, v85
    v_add_u32 v86, 0x10000, v86
    v_add_u32 v87, 0x10000, v87
    ds_read_b128 v[52:55], v84 offset:0
    ds_read_b128 v[56:59], v85 offset:0
    ds_read_b128 v[60:63], v86 offset:0
    ds_read_b128 v[64:67], v87 offset:0
    s_waitcnt lgkmcnt(4)
    v_mfma_f32_16x16x32_bf16 v[4:7], v[112:115], v[68:71], v[4:7]
    v_mfma_f32_16x16x32_bf16 v[16:19], v[112:115], v[72:75], v[16:19]
    v_mfma_f32_16x16x32_bf16 v[28:31], v[112:115], v[76:79], v[28:31]
    v_mfma_f32_16x16x32_bf16 v[40:43], v[112:115], v[80:83], v[40:43]
    v_mfma_f32_16x16x32_bf16 v[8:11], v[116:119], v[68:71], v[8:11]
    v_mfma_f32_16x16x32_bf16 v[20:23], v[116:119], v[72:75], v[20:23]
    v_mfma_f32_16x16x32_bf16 v[32:35], v[116:119], v[76:79], v[32:35]
    v_mfma_f32_16x16x32_bf16 v[44:47], v[116:119], v[80:83], v[44:47]
    s_waitcnt lgkmcnt(0)
    v_mfma_f32_16x16x32_bf16 v[4:7], v[120:123], v[52:55], v[4:7]
    v_mfma_f32_16x16x32_bf16 v[16:19], v[120:123], v[56:59], v[16:19]
    v_mfma_f32_16x16x32_bf16 v[28:31], v[120:123], v[60:63], v[28:31]
    v_mfma_f32_16x16x32_bf16 v[40:43], v[120:123], v[64:67], v[40:43]
    v_mfma_f32_16x16x32_bf16 v[8:11], v[124:127], v[52:55], v[8:11]
    v_mfma_f32_16x16x32_bf16 v[20:23], v[124:127], v[56:59], v[20:23]
    v_mfma_f32_16x16x32_bf16 v[32:35], v[124:127], v[60:63], v[32:35]
    v_mfma_f32_16x16x32_bf16 v[44:47], v[124:127], v[64:67], v[44:47]
    s_nop 7
    s_and_b32 s57, s3, 3
    s_add_u32 s58, s57, 1
    s_and_b32 s58, s58, 3
    s_mul_i32 s58, s58, 6144
    s_add_u32 s58, s58, 135168
    v_add_u32 v53, s58, v2
    s_add_u32 s58, s57, 2
    s_and_b32 s58, s58, 3
    s_mul_i32 s58, s58, 6144
    s_add_u32 s58, s58, 137216
    v_add_u32 v54, s58, v2
    s_add_u32 s58, s57, 3
    s_and_b32 s58, s58, 3
    s_mul_i32 s58, s58, 6144
    s_add_u32 s58, s58, 139264
    v_add_u32 v55, s58, v2
    s_mul_i32 s58, s57, 6144
    s_add_u32 s58, s58, 135168
    v_add_u32 v52, s58, v2
    ds_write_b128 v53, v[16:19] offset:0
    ds_write_b128 v53, v[20:23] offset:1024
    ds_write_b128 v54, v[28:31] offset:0
    ds_write_b128 v54, v[32:35] offset:1024
    ds_write_b128 v55, v[40:43] offset:0
    ds_write_b128 v55, v[44:47] offset:1024
    s_waitcnt lgkmcnt(0)
    s_barrier
    ds_read_b128 v[16:19], v52 offset:0
    ds_read_b128 v[20:23], v52 offset:1024
    ds_read_b128 v[28:31], v52 offset:2048
    ds_read_b128 v[32:35], v52 offset:3072
    ds_read_b128 v[40:43], v52 offset:4096
    ds_read_b128 v[44:47], v52 offset:5120
    s_waitcnt lgkmcnt(0)
    v_add_f32 v4, v4, v16
    v_add_f32 v28, v28, v40
    v_add_f32 v5, v5, v17
    v_add_f32 v29, v29, v41
    v_add_f32 v6, v6, v18
    v_add_f32 v30, v30, v42
    v_add_f32 v7, v7, v19
    v_add_f32 v31, v31, v43
    v_add_f32 v4, v4, v28
    v_add_f32 v5, v5, v29
    v_add_f32 v6, v6, v30
    v_add_f32 v7, v7, v31
    v_add_f32 v8, v8, v20
    v_add_f32 v32, v32, v44
    v_add_f32 v9, v9, v21
    v_add_f32 v33, v33, v45
    v_add_f32 v10, v10, v22
    v_add_f32 v34, v34, v46
    v_add_f32 v11, v11, v23
    v_add_f32 v35, v35, v47
    v_add_f32 v8, v8, v32
    v_add_f32 v9, v9, v33
    v_add_f32 v10, v10, v34
    v_add_f32 v11, v11, v35
    s_add_u32 s36, s24, 0xd00000
    s_addc_u32 s37, s25, 0
    s_mov_b32 s38, 0x280000
    s_mov_b32 s39, 0x20000
    s_mov_b32 s96, s36
    s_mov_b32 s97, s37
    s_mov_b32 s99, 0x20000
    s_cmp_eq_u32 s11, 1
    s_cselect_b32 s98, s38, 0
    s_cselect_b32 s38, 0, s38
    v_cvt_pk_bf16_f32 v4, v4, v5
    v_cvt_pk_bf16_f32 v5, v6, v7
    s_lshl_b32 s56, s49, 6
    s_and_b32 s57, s3, 3
    s_lshl_b32 s57, s57, 4
    s_add_u32 s56, s56, s57
    s_lshr_b32 s57, s56, 7
    s_mul_i32 s57, s57, 163840
    s_and_b32 s56, s56, 127
    v_and_b32 v63, 15, v1
    v_add_u32 v63, s56, v63
    v_bfe_u32 v61, v63, 1, 3
    v_lshlrev_b32 v60, 7, v63
    v_add_u32 v60, s57, v60
    s_mul_i32 s56, s50, 80
    s_cmp_lt_u32 s3, 4
    s_cselect_b32 s57, 48, 0
    s_add_u32 s56, s56, s57
    v_lshrrev_b32 v62, 4, v1
    v_lshlrev_b32 v62, 2, v62
    v_add_u32 v62, s56, v62
    v_add_u32 v68, 0, v62
    v_lshrrev_b32 v64, 6, v68
    v_lshlrev_b32 v64, 14, v64
    v_add_u32 v64, v64, v60
    v_bfe_u32 v69, v68, 3, 3
    v_xor_b32 v69, v69, v61
    v_lshl_add_u32 v64, v69, 4, v64
    v_bfe_u32 v69, v68, 2, 1
    v_lshl_add_u32 v64, v69, 3, v64
    buffer_store_dwordx2 v[4:5], v64, s[36:39], 0 offen  sc1
    buffer_store_dwordx2 v[4:5], v64, s[96:99], 0 offen
    v_cvt_pk_bf16_f32 v8, v8, v9
    v_cvt_pk_bf16_f32 v9, v10, v11
    v_add_u32 v68, 16, v62
    v_lshrrev_b32 v65, 6, v68
    v_lshlrev_b32 v65, 14, v65
    v_add_u32 v65, v65, v60
    v_bfe_u32 v69, v68, 3, 3
    v_xor_b32 v69, v69, v61
    v_lshl_add_u32 v65, v69, 4, v65
    v_bfe_u32 v69, v68, 2, 1
    v_lshl_add_u32 v65, v69, 3, v65
    buffer_store_dwordx2 v[8:9], v65, s[36:39], 0 offen  sc1
    buffer_store_dwordx2 v[8:9], v65, s[96:99], 0 offen
    v_mov_b32 v74, 0
    v_mov_b32 v75, 0
    v_lshlrev_b32 v72, 16, v4
    v_and_b32 v73, 0xffff0000, v4
    v_add_f32 v74, v74, v72
    v_fmac_f32 v75, v72, v72
    v_add_f32 v74, v74, v73
    v_fmac_f32 v75, v73, v73
    v_lshlrev_b32 v72, 16, v5
    v_and_b32 v73, 0xffff0000, v5
    v_add_f32 v74, v74, v72
    v_fmac_f32 v75, v72, v72
    v_add_f32 v74, v74, v73
    v_fmac_f32 v75, v73, v73
    v_lshlrev_b32 v72, 16, v8
    v_and_b32 v73, 0xffff0000, v8
    v_add_f32 v74, v74, v72
    v_fmac_f32 v75, v72, v72
    v_add_f32 v74, v74, v73
    v_fmac_f32 v75, v73, v73
    v_lshlrev_b32 v72, 16, v9
    v_and_b32 v73, 0xffff0000, v9
    v_add_f32 v74, v74, v72
    v_fmac_f32 v75, v72, v72
    v_add_f32 v74, v74, v73
    v_fmac_f32 v75, v73, v73
    v_mov_b32 v76, v74
    v_mov_b32 v77, v75
    s_nop 1
    v_permlane32_swap_b32 v76, v74
    v_permlane32_swap_b32 v77, v75
    s_nop 1
    v_add_f32 v74, v74, v76
    v_add_f32 v75, v75, v77
    v_mov_b32 v76, v74
    v_mov_b32 v77, v75
    s_nop 1
    v_permlane16_swap_b32 v76, v74
    v_permlane16_swap_b32 v77, v75
    s_nop 1
    v_add_f32 v74, v74, v76
    v_add_f32 v75, v75, v77
    s_lshl_b32 s56, s49, 6
    s_and_b32 s57, s3, 3
    s_lshl_b32 s57, s57, 4
    s_add_u32 s56, s56, s57
    v_and_b32 v76, 15, v1
    v_add_u32 v76, s56, v76
    v_lshlrev_b32 v76, 7, v76
    s_lshl_b32 s56, s50, 4
    s_add_u32 s56, s56, 0x8
    v_add_u32 v76, s56, v76
    s_add_u32 s36, s24, 0xc0000
    s_addc_u32 s37, s25, 0
    s_mov_b32 s38, 0x40000
    s_mov_b32 s39, 0x20000
    s_mov_b32 s96, s36
    s_mov_b32 s97, s37
    s_mov_b32 s99, 0x20000
    s_cmp_eq_u32 s11, 1
    s_cselect_b32 s98, s38, 0
    s_cselect_b32 s38, 0, s38
    s_mov_b64 exec, 0xffff
    buffer_store_dwordx2 v[74:75], v76, s[36:39], 0 offen  sc1
    buffer_store_dwordx2 v[74:75], v76, s[96:99], 0 offen
    s_mov_b64 exec, -1
L_g2p3_j:
    v_lshlrev_b32 v66, 3, v1
    v_add_u32 v66, s27, v66
    v_lshlrev_b32 v66, 7, v66
    s_lshl_b32 s57, s48, 2
    s_add_u32 s57, s57, 360448
    v_add_u32 v66, s57, v66
    v_mov_b32 v67, s26
    s_waitcnt vmcnt(0) lgkmcnt(0)
    s_barrier
    s_cmp_lg_u32 s3, 0
    s_cbranch_scc1 L_gb34_gskip0
    s_mov_b32 exec_lo, 0xffffffff
    s_mov_b32 exec_hi, 0x0
    s_cmp_eq_u32 s11, 1
    s_cbranch_scc1 L_gb34_gskipf
    buffer_store_dword v67, v66, s[40:43], 0 offen sc1
    s_branch L_gb34_gskipg
L_gb34_gskipf:
    buffer_store_dword v67, v66, s[40:43], 0 offen
L_gb34_gskipg:
    s_mov_b64 exec, -1
L_gb34_gskip0:
    s_cmp_lt_u32 s48, 28
    s_cbranch_scc1 L_h34_skip
    s_add_u32 s32, s24, 0x1800000
    s_addc_u32 s33, s25, 0
    s_mov_b32 s34, 0x21c000
    s_mov_b32 s35, 0x20000
    s_and_b32 s56, s3, 3
    s_mul_i32 s57, s56, 40
    s_and_b32 s58, s48, 7
    s_mul_i32 s58, s58, 5
    s_add_u32 s57, s57, s58
    s_cmp_lt_u32 s3, 4
    s_cselect_b32 s58, 3, 0
    s_add_u32 s57, s57, s58
    s_lshl_b32 s55, s57, 10
    v_lshlrev_b32 v2, 4, v1
    s_cmp_ge_u32 s3, 4
    s_cbranch_scc1 L_pfw2_A
    s_branch L_pfw2_J
L_pfw2_A:
    s_add_u32 s58, s55, 0
    buffer_load_dwordx4 v[88:91], v2, s[32:35], s58 offen sc1
    s_add_u32 s58, s55, 1024
    buffer_load_dwordx4 v[92:95], v2, s[32:35], s58 offen sc1
    s_add_u32 s58, s55, 2048
    buffer_load_dwordx4 v[96:99], v2, s[32:35], s58 offen sc1
    s_add_u32 s58, s55, 163840
    buffer_load_dwordx4 v[100:103], v2, s[32:35], s58 offen sc1
    s_add_u32 s58, s55, 164864
    buffer_load_dwordx4 v[104:107], v2, s[32:35], s58 offen sc1
    s_add_u32 s58, s55, 165888
    buffer_load_dwordx4 v[108:111], v2, s[32:35], s58 offen sc1
    s_add_u32 s58, s55, 327680
    buffer_load_dwordx4 v[112:115], v2, s[32:35], s58 offen sc1
    s_add_u32 s58, s55, 328704
    buffer_load_dwordx4 v[116:119], v2, s[32:35], s58 offen sc1
    s_add_u32 s58, s55, 329728
    buffer_load_dwordx4 v[120:123], v2, s[32:35], s58 offen sc1
    s_add_u32 s58, s55, 491520
    buffer_load_dwordx4 v[124:127], v2, s[32:35], s58 offen sc1
    s_add_u32 s58, s55, 492544
    buffer_load_dwordx4 v[128:131], v2, s[32:35], s58 offen sc1
    s_add_u32 s58, s55, 493568
    buffer_load_dwordx4 v[132:135], v2, s[32:35], s58 offen sc1
    s_add_u32 s58, s55, 655360
    buffer_load_dwordx4 v[136:139], v2, s[32:35], s58 offen sc1
    s_add_u32 s58, s55, 656384
    buffer_load_dwordx4 v[140:143], v2, s[32:35], s58 offen sc1
    s_add_u32 s58, s55, 657408
    buffer_load_dwordx4 v[144:147], v2, s[32:35], s58 offen sc1
L_pfw2_J:
L_h34_skip:
    s_cmp_ge_u32 s48, 28
    s_cbranch_scc1 L_p4s_done
    s_cmp_ge_u32 s48, 14
    s_cselect_b32 s56, 1, 0
    s_cselect_b32 s57, 14, 0
    s_sub_u32 s50, s48, s57
    s_lshl_b32 s49, s27, 1
    s_add_u32 s49, s49, s56
    s_cmp_ge_u32 s50, 10
    s_cselect_b32 s56, 10, 0
    s_sub_u32 s51, s50, s56
    s_cmp_lt_u32 s3, 4
    s_cbranch_scc1 L_p4s_compute
    s_sub_u32 s60, s3, 4
    v_lshrrev_b32 v16, 4, v1
    s_lshl_b32 s56, s60, 2
    v_add_u32 v17, s56, v16
    v_and_b32 v17, 7, v17
    v_and_b32 v18, 7, v1
    v_xor_b32 v17, v17, v18
    v_lshlrev_b32 v17, 4, v17
    v_lshrrev_b32 v18, 3, v1
    v_mul_u32_u24 v18, 1280, v18
    v_add_u32 v2, v17, v18
    v_lshlrev_b32 v17, 2, v16
    v_and_b32 v18, 15, v1
    v_xor_b32 v17, v17, v18
    v_lshlrev_b32 v17, 4, v17
    v_mul_u32_u24 v18, 3456, v16
    v_add_u32 v3, v17, v18
    s_lshl_b32 s56, s49, 7
    s_lshl_b32 s57, s60, 3
    s_add_u32 s56, s56, s57
    s_mul_i32 s54, s56, 1280
    s_mul_i32 s56, s60, 13824
    s_lshl_b32 s57, s50, 8
    s_add_u32 s55, s56, s57
    s_lshl_b32 s62, s60, 10
    s_mov_b32 s53, 0
    v_lshlrev_b32 v2, 4, v1
    s_mul_i32 s54, s49, 163840
    s_add_u32 s54, s54, s62
    s_add_u32 s28, s24, 0xd00000
    s_addc_u32 s29, s25, 0
    s_mov_b32 s30, 0x280000
    s_mov_b32 s31, 0x20000
    s_mov_b32 s32, s12
    s_mov_b32 s33, s13
    s_mov_b32 s34, 0x21c000
    s_mov_b32 s35, 0x20000
    s_mov_b32 s44, s14
    s_mov_b32 s45, s15
    s_mov_b32 s46, 0xd80
    s_mov_b32 s47, 0x20000
    s_sub_u32 s60, s3, 4
    s_lshl_b32 s60, s60, 5
    v_and_b32 v26, 31, v1
    v_add_u32 v26, s60, v26
    s_lshl_b32 s60, s50, 7
    v_add_u32 v27, s60, v26
    v_lshlrev_b32 v27, 1, v27
    buffer_load_ushort v38, v27, s[44:47], 0 offen
    v_lshlrev_b32 v27, 1, v27
    v_add_u32 v27, 0x70000, v27
    buffer_load_dword v39, v27, s[40:43], 0 offen sc1
    s_mov_b32 s59, s51
    s_mul_i32 s60, s59, 221184
    s_add_u32 s60, s60, s55
    s_add_u32 m0, s62, 16384
    s_add_u32 s58, s60, 0
    buffer_load_dwordx4 v3, s[32:35], s58 offen lds
    s_add_u32 m0, s62, 20480
    s_add_u32 s58, s60, 55296
    buffer_load_dwordx4 v3, s[32:35], s58 offen lds
    s_add_u32 m0, s62, 24576
    s_add_u32 s58, s60, 110592
    buffer_load_dwordx4 v3, s[32:35], s58 offen lds
    s_add_u32 m0, s62, 28672
    s_add_u32 s58, s60, 165888
    buffer_load_dwordx4 v3, s[32:35], s58 offen lds
    s_add_u32 s59, s59, 1
    s_cmp_eq_u32 s59, 10
    s_cselect_b32 s59, 0, s59
    s_mul_i32 s60, s59, 221184
    s_add_u32 s60, s60, s55
    s_add_u32 m0, s62, 49152
    s_add_u32 s58, s60, 0
    buffer_load_dwordx4 v3, s[32:35], s58 offen lds
    s_add_u32 m0, s62, 53248
    s_add_u32 s58, s60, 55296
    buffer_load_dwordx4 v3, s[32:35], s58 offen lds
    s_add_u32 m0, s62, 57344
    s_add_u32 s58, s60, 110592
    buffer_load_dwordx4 v3, s[32:35], s58 offen lds
    s_add_u32 m0, s62, 61440
    s_add_u32 s58, s60, 165888
    buffer_load_dwordx4 v3, s[32:35], s58 offen lds
    s_add_u32 s59, s59, 1
    s_cmp_eq_u32 s59, 10
    s_cselect_b32 s59, 0, s59
    s_mul_i32 s60, s59, 221184
    s_add_u32 s60, s60, s55
    s_add_u32 m0, s62, 81920
    s_add_u32 s58, s60, 0
    buffer_load_dwordx4 v3, s[32:35], s58 offen lds
    s_add_u32 m0, s62, 86016
    s_add_u32 s58, s60, 55296
    buffer_load_dwordx4 v3, s[32:35], s58 offen lds
    s_add_u32 m0, s62, 90112
    s_add_u32 s58, s60, 110592
    buffer_load_dwordx4 v3, s[32:35], s58 offen lds
    s_add_u32 m0, s62, 94208
    s_add_u32 s58, s60, 165888
    buffer_load_dwordx4 v3, s[32:35], s58 offen lds
    s_add_u32 s59, s59, 1
    s_cmp_eq_u32 s59, 10
    s_cselect_b32 s59, 0, s59
    s_branch L_p4s_done
L_p4s_compute:
    s_lshr_b32 s63, s3, 1
    s_and_b32 s64, s3, 1
    v_and_b32 v16, 31, v1
    s_lshl_b32 s56, s63, 6
    v_add_u32 v17, s56, v16
    v_lshlrev_b32 v17, 7, v17
    v_bfe_u32 v18, v16, 1, 3
    v_lshrrev_b32 v19, 5, v1
    v_xor_b32 v18, v18, v19
    v_xor_b32 v2, 0, v18
    v_lshlrev_b32 v2, 4, v2
    v_add_u32 v2, v2, v17
    v_xor_b32 v3, 2, v18
    v_lshlrev_b32 v3, 4, v3
    v_add_u32 v3, v3, v17
    v_xor_b32 v4, 4, v18
    v_lshlrev_b32 v4, 4, v4
    v_add_u32 v4, v4, v17
    v_xor_b32 v5, 6, v18
    v_lshlrev_b32 v5, 4, v5
    v_add_u32 v5, v5, v17
    v_and_b32 v20, 15, v1
    v_lshrrev_b32 v21, 2, v20
    v_lshlrev_b32 v22, 3, v19
    v_add_u32 v22, v22, v21
    v_lshlrev_b32 v22, 8, v22
    v_bfe_u32 v23, v1, 4, 1
    v_lshlrev_b32 v23, 1, v23
    v_bfe_u32 v24, v1, 1, 1
    v_add_u32 v23, v23, v24
    s_lshl_b32 s56, s64, 3
    s_lshl_b32 s57, s63, 2
    s_add_u32 s56, s56, s57
    v_add_u32 v23, s56, v23
    v_lshlrev_b32 v21, 2, v21
    v_xor_b32 v23, v23, v21
    v_lshlrev_b32 v23, 4, v23
    v_and_b32 v24, 1, v1
    v_lshlrev_b32 v24, 3, v24
    v_add_u32 v22, v22, v23
    v_add_u32 v22, v22, v24
    v_add_u32 v6, 16384, v22
    v_xor_b32 v7, 64, v6
    v_and_b32 v16, 15, v1
    v_bfe_u32 v17, v1, 4, 1
    v_cmp_eq_u32 vcc, v16, v17
    v_mov_b32 v18, 0x3f803f80
    s_nop 1
    v_cndmask_b32 v8, 0, v18, vcc
    v_mov_b32 v9, v8
    v_mov_b32 v10, v8
    v_mov_b32 v11, v8
    v_mov_b32 v12, 0
    v_mov_b32 v13, 0
    v_mov_b32 v14, 0
    v_mov_b32 v15, 0
    v_mov_b32 v80, 0
    v_mov_b32 v81, 0
    v_mov_b32 v82, 0
    v_mov_b32 v83, 0
    v_mov_b32 v84, 0
    v_mov_b32 v85, 0
    v_mov_b32 v86, 0
    v_mov_b32 v87, 0
    v_mov_b32 v88, 0
    v_mov_b32 v89, 0
    v_mov_b32 v90, 0
    v_mov_b32 v91, 0
    v_mov_b32 v92, 0
    v_mov_b32 v93, 0
    v_mov_b32 v94, 0
    v_mov_b32 v95, 0
    v_mov_b32 v96, 0
    v_mov_b32 v97, 0
    v_mov_b32 v98, 0
    v_mov_b32 v99, 0
    v_mov_b32 v100, 0
    v_mov_b32 v101, 0
    v_mov_b32 v102, 0
    v_mov_b32 v103, 0
    v_mov_b32 v104, 0
    v_mov_b32 v105, 0
    v_mov_b32 v106, 0
    v_mov_b32 v107, 0
    v_mov_b32 v108, 0
    v_mov_b32 v109, 0
    v_mov_b32 v110, 0
    v_mov_b32 v111, 0
    v_mov_b32 v112, 0
    v_mov_b32 v113, 0
    v_mov_b32 v114, 0
    v_mov_b32 v115, 0
    v_mov_b32 v116, 0
    v_mov_b32 v117, 0
    v_mov_b32 v118, 0
    v_mov_b32 v119, 0
    v_mov_b32 v120, 0
    v_mov_b32 v121, 0
    v_mov_b32 v122, 0
    v_mov_b32 v123, 0
    v_mov_b32 v124, 0
    v_mov_b32 v125, 0
    v_mov_b32 v126, 0
    v_mov_b32 v127, 0
    v_mov_b32 v128, 0
    v_mov_b32 v129, 0
    v_mov_b32 v130, 0
    v_mov_b32 v131, 0
    v_mov_b32 v132, 0
    v_mov_b32 v133, 0
    v_mov_b32 v134, 0
    v_mov_b32 v135, 0
    v_mov_b32 v136, 0
    v_mov_b32 v137, 0
    v_mov_b32 v138, 0
    v_mov_b32 v139, 0
    v_mov_b32 v140, 0
    v_mov_b32 v141, 0
    v_mov_b32 v142, 0
    v_mov_b32 v143, 0
L_p4s_done:
    s_cmp_lg_u32 s3, 0
    s_cbranch_scc1 L_gb34_gskip
    s_lshl_b32 s56, s2, 7
    s_add_u32 s56, s56, 360448
    v_lshlrev_b32 v68, 2, v1
    v_add_u32 v68, s56, v68
    s_mov_b32 s56, 0
L_gb34_poll:
    s_mov_b32 exec_lo, 0xffffffff
    s_mov_b32 exec_hi, 0x0
    buffer_load_dword v78, v68, s[40:43], 0 offen sc1
    s_waitcnt vmcnt(0)
    s_mov_b64 s[90:91], 0
    s_mov_b32 exec_lo, 0xffffffff
    s_mov_b32 exec_hi, 0x0
    v_cmp_ne_u32 vcc, s26, v78
    s_or_b64 s[90:91], s[90:91], vcc
    s_mov_b64 exec, -1
    s_cmp_eq_u64 s[90:91], 0
    s_cbranch_scc1 L_gb34_pollok
    s_add_u32 s56, s56, 1
    s_cmp_lt_u32 s56, 0x40000
    s_cbranch_scc1 L_gb34_poll
L_gb34_pollok:
L_gb34_gskip:
    s_barrier
    s_cmp_ge_u32 s48, 28
    s_cbranch_scc1 L_p4_done
    s_cmp_lt_u32 s3, 4
    s_cbranch_scc1 L_p4_compute
    s_lshl_b32 s60, s51, 14
    s_add_u32 s60, s60, s54
    s_add_u32 m0, s62, 0
    s_add_u32 s58, s60, 0
    buffer_load_dwordx4 v2, s[28:31], s58 offen sc1 lds
    s_add_u32 m0, s62, 4096
    s_add_u32 s58, s60, 4096
    buffer_load_dwordx4 v2, s[28:31], s58 offen sc1 lds
    s_add_u32 m0, s62, 8192
    s_add_u32 s58, s60, 8192
    buffer_load_dwordx4 v2, s[28:31], s58 offen sc1 lds
    s_add_u32 m0, s62, 12288
    s_add_u32 s58, s60, 12288
    buffer_load_dwordx4 v2, s[28:31], s58 offen sc1 lds
    s_add_u32 s51, s51, 1
    s_cmp_eq_u32 s51, 10
    s_cselect_b32 s51, 0, s51
    s_lshl_b32 s60, s51, 14
    s_add_u32 s60, s60, s54
    s_add_u32 m0, s62, 32768
    s_add_u32 s58, s60, 0
    buffer_load_dwordx4 v2, s[28:31], s58 offen sc1 lds
    s_add_u32 m0, s62, 36864
    s_add_u32 s58, s60, 4096
    buffer_load_dwordx4 v2, s[28:31], s58 offen sc1 lds
    s_add_u32 m0, s62, 40960
    s_add_u32 s58, s60, 8192
    buffer_load_dwordx4 v2, s[28:31], s58 offen sc1 lds
    s_add_u32 m0, s62, 45056
    s_add_u32 s58, s60, 12288
    buffer_load_dwordx4 v2, s[28:31], s58 offen sc1 lds
    s_add_u32 s51, s51, 1
    s_cmp_eq_u32 s51, 10
    s_cselect_b32 s51, 0, s51
    s_lshl_b32 s60, s51, 14
    s_add_u32 s60, s60, s54
    s_add_u32 m0, s62, 65536
    s_add_u32 s58, s60, 0
    buffer_load_dwordx4 v2, s[28:31], s58 offen sc1 lds
    s_add_u32 m0, s62, 69632
    s_add_u32 s58, s60, 4096
    buffer_load_dwordx4 v2, s[28:31], s58 offen sc1 lds
    s_add_u32 m0, s62, 73728
    s_add_u32 s58, s60, 8192
    buffer_load_dwordx4 v2, s[28:31], s58 offen sc1 lds
    s_add_u32 m0, s62, 77824
    s_add_u32 s58, s60, 12288
    buffer_load_dwordx4 v2, s[28:31], s58 offen sc1 lds
    s_add_u32 s51, s51, 1
    s_cmp_eq_u32 s51, 10
    s_cselect_b32 s51, 0, s51
    s_mov_b32 s53, 98304
    s_waitcnt vmcnt(8)
    s_barrier
    s_waitcnt vmcnt(4)
    s_mov_b32 s52, 0
L_p4_lloop:
    s_add_u32 s52, s52, 1
    s_waitcnt vmcnt(8)
    s_barrier
    s_lshl_b32 s58, s51, 14
    s_add_u32 s58, s58, s54
    s_add_u32 m0, s53, s62
    s_mul_i32 s59, s51, 221184
    buffer_load_dwordx4 v2, s[28:31], s58 offen sc1 lds
    s_add_u32 m0, m0, 4096
    s_add_u32 s58, s58, 4096
    buffer_load_dwordx4 v2, s[28:31], s58 offen sc1 lds
    s_add_u32 m0, m0, 4096
    s_add_u32 s58, s58, 4096
    buffer_load_dwordx4 v2, s[28:31], s58 offen sc1 lds
    s_add_u32 m0, m0, 4096
    s_add_u32 s58, s58, 4096
    buffer_load_dwordx4 v2, s[28:31], s58 offen sc1 lds
    s_add_u32 s58, s59, s55
    s_add_u32 m0, m0, 4096
    s_nop 0
    buffer_load_dwordx4 v3, s[32:35], s58 offen lds
    s_add_u32 m0, m0, 4096
    s_add_u32 s58, s58, 55296
    buffer_load_dwordx4 v3, s[32:35], s58 offen lds
    s_add_u32 m0, m0, 4096
    s_add_u32 s58, s58, 55296
    buffer_load_dwordx4 v3, s[32:35], s58 offen lds
    s_add_u32 m0, m0, 4096
    s_add_u32 s58, s58, 55296
    buffer_load_dwordx4 v3, s[32:35], s58 offen lds
    s_add_u32 s51, s51, 1
    s_cmp_eq_u32 s51, 10
    s_cselect_b32 s51, 0, s51
    s_add_u32 s53, s53, 32768
    s_cmp_eq_u32 s53, 131072
    s_cselect_b32 s53, 0, s53
    s_cmp_lt_u32 s52, 7
    s_cbranch_scc1 L_p4_lloop
    s_sub_u32 s60, s3, 4
    s_lshl_b32 s56, s60, 5
    v_and_b32 v16, 31, v1
    v_add_u32 v16, s56, v16
    s_lshl_b32 s57, s49, 7
    v_add_u32 v17, s57, v16
    v_lshlrev_b32 v17, 7, v17
    v_lshrrev_b32 v18, 5, v1
    v_lshl_add_u32 v17, v18, 6, v17
    v_add_u32 v17, 0xc0000, v17
    buffer_load_dwordx4 v[20:23], v17, s[40:43], 0 offen offset:0 sc1
    buffer_load_dwordx4 v[24:27], v17, s[40:43], 0 offen offset:16 sc1
    buffer_load_dwordx4 v[28:31], v17, s[40:43], 0 offen offset:32 sc1
    buffer_load_dwordx4 v[32:35], v17, s[40:43], 0 offen offset:48 sc1
    s_waitcnt vmcnt(12)
    s_barrier
    s_waitcnt vmcnt(4)
    s_barrier
    s_add_u32 s44, s24, 0x1800000
    s_addc_u32 s45, s25, 0
    s_mov_b32 s46, 0x21c000
    s_mov_b32 s47, 0x20000
    s_and_b32 s56, s3, 3
    s_mul_i32 s57, s56, 40
    s_and_b32 s58, s48, 7
    s_mul_i32 s58, s58, 5
    s_add_u32 s57, s57, s58
    s_cmp_lt_u32 s3, 4
    s_cselect_b32 s58, 3, 0
    s_add_u32 s57, s57, s58
    s_lshl_b32 s55, s57, 10
    v_lshlrev_b32 v40, 4, v1
    s_add_u32 s58, s55, 0
    buffer_load_dwordx4 v[88:91], v40, s[44:47], s58 offen sc1
    s_add_u32 s58, s55, 1024
    buffer_load_dwordx4 v[92:95], v40, s[44:47], s58 offen sc1
    s_add_u32 s58, s55, 2048
    buffer_load_dwordx4 v[96:99], v40, s[44:47], s58 offen sc1
    s_add_u32 s58, s55, 163840
    buffer_load_dwordx4 v[100:103], v40, s[44:47], s58 offen sc1
    s_add_u32 s58, s55, 164864
    buffer_load_dwordx4 v[104:107], v40, s[44:47], s58 offen sc1
    s_add_u32 s58, s55, 165888
    buffer_load_dwordx4 v[108:111], v40, s[44:47], s58 offen sc1
    s_add_u32 s58, s55, 327680
    buffer_load_dwordx4 v[112:115], v40, s[44:47], s58 offen sc1
    s_add_u32 s58, s55, 328704
    buffer_load_dwordx4 v[116:119], v40, s[44:47], s58 offen sc1
    s_add_u32 s58, s55, 329728
    buffer_load_dwordx4 v[120:123], v40, s[44:47], s58 offen sc1
    s_add_u32 s58, s55, 491520
    buffer_load_dwordx4 v[124:127], v40, s[44:47], s58 offen sc1
    s_add_u32 s58, s55, 492544
    buffer_load_dwordx4 v[128:131], v40, s[44:47], s58 offen sc1
    s_add_u32 s58, s55, 493568
    buffer_load_dwordx4 v[132:135], v40, s[44:47], s58 offen sc1
    s_add_u32 s58, s55, 655360
    buffer_load_dwordx4 v[136:139], v40, s[44:47], s58 offen sc1
    s_add_u32 s58, s55, 656384
    buffer_load_dwordx4 v[140:143], v40, s[44:47], s58 offen sc1
    s_add_u32 s58, s55, 657408
    buffer_load_dwordx4 v[144:147], v40, s[44:47], s58 offen sc1
    s_barrier
    s_waitcnt vmcnt(15)
    v_add_f32 v20, v20, v24
    v_add_f32 v21, v21, v25
    v_add_f32 v22, v22, v26
    v_add_f32 v23, v23, v27
    v_add_f32 v20, v20, v28
    v_add_f32 v21, v21, v29
    v_add_f32 v22, v22, v30
    v_add_f32 v23, v23, v31
    v_add_f32 v20, v20, v32
    v_add_f32 v21, v21, v33
    v_add_f32 v22, v22, v34
    v_add_f32 v23, v23, v35
    v_add_f32 v20, v20, v22
    v_add_f32 v21, v21, v23
    v_mov_b32 v22, v20
    v_mov_b32 v23, v21
    s_nop 1
    v_permlane32_swap_b32 v22, v20
    v_permlane32_swap_b32 v23, v21
    s_nop 1
    v_add_f32 v20, v20, v22
    v_add_f32 v21, v21, v23
    v_mul_f32 v24, 0x3acccccd, v20
    v_mul_f32 v25, 0x3acccccd, v21
    v_fma_f32 v25, -v24, v24, v25
    v_max_f32 v25, 0, v25
    v_add_f32 v25, 0x3727c5ac, v25
    v_rsq_f32 v25, v25
    s_nop 0
    v_mul_f32 v24, v24, v25
    v_sub_f32 v24, 0, v24
    v_lshlrev_b32 v16, 2, v16
    v_add_u32 v16, 131072, v16
    ds_write_b32 v16, v25 offset:9216
    ds_write_b32 v16, v24 offset:9728
    v_lshlrev_b32 v38, 16, v38
    ds_write_b32 v16, v38 offset:10752
    ds_write_b32 v16, v39 offset:10240
    s_waitcnt lgkmcnt(0)
    s_barrier
    s_branch L_p4_done
L_p4_compute:
    v_mov_b32 v0, v6
    v_mov_b32 v1, v7
    s_barrier
    ds_read_b64_tr_b16 v[24:25], v6 offset:0
    ds_read_b64_tr_b16 v[26:27], v6 offset:1024
    ds_read_b128 v[16:19], v2
    ds_read_b128 v[20:23], v2 offset:4096
    ds_read_b64_tr_b16 v[28:29], v7 offset:0
    ds_read_b64_tr_b16 v[30:31], v7 offset:1024
    ds_read_b64_tr_b16 v[40:41], v6 offset:4096
    ds_read_b64_tr_b16 v[42:43], v6 offset:5120
    ds_read_b128 v[32:35], v3
    ds_read_b128 v[36:39], v3 offset:4096
    ds_read_b64_tr_b16 v[44:45], v7 offset:4096
    ds_read_b64_tr_b16 v[46:47], v7 offset:5120
    ds_read_b64_tr_b16 v[56:57], v6 offset:8192
    ds_read_b64_tr_b16 v[58:59], v6 offset:9216
    ds_read_b128 v[48:51], v4
    ds_read_b128 v[52:55], v4 offset:4096
    ds_read_b64_tr_b16 v[60:61], v7 offset:8192
    ds_read_b64_tr_b16 v[62:63], v7 offset:9216
    s_mov_b32 s52, 0
    s_mov_b32 s69, 1
    s_mov_b32 s65, 32768
    v_add_u32 v2, s65, v2
    v_add_u32 v3, s65, v3
.p2align 5
L_p4_cloop:
    s_waitcnt lgkmcnt(12)
    v_mfma_f32_32x32x16_bf16 v[80:95], v[24:27], v[16:19], v[80:95]
    ds_read_b64_tr_b16 v[72:73], v0 offset:12288
    ds_read_b64_tr_b16 v[74:75], v0 offset:13312
    v_add_u32 v4, s65, v4
    v_mfma_f32_32x32x16_bf16 v[112:127], v[24:27], v[20:23], v[112:127]
    ds_read_b128 v[64:67], v5
    v_add_u32 v6, s65, v6
    v_mfma_f32_32x32x16_bf16 v[96:111], v[28:31], v[16:19], v[96:111]
    ds_read_b128 v[68:71], v5 offset:4096
    v_add_u32 v7, s65, v7
    v_mfma_f32_32x32x16_bf16 v[128:143], v[28:31], v[20:23], v[128:143]
    ds_read_b64_tr_b16 v[76:77], v1 offset:12288
    ds_read_b64_tr_b16 v[78:79], v1 offset:13312
    s_barrier
    s_waitcnt lgkmcnt(12)
    v_mfma_f32_32x32x16_bf16 v[80:95], v[40:43], v[32:35], v[80:95]
    ds_read_b64_tr_b16 v[24:25], v6 offset:0
    ds_read_b64_tr_b16 v[26:27], v6 offset:1024
    v_add_u32 v5, s65, v5
    s_cmp_eq_u32 s69, 3
    v_mfma_f32_32x32x16_bf16 v[112:127], v[40:43], v[36:39], v[112:127]
    ds_read_b128 v[16:19], v2
    s_mov_b32 s61, 32768
    s_cselect_b32 s61, 0xfffe8000, s61
    v_mfma_f32_32x32x16_bf16 v[96:111], v[44:47], v[32:35], v[96:111]
    ds_read_b128 v[20:23], v2 offset:4096
    v_mov_b32 v0, v6
    s_cselect_b32 s69, -1, s69
    v_mfma_f32_32x32x16_bf16 v[128:143], v[44:47], v[36:39], v[128:143]
    ds_read_b64_tr_b16 v[28:29], v7 offset:0
    ds_read_b64_tr_b16 v[30:31], v7 offset:1024
    v_mov_b32 v1, v7
    s_add_u32 s69, s69, 1
    s_waitcnt lgkmcnt(12)
    v_mfma_f32_32x32x16_bf16 v[80:95], v[56:59], v[48:51], v[80:95]
    ds_read_b64_tr_b16 v[40:41], v6 offset:4096
    ds_read_b64_tr_b16 v[42:43], v6 offset:5120
    v_add_u32 v2, s61, v2
    v_mfma_f32_32x32x16_bf16 v[112:127], v[56:59], v[52:55], v[112:127]
    ds_read_b128 v[32:35], v3
    s_add_u32 s52, s52, 1
    v_mfma_f32_32x32x16_bf16 v[96:111], v[60:63], v[48:51], v[96:111]
    ds_read_b128 v[36:39], v3 offset:4096
    v_mfma_f32_32x32x16_bf16 v[128:143], v[60:63], v[52:55], v[128:143]
    ds_read_b64_tr_b16 v[44:45], v7 offset:4096
    ds_read_b64_tr_b16 v[46:47], v7 offset:5120
    s_waitcnt lgkmcnt(12)
    v_mfma_f32_32x32x16_bf16 v[80:95], v[72:75], v[64:67], v[80:95]
    ds_read_b64_tr_b16 v[56:57], v6 offset:8192
    ds_read_b64_tr_b16 v[58:59], v6 offset:9216
    v_add_u32 v3, s61, v3
    v_mfma_f32_32x32x16_bf16 v[112:127], v[72:75], v[68:71], v[112:127]
    ds_read_b128 v[48:51], v4
    s_mov_b32 s65, s61
    v_mfma_f32_32x32x16_bf16 v[96:111], v[76:79], v[64:67], v[96:111]
    ds_read_b128 v[52:55], v4 offset:4096
    s_cmp_lt_u32 s52, 10
    v_mfma_f32_32x32x16_bf16 v[128:143], v[76:79], v[68:71], v[128:143]
    ds_read_b64_tr_b16 v[60:61], v7 offset:8192
    ds_read_b64_tr_b16 v[62:63], v7 offset:9216
    s_cbranch_scc1 L_p4_cloop
    s_waitcnt lgkmcnt(0)
    v_mbcnt_lo_u32_b32 v1, -1, 0
    v_mbcnt_hi_u32_b32 v1, -1, v1
    s_lshl_b32 s56, s64, 8
    s_lshl_b32 s57, s63, 7
    s_add_u32 s56, s56, s57
    s_add_u32 s56, s56, 141312
    v_lshlrev_b32 v16, 2, v1
    v_add_u32 v16, s56, v16
    s_barrier
    s_cmp_eq_u32 s50, 13
    s_cselect_b32 s56, s64, 0
    s_cmp_eq_u32 s56, 1
    s_cbranch_scc1 L_p4_skip
    v_and_b32 v2, 31, v1
    s_lshl_b32 s56, s63, 6
    v_add_u32 v3, s56, v2
    v_lshlrev_b32 v3, 2, v3
    v_add_u32 v3, 131072, v3
    ds_read_b32 v4, v3 offset:9216
    ds_read_b32 v5, v3 offset:9728
    ds_read_b32 v6, v3 offset:9344
    ds_read_b32 v7, v3 offset:9856
    v_lshrrev_b32 v8, 5, v1
    s_lshl_b32 s56, s64, 8
    s_lshl_b32 s57, s63, 7
    s_add_u32 s56, s56, s57
    s_add_u32 s56, s56, 141312
    v_lshlrev_b32 v9, 4, v8
    v_add_u32 v9, s56, v9
    v_xor_b32 v3, 128, v9
    ds_read_b128 v[16:19], v9 offset:0
    ds_read_b128 v[20:23], v9 offset:32
    ds_read_b128 v[24:27], v9 offset:64
    ds_read_b128 v[28:31], v9 offset:96
    ds_read_b128 v[32:35], v3 offset:0
    ds_read_b128 v[36:39], v3 offset:32
    ds_read_b128 v[40:43], v3 offset:64
    ds_read_b128 v[44:47], v3 offset:96
    ds_read_b128 v[48:51], v9 offset:512
    ds_read_b128 v[52:55], v9 offset:544
    ds_read_b128 v[56:59], v9 offset:576
    ds_read_b128 v[60:63], v9 offset:608
    ds_read_b128 v[64:67], v3 offset:512
    ds_read_b128 v[68:71], v3 offset:544
    ds_read_b128 v[72:75], v3 offset:576
    ds_read_b128 v[76:79], v3 offset:608
    s_add_u32 s36, s24, 0x1000000
    s_addc_u32 s37, s25, 0
    s_mov_b32 s38, 0x6c0000
    s_mov_b32 s39, 0x20000
    s_mov_b32 s96, s36
    s_mov_b32 s97, s37
    s_mov_b32 s99, 0x20000
    s_cmp_eq_u32 s11, 1
    s_cselect_b32 s98, s38, 0
    s_cselect_b32 s38, 0, s38
    s_lshl_b32 s56, s49, 1
    s_add_u32 s56, s56, s63
    s_mul_i32 s56, s56, 221184
    s_lshl_b32 s57, s50, 2
    s_lshl_b32 s58, s64, 1
    s_add_u32 s57, s57, s58
    s_add_u32 s58, s57, s63
    s_xor_b32 s59, s63, 1
    s_add_u32 s59, s57, s59
    s_lshl_b32 s58, s58, 12
    s_lshl_b32 s59, s59, 12
    s_add_u32 s60, s56, s58
    s_add_u32 s61, s56, s59
    v_bfe_u32 v10, v1, 4, 1
    v_lshlrev_b32 v10, 10, v10
    v_and_b32 v11, 15, v1
    v_lshl_add_u32 v10, v11, 4, v10
    v_lshl_add_u32 v10, v8, 8, v10
    s_waitcnt lgkmcnt(0)
    v_pk_fma_f32 v[80:81], v[80:81], v[4:5], v[48:49] op_sel:[0,0,0] op_sel_hi:[1,0,1]
    v_pk_fma_f32 v[80:81], v[16:17], v[4:5], v[80:81] op_sel:[0,1,0] op_sel_hi:[1,1,1]
    v_max_f32 v80, 0, v80
    v_max_f32 v81, 0, v81
    v_pk_mul_f32 v[80:81], v[80:81], v[80:81]
    v_pk_fma_f32 v[82:83], v[82:83], v[4:5], v[50:51] op_sel:[0,0,0] op_sel_hi:[1,0,1]
    v_pk_fma_f32 v[82:83], v[18:19], v[4:5], v[82:83] op_sel:[0,1,0] op_sel_hi:[1,1,1]
    v_max_f32 v82, 0, v82
    v_max_f32 v83, 0, v83
    v_pk_mul_f32 v[82:83], v[82:83], v[82:83]
    v_pk_fma_f32 v[84:85], v[84:85], v[4:5], v[52:53] op_sel:[0,0,0] op_sel_hi:[1,0,1]
    v_pk_fma_f32 v[84:85], v[20:21], v[4:5], v[84:85] op_sel:[0,1,0] op_sel_hi:[1,1,1]
    v_max_f32 v84, 0, v84
    v_max_f32 v85, 0, v85
    v_pk_mul_f32 v[84:85], v[84:85], v[84:85]
    v_pk_fma_f32 v[86:87], v[86:87], v[4:5], v[54:55] op_sel:[0,0,0] op_sel_hi:[1,0,1]
    v_pk_fma_f32 v[86:87], v[22:23], v[4:5], v[86:87] op_sel:[0,1,0] op_sel_hi:[1,1,1]
    v_max_f32 v86, 0, v86
    v_max_f32 v87, 0, v87
    v_pk_mul_f32 v[86:87], v[86:87], v[86:87]
    v_cvt_pk_bf16_f32 v80, v80, v81
    v_cvt_pk_bf16_f32 v81, v82, v83
    v_cvt_pk_bf16_f32 v82, v84, v85
    v_cvt_pk_bf16_f32 v83, v86, v87
    s_nop 1
    v_permlane32_swap_b32 v80, v82
    v_permlane32_swap_b32 v81, v83
    buffer_store_dwordx4 v[80:83], v10, s[36:39], s60 offen offset:0 sc1
    buffer_store_dwordx4 v[80:83], v10, s[96:99], s60 offen offset:0
    v_pk_fma_f32 v[88:89], v[88:89], v[4:5], v[56:57] op_sel:[0,0,0] op_sel_hi:[1,0,1]
    v_pk_fma_f32 v[88:89], v[24:25], v[4:5], v[88:89] op_sel:[0,1,0] op_sel_hi:[1,1,1]
    v_max_f32 v88, 0, v88
    v_max_f32 v89, 0, v89
    v_pk_mul_f32 v[88:89], v[88:89], v[88:89]
    v_pk_fma_f32 v[90:91], v[90:91], v[4:5], v[58:59] op_sel:[0,0,0] op_sel_hi:[1,0,1]
    v_pk_fma_f32 v[90:91], v[26:27], v[4:5], v[90:91] op_sel:[0,1,0] op_sel_hi:[1,1,1]
    v_max_f32 v90, 0, v90
    v_max_f32 v91, 0, v91
    v_pk_mul_f32 v[90:91], v[90:91], v[90:91]
    v_pk_fma_f32 v[92:93], v[92:93], v[4:5], v[60:61] op_sel:[0,0,0] op_sel_hi:[1,0,1]
    v_pk_fma_f32 v[92:93], v[28:29], v[4:5], v[92:93] op_sel:[0,1,0] op_sel_hi:[1,1,1]
    v_max_f32 v92, 0, v92
    v_max_f32 v93, 0, v93
    v_pk_mul_f32 v[92:93], v[92:93], v[92:93]
    v_pk_fma_f32 v[94:95], v[94:95], v[4:5], v[62:63] op_sel:[0,0,0] op_sel_hi:[1,0,1]
    v_pk_fma_f32 v[94:95], v[30:31], v[4:5], v[94:95] op_sel:[0,1,0] op_sel_hi:[1,1,1]
    v_max_f32 v94, 0, v94
    v_max_f32 v95, 0, v95
    v_pk_mul_f32 v[94:95], v[94:95], v[94:95]
    v_cvt_pk_bf16_f32 v88, v88, v89
    v_cvt_pk_bf16_f32 v89, v90, v91
    v_cvt_pk_bf16_f32 v90, v92, v93
    v_cvt_pk_bf16_f32 v91, v94, v95
    s_nop 1
    v_permlane32_swap_b32 v88, v90
    v_permlane32_swap_b32 v89, v91
    buffer_store_dwordx4 v[88:91], v10, s[36:39], s60 offen offset:512 sc1
    buffer_store_dwordx4 v[88:91], v10, s[96:99], s60 offen offset:512
    v_pk_fma_f32 v[96:97], v[96:97], v[4:5], v[64:65] op_sel:[0,0,0] op_sel_hi:[1,0,1]
    v_pk_fma_f32 v[96:97], v[32:33], v[4:5], v[96:97] op_sel:[0,1,0] op_sel_hi:[1,1,1]
    v_max_f32 v96, 0, v96
    v_max_f32 v97, 0, v97
    v_pk_mul_f32 v[96:97], v[96:97], v[96:97]
    v_pk_fma_f32 v[98:99], v[98:99], v[4:5], v[66:67] op_sel:[0,0,0] op_sel_hi:[1,0,1]
    v_pk_fma_f32 v[98:99], v[34:35], v[4:5], v[98:99] op_sel:[0,1,0] op_sel_hi:[1,1,1]
    v_max_f32 v98, 0, v98
    v_max_f32 v99, 0, v99
    v_pk_mul_f32 v[98:99], v[98:99], v[98:99]
    v_pk_fma_f32 v[100:101], v[100:101], v[4:5], v[68:69] op_sel:[0,0,0] op_sel_hi:[1,0,1]
    v_pk_fma_f32 v[100:101], v[36:37], v[4:5], v[100:101] op_sel:[0,1,0] op_sel_hi:[1,1,1]
    v_max_f32 v100, 0, v100
    v_max_f32 v101, 0, v101
    v_pk_mul_f32 v[100:101], v[100:101], v[100:101]
    v_pk_fma_f32 v[102:103], v[102:103], v[4:5], v[70:71] op_sel:[0,0,0] op_sel_hi:[1,0,1]
    v_pk_fma_f32 v[102:103], v[38:39], v[4:5], v[102:103] op_sel:[0,1,0] op_sel_hi:[1,1,1]
    v_max_f32 v102, 0, v102
    v_max_f32 v103, 0, v103
    v_pk_mul_f32 v[102:103], v[102:103], v[102:103]
    v_cvt_pk_bf16_f32 v96, v96, v97
    v_cvt_pk_bf16_f32 v97, v98, v99
    v_cvt_pk_bf16_f32 v98, v100, v101
    v_cvt_pk_bf16_f32 v99, v102, v103
    s_nop 1
    v_permlane32_swap_b32 v96, v98
    v_permlane32_swap_b32 v97, v99
    buffer_store_dwordx4 v[96:99], v10, s[36:39], s61 offen offset:0 sc1
    buffer_store_dwordx4 v[96:99], v10, s[96:99], s61 offen offset:0
    v_pk_fma_f32 v[104:105], v[104:105], v[4:5], v[72:73] op_sel:[0,0,0] op_sel_hi:[1,0,1]
    v_pk_fma_f32 v[104:105], v[40:41], v[4:5], v[104:105] op_sel:[0,1,0] op_sel_hi:[1,1,1]
    v_max_f32 v104, 0, v104
    v_max_f32 v105, 0, v105
    v_pk_mul_f32 v[104:105], v[104:105], v[104:105]
    v_pk_fma_f32 v[106:107], v[106:107], v[4:5], v[74:75] op_sel:[0,0,0] op_sel_hi:[1,0,1]
    v_pk_fma_f32 v[106:107], v[42:43], v[4:5], v[106:107] op_sel:[0,1,0] op_sel_hi:[1,1,1]
    v_max_f32 v106, 0, v106
    v_max_f32 v107, 0, v107
    v_pk_mul_f32 v[106:107], v[106:107], v[106:107]
    v_pk_fma_f32 v[108:109], v[108:109], v[4:5], v[76:77] op_sel:[0,0,0] op_sel_hi:[1,0,1]
    v_pk_fma_f32 v[108:109], v[44:45], v[4:5], v[108:109] op_sel:[0,1,0] op_sel_hi:[1,1,1]
    v_max_f32 v108, 0, v108
    v_max_f32 v109, 0, v109
    v_pk_mul_f32 v[108:109], v[108:109], v[108:109]
    v_pk_fma_f32 v[110:111], v[110:111], v[4:5], v[78:79] op_sel:[0,0,0] op_sel_hi:[1,0,1]
    v_pk_fma_f32 v[110:111], v[46:47], v[4:5], v[110:111] op_sel:[0,1,0] op_sel_hi:[1,1,1]
    v_max_f32 v110, 0, v110
    v_max_f32 v111, 0, v111
    v_pk_mul_f32 v[110:111], v[110:111], v[110:111]
    v_cvt_pk_bf16_f32 v104, v104, v105
    v_cvt_pk_bf16_f32 v105, v106, v107
    v_cvt_pk_bf16_f32 v106, v108, v109
    v_cvt_pk_bf16_f32 v107, v110, v111
    s_nop 1
    v_permlane32_swap_b32 v104, v106
    v_permlane32_swap_b32 v105, v107
    buffer_store_dwordx4 v[104:107], v10, s[36:39], s61 offen offset:512 sc1
    buffer_store_dwordx4 v[104:107], v10, s[96:99], s61 offen offset:512
    v_pk_fma_f32 v[112:113], v[112:113], v[6:7], v[48:49] op_sel:[0,0,0] op_sel_hi:[1,0,1]
    v_pk_fma_f32 v[112:113], v[16:17], v[6:7], v[112:113] op_sel:[0,1,0] op_sel_hi:[1,1,1]
    v_max_f32 v112, 0, v112
    v_max_f32 v113, 0, v113
    v_pk_mul_f32 v[112:113], v[112:113], v[112:113]
    v_pk_fma_f32 v[114:115], v[114:115], v[6:7], v[50:51] op_sel:[0,0,0] op_sel_hi:[1,0,1]
    v_pk_fma_f32 v[114:115], v[18:19], v[6:7], v[114:115] op_sel:[0,1,0] op_sel_hi:[1,1,1]
    v_max_f32 v114, 0, v114
    v_max_f32 v115, 0, v115
    v_pk_mul_f32 v[114:115], v[114:115], v[114:115]
    v_pk_fma_f32 v[116:117], v[116:117], v[6:7], v[52:53] op_sel:[0,0,0] op_sel_hi:[1,0,1]
    v_pk_fma_f32 v[116:117], v[20:21], v[6:7], v[116:117] op_sel:[0,1,0] op_sel_hi:[1,1,1]
    v_max_f32 v116, 0, v116
    v_max_f32 v117, 0, v117
    v_pk_mul_f32 v[116:117], v[116:117], v[116:117]
    v_pk_fma_f32 v[118:119], v[118:119], v[6:7], v[54:55] op_sel:[0,0,0] op_sel_hi:[1,0,1]
    v_pk_fma_f32 v[118:119], v[22:23], v[6:7], v[118:119] op_sel:[0,1,0] op_sel_hi:[1,1,1]
    v_max_f32 v118, 0, v118
    v_max_f32 v119, 0, v119
    v_pk_mul_f32 v[118:119], v[118:119], v[118:119]
    v_cvt_pk_bf16_f32 v112, v112, v113
    v_cvt_pk_bf16_f32 v113, v114, v115
    v_cvt_pk_bf16_f32 v114, v116, v117
    v_cvt_pk_bf16_f32 v115, v118, v119
    s_nop 1
    v_permlane32_swap_b32 v112, v114
    v_permlane32_swap_b32 v113, v115
    buffer_store_dwordx4 v[112:115], v10, s[36:39], s60 offen offset:2048 sc1
    buffer_store_dwordx4 v[112:115], v10, s[96:99], s60 offen offset:2048
    v_pk_fma_f32 v[120:121], v[120:121], v[6:7], v[56:57] op_sel:[0,0,0] op_sel_hi:[1,0,1]
    v_pk_fma_f32 v[120:121], v[24:25], v[6:7], v[120:121] op_sel:[0,1,0] op_sel_hi:[1,1,1]
    v_max_f32 v120, 0, v120
    v_max_f32 v121, 0, v121
    v_pk_mul_f32 v[120:121], v[120:121], v[120:121]
    v_pk_fma_f32 v[122:123], v[122:123], v[6:7], v[58:59] op_sel:[0,0,0] op_sel_hi:[1,0,1]
    v_pk_fma_f32 v[122:123], v[26:27], v[6:7], v[122:123] op_sel:[0,1,0] op_sel_hi:[1,1,1]
    v_max_f32 v122, 0, v122
    v_max_f32 v123, 0, v123
    v_pk_mul_f32 v[122:123], v[122:123], v[122:123]
    v_pk_fma_f32 v[124:125], v[124:125], v[6:7], v[60:61] op_sel:[0,0,0] op_sel_hi:[1,0,1]
    v_pk_fma_f32 v[124:125], v[28:29], v[6:7], v[124:125] op_sel:[0,1,0] op_sel_hi:[1,1,1]
    v_max_f32 v124, 0, v124
    v_max_f32 v125, 0, v125
    v_pk_mul_f32 v[124:125], v[124:125], v[124:125]
    v_pk_fma_f32 v[126:127], v[126:127], v[6:7], v[62:63] op_sel:[0,0,0] op_sel_hi:[1,0,1]
    v_pk_fma_f32 v[126:127], v[30:31], v[6:7], v[126:127] op_sel:[0,1,0] op_sel_hi:[1,1,1]
    v_max_f32 v126, 0, v126
    v_max_f32 v127, 0, v127
    v_pk_mul_f32 v[126:127], v[126:127], v[126:127]
    v_cvt_pk_bf16_f32 v120, v120, v121
    v_cvt_pk_bf16_f32 v121, v122, v123
    v_cvt_pk_bf16_f32 v122, v124, v125
    v_cvt_pk_bf16_f32 v123, v126, v127
    s_nop 1
    v_permlane32_swap_b32 v120, v122
    v_permlane32_swap_b32 v121, v123
    buffer_store_dwordx4 v[120:123], v10, s[36:39], s60 offen offset:2560 sc1
    buffer_store_dwordx4 v[120:123], v10, s[96:99], s60 offen offset:2560
    v_pk_fma_f32 v[128:129], v[128:129], v[6:7], v[64:65] op_sel:[0,0,0] op_sel_hi:[1,0,1]
    v_pk_fma_f32 v[128:129], v[32:33], v[6:7], v[128:129] op_sel:[0,1,0] op_sel_hi:[1,1,1]
    v_max_f32 v128, 0, v128
    v_max_f32 v129, 0, v129
    v_pk_mul_f32 v[128:129], v[128:129], v[128:129]
    v_pk_fma_f32 v[130:131], v[130:131], v[6:7], v[66:67] op_sel:[0,0,0] op_sel_hi:[1,0,1]
    v_pk_fma_f32 v[130:131], v[34:35], v[6:7], v[130:131] op_sel:[0,1,0] op_sel_hi:[1,1,1]
    v_max_f32 v130, 0, v130
    v_max_f32 v131, 0, v131
    v_pk_mul_f32 v[130:131], v[130:131], v[130:131]
    v_pk_fma_f32 v[132:133], v[132:133], v[6:7], v[68:69] op_sel:[0,0,0] op_sel_hi:[1,0,1]
    v_pk_fma_f32 v[132:133], v[36:37], v[6:7], v[132:133] op_sel:[0,1,0] op_sel_hi:[1,1,1]
    v_max_f32 v132, 0, v132
    v_max_f32 v133, 0, v133
    v_pk_mul_f32 v[132:133], v[132:133], v[132:133]
    v_pk_fma_f32 v[134:135], v[134:135], v[6:7], v[70:71] op_sel:[0,0,0] op_sel_hi:[1,0,1]
    v_pk_fma_f32 v[134:135], v[38:39], v[6:7], v[134:135] op_sel:[0,1,0] op_sel_hi:[1,1,1]
    v_max_f32 v134, 0, v134
    v_max_f32 v135, 0, v135
    v_pk_mul_f32 v[134:135], v[134:135], v[134:135]
    v_cvt_pk_bf16_f32 v128, v128, v129
    v_cvt_pk_bf16_f32 v129, v130, v131
    v_cvt_pk_bf16_f32 v130, v132, v133
    v_cvt_pk_bf16_f32 v131, v134, v135
    s_nop 1
    v_permlane32_swap_b32 v128, v130
    v_permlane32_swap_b32 v129, v131
    buffer_store_dwordx4 v[128:131], v10, s[36:39], s61 offen offset:2048 sc1
    buffer_store_dwordx4 v[128:131], v10, s[96:99], s61 offen offset:2048
    v_pk_fma_f32 v[136:137], v[136:137], v[6:7], v[72:73] op_sel:[0,0,0] op_sel_hi:[1,0,1]
    v_pk_fma_f32 v[136:137], v[40:41], v[6:7], v[136:137] op_sel:[0,1,0] op_sel_hi:[1,1,1]
    v_max_f32 v136, 0, v136
    v_max_f32 v137, 0, v137
    v_pk_mul_f32 v[136:137], v[136:137], v[136:137]
    v_pk_fma_f32 v[138:139], v[138:139], v[6:7], v[74:75] op_sel:[0,0,0] op_sel_hi:[1,0,1]
    v_pk_fma_f32 v[138:139], v[42:43], v[6:7], v[138:139] op_sel:[0,1,0] op_sel_hi:[1,1,1]
    v_max_f32 v138, 0, v138
    v_max_f32 v139, 0, v139
    v_pk_mul_f32 v[138:139], v[138:139], v[138:139]
    v_pk_fma_f32 v[140:141], v[140:141], v[6:7], v[76:77] op_sel:[0,0,0] op_sel_hi:[1,0,1]
    v_pk_fma_f32 v[140:141], v[44:45], v[6:7], v[140:141] op_sel:[0,1,0] op_sel_hi:[1,1,1]
    v_max_f32 v140, 0, v140
    v_max_f32 v141, 0, v141
    v_pk_mul_f32 v[140:141], v[140:141], v[140:141]
    v_pk_fma_f32 v[142:143], v[142:143], v[6:7], v[78:79] op_sel:[0,0,0] op_sel_hi:[1,0,1]
    v_pk_fma_f32 v[142:143], v[46:47], v[6:7], v[142:143] op_sel:[0,1,0] op_sel_hi:[1,1,1]
    v_max_f32 v142, 0, v142
    v_max_f32 v143, 0, v143
    v_pk_mul_f32 v[142:143], v[142:143], v[142:143]
    v_cvt_pk_bf16_f32 v136, v136, v137
    v_cvt_pk_bf16_f32 v137, v138, v139
    v_cvt_pk_bf16_f32 v138, v140, v141
    v_cvt_pk_bf16_f32 v139, v142, v143
    s_nop 1
    v_permlane32_swap_b32 v136, v138
    v_permlane32_swap_b32 v137, v139
    buffer_store_dwordx4 v[136:139], v10, s[36:39], s61 offen offset:2560 sc1
    buffer_store_dwordx4 v[136:139], v10, s[96:99], s61 offen offset:2560
L_p4_skip:
L_p4_done:
    v_lshlrev_b32 v66, 3, v1
    v_add_u32 v66, s27, v66
    v_lshlrev_b32 v66, 7, v66
    s_lshl_b32 s57, s48, 2
    s_add_u32 s57, s57, 393216
    v_add_u32 v66, s57, v66
    v_mov_b32 v67, s26
    s_waitcnt vmcnt(0) lgkmcnt(0)
    s_barrier
    s_cmp_lg_u32 s3, 0
    s_cbranch_scc1 L_gb45_gskip0
    s_mov_b32 exec_lo, 0xffffffff
    s_mov_b32 exec_hi, 0x0
    s_cmp_eq_u32 s11, 1
    s_cbranch_scc1 L_gb45_gskipf
    buffer_store_dword v67, v66, s[40:43], 0 offen sc1
    s_branch L_gb45_gskipg
L_gb45_gskipf:
    buffer_store_dword v67, v66, s[40:43], 0 offen
L_gb45_gskipg:
    s_mov_b64 exec, -1
L_gb45_gskip0:
    s_lshr_b32 s56, s48, 3
    s_lshl_b32 s57, s27, 2
    s_add_u32 s49, s56, s57
    s_and_b32 s50, s48, 7
    s_mul_i32 s56, s49, 221184
    s_add_u32 s56, s56, 0x1000000
    s_add_u32 s28, s24, s56
    s_addc_u32 s29, s25, 0
    s_mov_b32 s30, 221184
    s_mov_b32 s31, 0x20000
    s_lshl_b32 s62, s3, 10
    v_lshlrev_b32 v2, 4, v1
    s_and_b32 s56, s3, 3
    s_add_u32 s57, s56, 0
    s_and_b32 s57, s57, 3
    s_lshl_b32 s57, s57, 10
    s_lshl_b32 s58, s56, 12
    s_add_u32 s57, s57, s58
    v_add_u32 v84, s57, v2
    s_add_u32 s57, s56, 1
    s_and_b32 s57, s57, 3
    s_lshl_b32 s57, s57, 10
    s_lshl_b32 s58, s56, 12
    s_add_u32 s57, s57, s58
    v_add_u32 v85, s57, v2
    s_add_u32 s57, s56, 2
    s_and_b32 s57, s57, 3
    s_lshl_b32 s57, s57, 10
    s_lshl_b32 s58, s56, 12
    s_add_u32 s57, s57, s58
    v_add_u32 v86, s57, v2
    s_add_u32 s57, s56, 3
    s_and_b32 s57, s57, 3
    s_lshl_b32 s57, s57, 10
    s_lshl_b32 s58, s56, 12
    s_add_u32 s57, s57, s58
    v_add_u32 v87, s57, v2
    s_lshl_b32 s56, s49, 6
    s_and_b32 s57, s3, 3
    s_lshl_b32 s57, s57, 4
    s_add_u32 s56, s56, s57
    v_and_b32 v3, 15, v1
    v_add_u32 v3, s56, v3
    v_mul_u32_u24 v3, 1280, v3
    s_mul_i32 s56, s50, 160
    s_cmp_lt_u32 s3, 4
    s_cselect_b32 s57, 96, 0
    s_add_u32 s56, s56, s57
    v_lshrrev_b32 v64, 4, v1
    v_lshlrev_b32 v64, 3, v64
    v_add_u32 v64, s56, v64
    v_add_u32 v3, v3, v64
    s_add_u32 s44, s24, 0xd00000
    s_addc_u32 s45, s25, 0
    s_mov_b32 s46, 0x280000
    s_mov_b32 s47, 0x20000
    s_lshl_b32 s56, s49, 6
    s_and_b32 s57, s3, 3
    s_lshl_b32 s57, s57, 4
    s_add_u32 s56, s56, s57
    s_lshr_b32 s57, s56, 7
    s_mul_i32 s57, s57, 163840
    s_and_b32 s56, s56, 127
    v_and_b32 v71, 15, v1
    v_add_u32 v71, s56, v71
    v_bfe_u32 v69, v71, 1, 3
    v_lshlrev_b32 v68, 7, v71
    v_add_u32 v68, s57, v68
    s_mul_i32 s56, s50, 80
    s_cmp_lt_u32 s3, 4
    s_cselect_b32 s57, 48, 0
    s_add_u32 s56, s56, s57
    v_lshrrev_b32 v70, 4, v1
    v_lshlrev_b32 v70, 2, v70
    v_add_u32 v70, s56, v70
    v_add_u32 v73, 0, v70
    v_lshrrev_b32 v72, 6, v73
    v_lshlrev_b32 v72, 14, v72
    v_add_u32 v72, v72, v68
    v_bfe_u32 v74, v73, 3, 3
    v_xor_b32 v74, v74, v69
    v_lshl_add_u32 v72, v74, 4, v72
    v_bfe_u32 v74, v73, 2, 1
    v_lshl_add_u32 v72, v74, 3, v72
    buffer_load_dwordx2 v[52:53], v72, s[44:47], 0 offen sc1
    v_add_u32 v73, 16, v70
    v_lshrrev_b32 v72, 6, v73
    v_lshlrev_b32 v72, 14, v72
    v_add_u32 v72, v72, v68
    v_bfe_u32 v74, v73, 3, 3
    v_xor_b32 v74, v74, v69
    v_lshl_add_u32 v72, v74, 4, v72
    v_bfe_u32 v74, v73, 2, 1
    v_lshl_add_u32 v72, v74, 3, v72
    buffer_load_dwordx2 v[54:55], v72, s[44:47], 0 offen sc1
    v_add_u32 v73, 32, v70
    v_lshrrev_b32 v72, 6, v73
    v_lshlrev_b32 v72, 14, v72
    v_add_u32 v72, v72, v68
    v_bfe_u32 v74, v73, 3, 3
    v_xor_b32 v74, v74, v69
    v_lshl_add_u32 v72, v74, 4, v72
    v_bfe_u32 v74, v73, 2, 1
    v_lshl_add_u32 v72, v74, 3, v72
    buffer_load_dwordx2 v[56:57], v72, s[44:47], 0 offen sc1
    s_mov_b32 s44, s18
    s_mov_b32 s45, s19
    s_mov_b32 s46, 0x500
    s_mov_b32 s47, 0x20000
    buffer_load_dwordx2 v[58:59], v64, s[44:47], 0 offen offset:0
    buffer_load_dwordx2 v[60:61], v64, s[44:47], 0 offen offset:32
    buffer_load_dwordx2 v[62:63], v64, s[44:47], 0 offen offset:64
    v_mov_b32 v16, 0
    v_mov_b32 v17, 0
    v_mov_b32 v18, 0
    v_mov_b32 v19, 0
    v_mov_b32 v20, 0
    v_mov_b32 v21, 0
    v_mov_b32 v22, 0
    v_mov_b32 v23, 0
    v_mov_b32 v24, 0
    v_mov_b32 v25, 0
    v_mov_b32 v26, 0
    v_mov_b32 v27, 0
    v_mov_b32 v28, 0
    v_mov_b32 v29, 0
    v_mov_b32 v30, 0
    v_mov_b32 v31, 0
    v_mov_b32 v32, 0
    v_mov_b32 v33, 0
    v_mov_b32 v34, 0
    v_mov_b32 v35, 0
    v_mov_b32 v36, 0
    v_mov_b32 v37, 0
    v_mov_b32 v38, 0
    v_mov_b32 v39, 0
    v_mov_b32 v40, 0
    v_mov_b32 v41, 0
    v_mov_b32 v42, 0
    v_mov_b32 v43, 0
    v_mov_b32 v44, 0
    v_mov_b32 v45, 0
    v_mov_b32 v46, 0
    v_mov_b32 v47, 0
    v_mov_b32 v48, 0
    v_mov_b32 v49, 0
    v_mov_b32 v50, 0
    v_mov_b32 v51, 0
    s_cmp_lg_u32 s3, 0
    s_cbranch_scc1 L_gb45_gskip
    s_lshl_b32 s56, s2, 7
    s_add_u32 s56, s56, 393216
    v_lshlrev_b32 v68, 2, v1
    v_add_u32 v68, s56, v68
    s_mov_b32 s56, 0
L_gb45_poll:
    s_mov_b32 exec_lo, 0xffffffff
    s_mov_b32 exec_hi, 0x0
    buffer_load_dword v78, v68, s[40:43], 0 offen sc1
    s_waitcnt vmcnt(0)
    s_mov_b64 s[90:91], 0
    s_mov_b32 exec_lo, 0xffffffff
    s_mov_b32 exec_hi, 0x0
    v_cmp_ne_u32 vcc, s26, v78
    s_or_b64 s[90:91], s[90:91], vcc
    s_mov_b64 exec, -1
    s_cmp_eq_u64 s[90:91], 0
    s_cbranch_scc1 L_gb45_pollok
    s_add_u32 s56, s56, 1
    s_cmp_lt_u32 s56, 0x40000
    s_cbranch_scc1 L_gb45_poll
L_gb45_pollok:
L_gb45_gskip:
    s_barrier
    s_cmp_lt_u32 s3, 4
    s_cbranch_scc1 L_g2p5_n1
    s_setprio 1
    s_add_u32 m0, s62, 0
    s_add_u32 s58, s62, 0
    buffer_load_dwordx4 v2, s[28:31], s58 offen sc1 lds
    s_add_u32 m0, s62, 8192
    s_add_u32 s58, s62, 8192
    buffer_load_dwordx4 v2, s[28:31], s58 offen sc1 lds
    s_add_u32 m0, s62, 16384
    s_add_u32 s58, s62, 16384
    buffer_load_dwordx4 v2, s[28:31], s58 offen sc1 lds
    s_add_u32 m0, s62, 24576
    s_add_u32 s58, s62, 24576
    buffer_load_dwordx4 v2, s[28:31], s58 offen sc1 lds
    s_add_u32 m0, s62, 32768
    s_add_u32 s58, s62, 32768
    buffer_load_dwordx4 v2, s[28:31], s58 offen sc1 lds
    s_add_u32 m0, s62, 40960
    s_add_u32 s58, s62, 40960
    buffer_load_dwordx4 v2, s[28:31], s58 offen sc1 lds
    s_add_u32 m0, s62, 49152
    s_add_u32 s58, s62, 49152
    buffer_load_dwordx4 v2, s[28:31], s58 offen sc1 lds
    s_add_u32 m0, s62, 57344
    s_add_u32 s58, s62, 57344
    buffer_load_dwordx4 v2, s[28:31], s58 offen sc1 lds
    s_waitcnt vmcnt(8)
    v_lshlrev_b32 v4, 16, v52
    v_and_b32 v5, 0xffff0000, v52
    v_lshlrev_b32 v66, 16, v58
    v_and_b32 v67, 0xffff0000, v58
    v_add_f32 v4, v4, v66
    v_add_f32 v5, v5, v67
    v_lshlrev_b32 v6, 16, v53
    v_and_b32 v7, 0xffff0000, v53
    v_lshlrev_b32 v66, 16, v59
    v_and_b32 v67, 0xffff0000, v59
    v_add_f32 v6, v6, v66
    v_add_f32 v7, v7, v67
    v_lshlrev_b32 v8, 16, v54
    v_and_b32 v9, 0xffff0000, v54
    v_lshlrev_b32 v66, 16, v60
    v_and_b32 v67, 0xffff0000, v60
    v_add_f32 v8, v8, v66
    v_add_f32 v9, v9, v67
    v_lshlrev_b32 v10, 16, v55
    v_and_b32 v11, 0xffff0000, v55
    v_lshlrev_b32 v66, 16, v61
    v_and_b32 v67, 0xffff0000, v61
    v_add_f32 v10, v10, v66
    v_add_f32 v11, v11, v67
    v_lshlrev_b32 v12, 16, v56
    v_and_b32 v13, 0xffff0000, v56
    v_lshlrev_b32 v66, 16, v62
    v_and_b32 v67, 0xffff0000, v62
    v_add_f32 v12, v12, v66
    v_add_f32 v13, v13, v67
    v_lshlrev_b32 v14, 16, v57
    v_and_b32 v15, 0xffff0000, v57
    v_lshlrev_b32 v66, 16, v63
    v_and_b32 v67, 0xffff0000, v63
    v_add_f32 v14, v14, v66
    v_add_f32 v15, v15, v67
    s_waitcnt vmcnt(6)
    s_barrier
    ds_read_b128 v[52:55], v84 offset:0
    ds_read_b128 v[56:59], v85 offset:0
    ds_read_b128 v[60:63], v86 offset:0
    ds_read_b128 v[64:67], v87 offset:0
    s_add_u32 m0, s62, 65536
    s_add_u32 s58, s62, 65536
    buffer_load_dwordx4 v2, s[28:31], s58 offen sc1 lds
    s_add_u32 m0, s62, 73728
    s_add_u32 s58, s62, 73728
    buffer_load_dwordx4 v2, s[28:31], s58 offen sc1 lds
    s_add_u32 m0, s62, 81920
    s_add_u32 s58, s62, 81920
    buffer_load_dwordx4 v2, s[28:31], s58 offen sc1 lds
    s_add_u32 m0, s62, 90112
    s_add_u32 s58, s62, 90112
    buffer_load_dwordx4 v2, s[28:31], s58 offen sc1 lds
    s_waitcnt lgkmcnt(0)
    v_mfma_f32_16x16x32_bf16 v[4:7], v[88:91], v[52:55], v[4:7]
    v_mfma_f32_16x16x32_bf16 v[16:19], v[88:91], v[56:59], v[16:19]
    v_mfma_f32_16x16x32_bf16 v[28:31], v[88:91], v[60:63], v[28:31]
    v_mfma_f32_16x16x32_bf16 v[40:43], v[88:91], v[64:67], v[40:43]
    v_mfma_f32_16x16x32_bf16 v[8:11], v[92:95], v[52:55], v[8:11]
    v_mfma_f32_16x16x32_bf16 v[20:23], v[92:95], v[56:59], v[20:23]
    v_mfma_f32_16x16x32_bf16 v[32:35], v[92:95], v[60:63], v[32:35]
    v_mfma_f32_16x16x32_bf16 v[44:47], v[92:95], v[64:67], v[44:47]
    v_mfma_f32_16x16x32_bf16 v[12:15], v[96:99], v[52:55], v[12:15]
    v_mfma_f32_16x16x32_bf16 v[24:27], v[96:99], v[56:59], v[24:27]
    v_mfma_f32_16x16x32_bf16 v[36:39], v[96:99], v[60:63], v[36:39]
    v_mfma_f32_16x16x32_bf16 v[48:51], v[96:99], v[64:67], v[48:51]
    s_waitcnt vmcnt(4)
    s_barrier
    ds_read_b128 v[68:71], v84 offset:16384
    ds_read_b128 v[72:75], v85 offset:16384
    ds_read_b128 v[76:79], v86 offset:16384
    ds_read_b128 v[80:83], v87 offset:16384
    s_add_u32 m0, s62, 98304
    s_add_u32 s58, s62, 98304
    buffer_load_dwordx4 v2, s[28:31], s58 offen sc1 lds
    s_add_u32 m0, s62, 106496
    s_add_u32 s58, s62, 106496
    buffer_load_dwordx4 v2, s[28:31], s58 offen sc1 lds
    s_add_u32 m0, s62, 114688
    s_add_u32 s58, s62, 114688
    buffer_load_dwordx4 v2, s[28:31], s58 offen sc1 lds
    s_add_u32 m0, s62, 122880
    s_add_u32 s58, s62, 122880
    buffer_load_dwordx4 v2, s[28:31], s58 offen sc1 lds
    ds_read_b128 v[52:55], v84 offset:32768
    ds_read_b128 v[56:59], v85 offset:32768
    ds_read_b128 v[60:63], v86 offset:32768
    ds_read_b128 v[64:67], v87 offset:32768
    s_waitcnt lgkmcnt(4)
    v_mfma_f32_16x16x32_bf16 v[4:7], v[100:103], v[68:71], v[4:7]
    v_mfma_f32_16x16x32_bf16 v[16:19], v[100:103], v[72:75], v[16:19]
    v_mfma_f32_16x16x32_bf16 v[28:31], v[100:103], v[76:79], v[28:31]
    v_mfma_f32_16x16x32_bf16 v[40:43], v[100:103], v[80:83], v[40:43]
    v_mfma_f32_16x16x32_bf16 v[8:11], v[104:107], v[68:71], v[8:11]
    v_mfma_f32_16x16x32_bf16 v[20:23], v[104:107], v[72:75], v[20:23]
    v_mfma_f32_16x16x32_bf16 v[32:35], v[104:107], v[76:79], v[32:35]
    v_mfma_f32_16x16x32_bf16 v[44:47], v[104:107], v[80:83], v[44:47]
    v_mfma_f32_16x16x32_bf16 v[12:15], v[108:111], v[68:71], v[12:15]
    v_mfma_f32_16x16x32_bf16 v[24:27], v[108:111], v[72:75], v[24:27]
    v_mfma_f32_16x16x32_bf16 v[36:39], v[108:111], v[76:79], v[36:39]
    v_mfma_f32_16x16x32_bf16 v[48:51], v[108:111], v[80:83], v[48:51]
    s_waitcnt vmcnt(4)
    s_barrier
    ds_read_b128 v[68:71], v84 offset:49152
    ds_read_b128 v[72:75], v85 offset:49152
    ds_read_b128 v[76:79], v86 offset:49152
    ds_read_b128 v[80:83], v87 offset:49152
    s_waitcnt lgkmcnt(4)
    v_mfma_f32_16x16x32_bf16 v[4:7], v[112:115], v[52:55], v[4:7]
    v_mfma_f32_16x16x32_bf16 v[16:19], v[112:115], v[56:59], v[16:19]
    v_mfma_f32_16x16x32_bf16 v[28:31], v[112:115], v[60:63], v[28:31]
    v_mfma_f32_16x16x32_bf16 v[40:43], v[112:115], v[64:67], v[40:43]
    v_mfma_f32_16x16x32_bf16 v[8:11], v[116:119], v[52:55], v[8:11]
    v_mfma_f32_16x16x32_bf16 v[20:23], v[116:119], v[56:59], v[20:23]
    v_mfma_f32_16x16x32_bf16 v[32:35], v[116:119], v[60:63], v[32:35]
    v_mfma_f32_16x16x32_bf16 v[44:47], v[116:119], v[64:67], v[44:47]
    v_mfma_f32_16x16x32_bf16 v[12:15], v[120:123], v[52:55], v[12:15]
    v_mfma_f32_16x16x32_bf16 v[24:27], v[120:123], v[56:59], v[24:27]
    v_mfma_f32_16x16x32_bf16 v[36:39], v[120:123], v[60:63], v[36:39]
    v_mfma_f32_16x16x32_bf16 v[48:51], v[120:123], v[64:67], v[48:51]
    s_add_u32 m0, s62, 0
    s_add_u32 s58, s62, 131072
    buffer_load_dwordx4 v2, s[28:31], s58 offen sc1 lds
    s_add_u32 m0, s62, 8192
    s_add_u32 s58, s62, 139264
    buffer_load_dwordx4 v2, s[28:31], s58 offen sc1 lds
    s_add_u32 m0, s62, 16384
    s_add_u32 s58, s62, 147456
    buffer_load_dwordx4 v2, s[28:31], s58 offen sc1 lds
    s_add_u32 m0, s62, 24576
    s_add_u32 s58, s62, 155648
    buffer_load_dwordx4 v2, s[28:31], s58 offen sc1 lds
    v_add_u32 v84, 0x10000, v84
    v_add_u32 v85, 0x10000, v85
    v_add_u32 v86, 0x10000, v86
    v_add_u32 v87, 0x10000, v87
    ds_read_b128 v[52:55], v84 offset:0
    ds_read_b128 v[56:59], v85 offset:0
    ds_read_b128 v[60:63], v86 offset:0
    ds_read_b128 v[64:67], v87 offset:0
    s_waitcnt lgkmcnt(4)
    v_mfma_f32_16x16x32_bf16 v[4:7], v[124:127], v[68:71], v[4:7]
    v_mfma_f32_16x16x32_bf16 v[16:19], v[124:127], v[72:75], v[16:19]
    v_mfma_f32_16x16x32_bf16 v[28:31], v[124:127], v[76:79], v[28:31]
    v_mfma_f32_16x16x32_bf16 v[40:43], v[124:127], v[80:83], v[40:43]
    v_mfma_f32_16x16x32_bf16 v[8:11], v[128:131], v[68:71], v[8:11]
    v_mfma_f32_16x16x32_bf16 v[20:23], v[128:131], v[72:75], v[20:23]
    v_mfma_f32_16x16x32_bf16 v[32:35], v[128:131], v[76:79], v[32:35]
    v_mfma_f32_16x16x32_bf16 v[44:47], v[128:131], v[80:83], v[44:47]
    v_mfma_f32_16x16x32_bf16 v[12:15], v[132:135], v[68:71], v[12:15]
    v_mfma_f32_16x16x32_bf16 v[24:27], v[132:135], v[72:75], v[24:27]
    v_mfma_f32_16x16x32_bf16 v[36:39], v[132:135], v[76:79], v[36:39]
    v_mfma_f32_16x16x32_bf16 v[48:51], v[132:135], v[80:83], v[48:51]
    s_waitcnt vmcnt(4)
    s_barrier
    ds_read_b128 v[68:71], v84 offset:16384
    ds_read_b128 v[72:75], v85 offset:16384
    ds_read_b128 v[76:79], v86 offset:16384
    ds_read_b128 v[80:83], v87 offset:16384
    s_waitcnt lgkmcnt(4)
    v_mfma_f32_16x16x32_bf16 v[4:7], v[136:139], v[52:55], v[4:7]
    v_mfma_f32_16x16x32_bf16 v[16:19], v[136:139], v[56:59], v[16:19]
    v_mfma_f32_16x16x32_bf16 v[28:31], v[136:139], v[60:63], v[28:31]
    v_mfma_f32_16x16x32_bf16 v[40:43], v[136:139], v[64:67], v[40:43]
    v_mfma_f32_16x16x32_bf16 v[8:11], v[140:143], v[52:55], v[8:11]
    v_mfma_f32_16x16x32_bf16 v[20:23], v[140:143], v[56:59], v[20:23]
    v_mfma_f32_16x16x32_bf16 v[32:35], v[140:143], v[60:63], v[32:35]
    v_mfma_f32_16x16x32_bf16 v[44:47], v[140:143], v[64:67], v[44:47]
    v_mfma_f32_16x16x32_bf16 v[12:15], v[144:147], v[52:55], v[12:15]
    v_mfma_f32_16x16x32_bf16 v[24:27], v[144:147], v[56:59], v[24:27]
    v_mfma_f32_16x16x32_bf16 v[36:39], v[144:147], v[60:63], v[36:39]
    v_mfma_f32_16x16x32_bf16 v[48:51], v[144:147], v[64:67], v[48:51]
    s_add_u32 m0, s62, 32768
    s_add_u32 s58, s62, 163840
    buffer_load_dwordx4 v2, s[28:31], s58 offen sc1 lds
    s_add_u32 m0, s62, 40960
    s_add_u32 s58, s62, 172032
    buffer_load_dwordx4 v2, s[28:31], s58 offen sc1 lds
    s_add_u32 m0, s62, 49152
    s_add_u32 s58, s62, 180224
    buffer_load_dwordx4 v2, s[28:31], s58 offen sc1 lds
    s_add_u32 m0, s62, 57344
    s_add_u32 s58, s62, 188416
    buffer_load_dwordx4 v2, s[28:31], s58 offen sc1 lds
    ds_read_b128 v[52:55], v84 offset:32768
    ds_read_b128 v[56:59], v85 offset:32768
    ds_read_b128 v[60:63], v86 offset:32768
    ds_read_b128 v[64:67], v87 offset:32768
    s_waitcnt lgkmcnt(4)
    v_mfma_f32_16x16x32_bf16 v[4:7], v[148:151], v[68:71], v[4:7]
    v_mfma_f32_16x16x32_bf16 v[16:19], v[148:151], v[72:75], v[16:19]
    v_mfma_f32_16x16x32_bf16 v[28:31], v[148:151], v[76:79], v[28:31]
    v_mfma_f32_16x16x32_bf16 v[40:43], v[148:151], v[80:83], v[40:43]
    v_mfma_f32_16x16x32_bf16 v[8:11], v[152:155], v[68:71], v[8:11]
    v_mfma_f32_16x16x32_bf16 v[20:23], v[152:155], v[72:75], v[20:23]
    v_mfma_f32_16x16x32_bf16 v[32:35], v[152:155], v[76:79], v[32:35]
    v_mfma_f32_16x16x32_bf16 v[44:47], v[152:155], v[80:83], v[44:47]
    v_mfma_f32_16x16x32_bf16 v[12:15], v[156:159], v[68:71], v[12:15]
    v_mfma_f32_16x16x32_bf16 v[24:27], v[156:159], v[72:75], v[24:27]
    v_mfma_f32_16x16x32_bf16 v[36:39], v[156:159], v[76:79], v[36:39]
    v_mfma_f32_16x16x32_bf16 v[48:51], v[156:159], v[80:83], v[48:51]
    s_waitcnt vmcnt(4)
    s_barrier
    ds_read_b128 v[68:71], v84 offset:49152
    ds_read_b128 v[72:75], v85 offset:49152
    ds_read_b128 v[76:79], v86 offset:49152
    ds_read_b128 v[80:83], v87 offset:49152
    s_waitcnt lgkmcnt(4)
    v_mfma_f32_16x16x32_bf16 v[4:7], v[160:163], v[52:55], v[4:7]
    v_mfma_f32_16x16x32_bf16 v[16:19], v[160:163], v[56:59], v[16:19]
    v_mfma_f32_16x16x32_bf16 v[28:31], v[160:163], v[60:63], v[28:31]
    v_mfma_f32_16x16x32_bf16 v[40:43], v[160:163], v[64:67], v[40:43]
    v_mfma_f32_16x16x32_bf16 v[8:11], v[164:167], v[52:55], v[8:11]
    v_mfma_f32_16x16x32_bf16 v[20:23], v[164:167], v[56:59], v[20:23]
    v_mfma_f32_16x16x32_bf16 v[32:35], v[164:167], v[60:63], v[32:35]
    v_mfma_f32_16x16x32_bf16 v[44:47], v[164:167], v[64:67], v[44:47]
    v_mfma_f32_16x16x32_bf16 v[12:15], v[168:171], v[52:55], v[12:15]
    v_mfma_f32_16x16x32_bf16 v[24:27], v[168:171], v[56:59], v[24:27]
    v_mfma_f32_16x16x32_bf16 v[36:39], v[168:171], v[60:63], v[36:39]
    v_mfma_f32_16x16x32_bf16 v[48:51], v[168:171], v[64:67], v[48:51]
    s_add_u32 m0, s62, 65536
    s_add_u32 s58, s62, 196608
    buffer_load_dwordx4 v2, s[28:31], s58 offen sc1 lds
    s_add_u32 m0, s62, 73728
    s_add_u32 s58, s62, 204800
    buffer_load_dwordx4 v2, s[28:31], s58 offen sc1 lds
    s_add_u32 m0, s62, 81920
    s_add_u32 s58, s62, 212992
    buffer_load_dwordx4 v2, s[28:31], s58 offen sc1 lds
    s_add_u32 m0, s62, 90112
    s_add_u32 s58, s62, 221184
    buffer_load_dwordx4 v2, s[28:31], s58 offen sc1 lds
    v_subrev_u32 v84, 0x10000, v84
    v_subrev_u32 v85, 0x10000, v85
    v_subrev_u32 v86, 0x10000, v86
    v_subrev_u32 v87, 0x10000, v87
    ds_read_b128 v[52:55], v84 offset:0
    ds_read_b128 v[56:59], v85 offset:0
    ds_read_b128 v[60:63], v86 offset:0
    ds_read_b128 v[64:67], v87 offset:0
    s_waitcnt lgkmcnt(4)
    v_mfma_f32_16x16x32_bf16 v[4:7], v[172:175], v[68:71], v[4:7]
    v_mfma_f32_16x16x32_bf16 v[16:19], v[172:175], v[72:75], v[16:19]
    v_mfma_f32_16x16x32_bf16 v[28:31], v[172:175], v[76:79], v[28:31]
    v_mfma_f32_16x16x32_bf16 v[40:43], v[172:175], v[80:83], v[40:43]
    v_mfma_f32_16x16x32_bf16 v[8:11], v[176:179], v[68:71], v[8:11]
    v_mfma_f32_16x16x32_bf16 v[20:23], v[176:179], v[72:75], v[20:23]
    v_mfma_f32_16x16x32_bf16 v[32:35], v[176:179], v[76:79], v[32:35]
    v_mfma_f32_16x16x32_bf16 v[44:47], v[176:179], v[80:83], v[44:47]
    v_mfma_f32_16x16x32_bf16 v[12:15], v[180:183], v[68:71], v[12:15]
    v_mfma_f32_16x16x32_bf16 v[24:27], v[180:183], v[72:75], v[24:27]
    v_mfma_f32_16x16x32_bf16 v[36:39], v[180:183], v[76:79], v[36:39]
    v_mfma_f32_16x16x32_bf16 v[48:51], v[180:183], v[80:83], v[48:51]
    s_waitcnt vmcnt(4)
    s_barrier
    ds_read_b128 v[68:71], v84 offset:16384
    ds_read_b128 v[72:75], v85 offset:16384
    ds_read_b128 v[76:79], v86 offset:16384
    ds_read_b128 v[80:83], v87 offset:16384
    s_waitcnt lgkmcnt(4)
    v_mfma_f32_16x16x32_bf16 v[4:7], v[184:187], v[52:55], v[4:7]
    v_mfma_f32_16x16x32_bf16 v[16:19], v[184:187], v[56:59], v[16:19]
    v_mfma_f32_16x16x32_bf16 v[28:31], v[184:187], v[60:63], v[28:31]
    v_mfma_f32_16x16x32_bf16 v[40:43], v[184:187], v[64:67], v[40:43]
    v_mfma_f32_16x16x32_bf16 v[8:11], v[188:191], v[52:55], v[8:11]
    v_mfma_f32_16x16x32_bf16 v[20:23], v[188:191], v[56:59], v[20:23]
    v_mfma_f32_16x16x32_bf16 v[32:35], v[188:191], v[60:63], v[32:35]
    v_mfma_f32_16x16x32_bf16 v[44:47], v[188:191], v[64:67], v[44:47]
    v_mfma_f32_16x16x32_bf16 v[12:15], v[192:195], v[52:55], v[12:15]
    v_mfma_f32_16x16x32_bf16 v[24:27], v[192:195], v[56:59], v[24:27]
    v_mfma_f32_16x16x32_bf16 v[36:39], v[192:195], v[60:63], v[36:39]
    v_mfma_f32_16x16x32_bf16 v[48:51], v[192:195], v[64:67], v[48:51]
    ds_read_b128 v[52:55], v84 offset:32768
    ds_read_b128 v[56:59], v85 offset:32768
    ds_read_b128 v[60:63], v86 offset:32768
    ds_read_b128 v[64:67], v87 offset:32768
    s_waitcnt lgkmcnt(4)
    v_mfma_f32_16x16x32_bf16 v[4:7], v[196:199], v[68:71], v[4:7]
    v_mfma_f32_16x16x32_bf16 v[16:19], v[196:199], v[72:75], v[16:19]
    v_mfma_f32_16x16x32_bf16 v[28:31], v[196:199], v[76:79], v[28:31]
    v_mfma_f32_16x16x32_bf16 v[40:43], v[196:199], v[80:83], v[40:43]
    v_mfma_f32_16x16x32_bf16 v[8:11], v[200:203], v[68:71], v[8:11]
    v_mfma_f32_16x16x32_bf16 v[20:23], v[200:203], v[72:75], v[20:23]
    v_mfma_f32_16x16x32_bf16 v[32:35], v[200:203], v[76:79], v[32:35]
    v_mfma_f32_16x16x32_bf16 v[44:47], v[200:203], v[80:83], v[44:47]
    v_mfma_f32_16x16x32_bf16 v[12:15], v[204:207], v[68:71], v[12:15]
    v_mfma_f32_16x16x32_bf16 v[24:27], v[204:207], v[72:75], v[24:27]
    v_mfma_f32_16x16x32_bf16 v[36:39], v[204:207], v[76:79], v[36:39]
    v_mfma_f32_16x16x32_bf16 v[48:51], v[204:207], v[80:83], v[48:51]
    s_waitcnt vmcnt(0)
    s_barrier
    ds_read_b128 v[68:71], v84 offset:49152
    ds_read_b128 v[72:75], v85 offset:49152
    ds_read_b128 v[76:79], v86 offset:49152
    ds_read_b128 v[80:83], v87 offset:49152
    s_waitcnt lgkmcnt(4)
    v_mfma_f32_16x16x32_bf16 v[4:7], v[208:211], v[52:55], v[4:7]
    v_mfma_f32_16x16x32_bf16 v[16:19], v[208:211], v[56:59], v[16:19]
    v_mfma_f32_16x16x32_bf16 v[28:31], v[208:211], v[60:63], v[28:31]
    v_mfma_f32_16x16x32_bf16 v[40:43], v[208:211], v[64:67], v[40:43]
    v_mfma_f32_16x16x32_bf16 v[8:11], v[212:215], v[52:55], v[8:11]
    v_mfma_f32_16x16x32_bf16 v[20:23], v[212:215], v[56:59], v[20:23]
    v_mfma_f32_16x16x32_bf16 v[32:35], v[212:215], v[60:63], v[32:35]
    v_mfma_f32_16x16x32_bf16 v[44:47], v[212:215], v[64:67], v[44:47]
    v_mfma_f32_16x16x32_bf16 v[12:15], v[216:219], v[52:55], v[12:15]
    v_mfma_f32_16x16x32_bf16 v[24:27], v[216:219], v[56:59], v[24:27]
    v_mfma_f32_16x16x32_bf16 v[36:39], v[216:219], v[60:63], v[36:39]
    v_mfma_f32_16x16x32_bf16 v[48:51], v[216:219], v[64:67], v[48:51]
    v_add_u32 v84, 0x10000, v84
    v_add_u32 v85, 0x10000, v85
    v_add_u32 v86, 0x10000, v86
    v_add_u32 v87, 0x10000, v87
    ds_read_b128 v[52:55], v84 offset:0
    ds_read_b128 v[56:59], v85 offset:0
    ds_read_b128 v[60:63], v86 offset:0
    ds_read_b128 v[64:67], v87 offset:0
    s_waitcnt lgkmcnt(4)
    v_mfma_f32_16x16x32_bf16 v[4:7], v[220:223], v[68:71], v[4:7]
    v_mfma_f32_16x16x32_bf16 v[16:19], v[220:223], v[72:75], v[16:19]
    v_mfma_f32_16x16x32_bf16 v[28:31], v[220:223], v[76:79], v[28:31]
    v_mfma_f32_16x16x32_bf16 v[40:43], v[220:223], v[80:83], v[40:43]
    v_mfma_f32_16x16x32_bf16 v[8:11], v[224:227], v[68:71], v[8:11]
    v_mfma_f32_16x16x32_bf16 v[20:23], v[224:227], v[72:75], v[20:23]
    v_mfma_f32_16x16x32_bf16 v[32:35], v[224:227], v[76:79], v[32:35]
    v_mfma_f32_16x16x32_bf16 v[44:47], v[224:227], v[80:83], v[44:47]
    v_mfma_f32_16x16x32_bf16 v[12:15], v[228:231], v[68:71], v[12:15]
    v_mfma_f32_16x16x32_bf16 v[24:27], v[228:231], v[72:75], v[24:27]
    v_mfma_f32_16x16x32_bf16 v[36:39], v[228:231], v[76:79], v[36:39]
    v_mfma_f32_16x16x32_bf16 v[48:51], v[228:231], v[80:83], v[48:51]
    ds_read_b128 v[68:71], v84 offset:16384
    ds_read_b128 v[72:75], v85 offset:16384
    ds_read_b128 v[76:79], v86 offset:16384
    ds_read_b128 v[80:83], v87 offset:16384
    s_waitcnt lgkmcnt(4)
    v_mfma_f32_16x16x32_bf16 v[4:7], v[232:235], v[52:55], v[4:7]
    v_mfma_f32_16x16x32_bf16 v[16:19], v[232:235], v[56:59], v[16:19]
    v_mfma_f32_16x16x32_bf16 v[28:31], v[232:235], v[60:63], v[28:31]
    v_mfma_f32_16x16x32_bf16 v[40:43], v[232:235], v[64:67], v[40:43]
    v_mfma_f32_16x16x32_bf16 v[8:11], v[236:239], v[52:55], v[8:11]
    v_mfma_f32_16x16x32_bf16 v[20:23], v[236:239], v[56:59], v[20:23]
    v_mfma_f32_16x16x32_bf16 v[32:35], v[236:239], v[60:63], v[32:35]
    v_mfma_f32_16x16x32_bf16 v[44:47], v[236:239], v[64:67], v[44:47]
    v_mfma_f32_16x16x32_bf16 v[12:15], v[240:243], v[52:55], v[12:15]
    v_mfma_f32_16x16x32_bf16 v[24:27], v[240:243], v[56:59], v[24:27]
    v_mfma_f32_16x16x32_bf16 v[36:39], v[240:243], v[60:63], v[36:39]
    v_mfma_f32_16x16x32_bf16 v[48:51], v[240:243], v[64:67], v[48:51]
    s_waitcnt lgkmcnt(0)
    v_mfma_f32_16x16x32_bf16 v[4:7], v[244:247], v[68:71], v[4:7]
    v_mfma_f32_16x16x32_bf16 v[16:19], v[244:247], v[72:75], v[16:19]
    v_mfma_f32_16x16x32_bf16 v[28:31], v[244:247], v[76:79], v[28:31]
    v_mfma_f32_16x16x32_bf16 v[40:43], v[244:247], v[80:83], v[40:43]
    v_mfma_f32_16x16x32_bf16 v[8:11], v[248:251], v[68:71], v[8:11]
    v_mfma_f32_16x16x32_bf16 v[20:23], v[248:251], v[72:75], v[20:23]
    v_mfma_f32_16x16x32_bf16 v[32:35], v[248:251], v[76:79], v[32:35]
    v_mfma_f32_16x16x32_bf16 v[44:47], v[248:251], v[80:83], v[44:47]
    v_mfma_f32_16x16x32_bf16 v[12:15], v[252:255], v[68:71], v[12:15]
    v_mfma_f32_16x16x32_bf16 v[24:27], v[252:255], v[72:75], v[24:27]
    v_mfma_f32_16x16x32_bf16 v[36:39], v[252:255], v[76:79], v[36:39]
    v_mfma_f32_16x16x32_bf16 v[48:51], v[252:255], v[80:83], v[48:51]
    s_setprio 0
    s_nop 7
    s_and_b32 s57, s3, 3
    s_add_u32 s58, s57, 1
    s_and_b32 s58, s58, 3
    s_mul_i32 s58, s58, 9216
    s_add_u32 s58, s58, 98304
    v_add_u32 v53, s58, v2
    s_add_u32 s58, s57, 2
    s_and_b32 s58, s58, 3
    s_mul_i32 s58, s58, 9216
    s_add_u32 s58, s58, 101376
    v_add_u32 v54, s58, v2
    s_add_u32 s58, s57, 3
    s_and_b32 s58, s58, 3
    s_mul_i32 s58, s58, 9216
    s_add_u32 s58, s58, 104448
    v_add_u32 v55, s58, v2
    s_mul_i32 s58, s57, 9216
    s_add_u32 s58, s58, 98304
    v_add_u32 v52, s58, v2
    ds_write_b128 v53, v[16:19] offset:0
    ds_write_b128 v53, v[20:23] offset:1024
    ds_write_b128 v53, v[24:27] offset:2048
    ds_write_b128 v54, v[28:31] offset:0
    ds_write_b128 v54, v[32:35] offset:1024
    ds_write_b128 v54, v[36:39] offset:2048
    ds_write_b128 v55, v[40:43] offset:0
    ds_write_b128 v55, v[44:47] offset:1024
    ds_write_b128 v55, v[48:51] offset:2048
    s_waitcnt lgkmcnt(0)
    s_barrier
    ds_read_b128 v[16:19], v52 offset:0
    ds_read_b128 v[20:23], v52 offset:1024
    ds_read_b128 v[24:27], v52 offset:2048
    ds_read_b128 v[28:31], v52 offset:3072
    ds_read_b128 v[32:35], v52 offset:4096
    ds_read_b128 v[36:39], v52 offset:5120
    ds_read_b128 v[40:43], v52 offset:6144
    ds_read_b128 v[44:47], v52 offset:7168
    ds_read_b128 v[48:51], v52 offset:8192
    s_waitcnt lgkmcnt(0)
    v_add_f32 v4, v4, v16
    v_add_f32 v28, v28, v40
    v_add_f32 v5, v5, v17
    v_add_f32 v29, v29, v41
    v_add_f32 v6, v6, v18
    v_add_f32 v30, v30, v42
    v_add_f32 v7, v7, v19
    v_add_f32 v31, v31, v43
    v_add_f32 v4, v4, v28
    v_add_f32 v5, v5, v29
    v_add_f32 v6, v6, v30
    v_add_f32 v7, v7, v31
    v_add_f32 v8, v8, v20
    v_add_f32 v32, v32, v44
    v_add_f32 v9, v9, v21
    v_add_f32 v33, v33, v45
    v_add_f32 v10, v10, v22
    v_add_f32 v34, v34, v46
    v_add_f32 v11, v11, v23
    v_add_f32 v35, v35, v47
    v_add_f32 v8, v8, v32
    v_add_f32 v9, v9, v33
    v_add_f32 v10, v10, v34
    v_add_f32 v11, v11, v35
    v_add_f32 v12, v12, v24
    v_add_f32 v36, v36, v48
    v_add_f32 v13, v13, v25
    v_add_f32 v37, v37, v49
    v_add_f32 v14, v14, v26
    v_add_f32 v38, v38, v50
    v_add_f32 v15, v15, v27
    v_add_f32 v39, v39, v51
    v_add_f32 v12, v12, v36
    v_add_f32 v13, v13, v37
    v_add_f32 v14, v14, v38
    v_add_f32 v15, v15, v39
    s_mov_b32 s36, s20
    s_mov_b32 s37, s21
    s_mov_b32 s38, 0x280000
    s_mov_b32 s39, 0x20000
    v_cvt_pk_bf16_f32 v4, v4, v5
    v_cvt_pk_bf16_f32 v5, v6, v7
    buffer_store_dwordx2 v[4:5], v3, s[36:39], 0 offen offset:0
    v_cvt_pk_bf16_f32 v8, v8, v9
    v_cvt_pk_bf16_f32 v9, v10, v11
    buffer_store_dwordx2 v[8:9], v3, s[36:39], 0 offen offset:32
    v_cvt_pk_bf16_f32 v12, v12, v13
    v_cvt_pk_bf16_f32 v13, v14, v15
    buffer_store_dwordx2 v[12:13], v3, s[36:39], 0 offen offset:64
    s_branch L_g2p5_j
L_g2p5_n1:
    s_add_u32 m0, s62, 0
    s_add_u32 s58, s62, 0
    buffer_load_dwordx4 v2, s[28:31], s58 offen sc1 lds
    s_add_u32 m0, s62, 8192
    s_add_u32 s58, s62, 8192
    buffer_load_dwordx4 v2, s[28:31], s58 offen sc1 lds
    s_add_u32 m0, s62, 16384
    s_add_u32 s58, s62, 16384
    buffer_load_dwordx4 v2, s[28:31], s58 offen sc1 lds
    s_add_u32 m0, s62, 24576
    s_add_u32 s58, s62, 24576
    buffer_load_dwordx4 v2, s[28:31], s58 offen sc1 lds
    s_add_u32 m0, s62, 32768
    s_add_u32 s58, s62, 32768
    buffer_load_dwordx4 v2, s[28:31], s58 offen sc1 lds
    s_add_u32 m0, s62, 40960
    s_add_u32 s58, s62, 40960
    buffer_load_dwordx4 v2, s[28:31], s58 offen sc1 lds
    s_add_u32 m0, s62, 49152
    s_add_u32 s58, s62, 49152
    buffer_load_dwordx4 v2, s[28:31], s58 offen sc1 lds
    s_add_u32 m0, s62, 57344
    s_add_u32 s58, s62, 57344
    buffer_load_dwordx4 v2, s[28:31], s58 offen sc1 lds
    s_waitcnt vmcnt(8)
    v_lshlrev_b32 v4, 16, v52
    v_and_b32 v5, 0xffff0000, v52
    v_lshlrev_b32 v66, 16, v58
    v_and_b32 v67, 0xffff0000, v58
    v_add_f32 v4, v4, v66
    v_add_f32 v5, v5, v67
    v_lshlrev_b32 v6, 16, v53
    v_and_b32 v7, 0xffff0000, v53
    v_lshlrev_b32 v66, 16, v59
    v_and_b32 v67, 0xffff0000, v59
    v_add_f32 v6, v6, v66
    v_add_f32 v7, v7, v67
    v_lshlrev_b32 v8, 16, v54
    v_and_b32 v9, 0xffff0000, v54
    v_lshlrev_b32 v66, 16, v60
    v_and_b32 v67, 0xffff0000, v60
    v_add_f32 v8, v8, v66
    v_add_f32 v9, v9, v67
    v_lshlrev_b32 v10, 16, v55
    v_and_b32 v11, 0xffff0000, v55
    v_lshlrev_b32 v66, 16, v61
    v_and_b32 v67, 0xffff0000, v61
    v_add_f32 v10, v10, v66
    v_add_f32 v11, v11, v67
    s_waitcnt vmcnt(6)
    s_barrier
    ds_read_b128 v[52:55], v84 offset:0
    ds_read_b128 v[56:59], v85 offset:0
    ds_read_b128 v[60:63], v86 offset:0
    ds_read_b128 v[64:67], v87 offset:0
    s_add_u32 m0, s62, 65536
    s_add_u32 s58, s62, 65536
    buffer_load_dwordx4 v2, s[28:31], s58 offen sc1 lds
    s_add_u32 m0, s62, 73728
    s_add_u32 s58, s62, 73728
    buffer_load_dwordx4 v2, s[28:31], s58 offen sc1 lds
    s_add_u32 m0, s62, 81920
    s_add_u32 s58, s62, 81920
    buffer_load_dwordx4 v2, s[28:31], s58 offen sc1 lds
    s_add_u32 m0, s62, 90112
    s_add_u32 s58, s62, 90112
    buffer_load_dwordx4 v2, s[28:31], s58 offen sc1 lds
    s_waitcnt lgkmcnt(0)
    v_mfma_f32_16x16x32_bf16 v[4:7], v[144:147], v[52:55], v[4:7]
    v_mfma_f32_16x16x32_bf16 v[16:19], v[144:147], v[56:59], v[16:19]
    v_mfma_f32_16x16x32_bf16 v[28:31], v[144:147], v[60:63], v[28:31]
    v_mfma_f32_16x16x32_bf16 v[40:43], v[144:147], v[64:67], v[40:43]
    v_mfma_f32_16x16x32_bf16 v[8:11], v[148:151], v[52:55], v[8:11]
    v_mfma_f32_16x16x32_bf16 v[20:23], v[148:151], v[56:59], v[20:23]
    v_mfma_f32_16x16x32_bf16 v[32:35], v[148:151], v[60:63], v[32:35]
    v_mfma_f32_16x16x32_bf16 v[44:47], v[148:151], v[64:67], v[44:47]
    s_waitcnt vmcnt(4)
    s_barrier
    ds_read_b128 v[68:71], v84 offset:16384
    ds_read_b128 v[72:75], v85 offset:16384
    ds_read_b128 v[76:79], v86 offset:16384
    ds_read_b128 v[80:83], v87 offset:16384
    s_add_u32 m0, s62, 98304
    s_add_u32 s58, s62, 98304
    buffer_load_dwordx4 v2, s[28:31], s58 offen sc1 lds
    s_add_u32 m0, s62, 106496
    s_add_u32 s58, s62, 106496
    buffer_load_dwordx4 v2, s[28:31], s58 offen sc1 lds
    s_add_u32 m0, s62, 114688
    s_add_u32 s58, s62, 114688
    buffer_load_dwordx4 v2, s[28:31], s58 offen sc1 lds
    s_add_u32 m0, s62, 122880
    s_add_u32 s58, s62, 122880
    buffer_load_dwordx4 v2, s[28:31], s58 offen sc1 lds
    ds_read_b128 v[52:55], v84 offset:32768
    ds_read_b128 v[56:59], v85 offset:32768
    ds_read_b128 v[60:63], v86 offset:32768
    ds_read_b128 v[64:67], v87 offset:32768
    s_waitcnt lgkmcnt(4)
    v_mfma_f32_16x16x32_bf16 v[4:7], v[152:155], v[68:71], v[4:7]
    v_mfma_f32_16x16x32_bf16 v[16:19], v[152:155], v[72:75], v[16:19]
    v_mfma_f32_16x16x32_bf16 v[28:31], v[152:155], v[76:79], v[28:31]
    v_mfma_f32_16x16x32_bf16 v[40:43], v[152:155], v[80:83], v[40:43]
    v_mfma_f32_16x16x32_bf16 v[8:11], v[156:159], v[68:71], v[8:11]
    v_mfma_f32_16x16x32_bf16 v[20:23], v[156:159], v[72:75], v[20:23]
    v_mfma_f32_16x16x32_bf16 v[32:35], v[156:159], v[76:79], v[32:35]
    v_mfma_f32_16x16x32_bf16 v[44:47], v[156:159], v[80:83], v[44:47]
    s_waitcnt vmcnt(4)
    s_barrier
    ds_read_b128 v[68:71], v84 offset:49152
    ds_read_b128 v[72:75], v85 offset:49152
    ds_read_b128 v[76:79], v86 offset:49152
    ds_read_b128 v[80:83], v87 offset:49152
    s_waitcnt lgkmcnt(4)
    v_mfma_f32_16x16x32_bf16 v[4:7], v[160:163], v[52:55], v[4:7]
    v_mfma_f32_16x16x32_bf16 v[16:19], v[160:163], v[56:59], v[16:19]
    v_mfma_f32_16x16x32_bf16 v[28:31], v[160:163], v[60:63], v[28:31]
    v_mfma_f32_16x16x32_bf16 v[40:43], v[160:163], v[64:67], v[40:43]
    v_mfma_f32_16x16x32_bf16 v[8:11], v[164:167], v[52:55], v[8:11]
    v_mfma_f32_16x16x32_bf16 v[20:23], v[164:167], v[56:59], v[20:23]
    v_mfma_f32_16x16x32_bf16 v[32:35], v[164:167], v[60:63], v[32:35]
    v_mfma_f32_16x16x32_bf16 v[44:47], v[164:167], v[64:67], v[44:47]
    s_add_u32 m0, s62, 0
    s_add_u32 s58, s62, 131072
    buffer_load_dwordx4 v2, s[28:31], s58 offen sc1 lds
    s_add_u32 m0, s62, 8192
    s_add_u32 s58, s62, 139264
    buffer_load_dwordx4 v2, s[28:31], s58 offen sc1 lds
    s_add_u32 m0, s62, 16384
    s_add_u32 s58, s62, 147456
    buffer_load_dwordx4 v2, s[28:31], s58 offen sc1 lds
    s_add_u32 m0, s62, 24576
    s_add_u32 s58, s62, 155648
    buffer_load_dwordx4 v2, s[28:31], s58 offen sc1 lds
    v_add_u32 v84, 0x10000, v84
    v_add_u32 v85, 0x10000, v85
    v_add_u32 v86, 0x10000, v86
    v_add_u32 v87, 0x10000, v87
    ds_read_b128 v[52:55], v84 offset:0
    ds_read_b128 v[56:59], v85 offset:0
    ds_read_b128 v[60:63], v86 offset:0
    ds_read_b128 v[64:67], v87 offset:0
    s_waitcnt lgkmcnt(4)
    v_mfma_f32_16x16x32_bf16 v[4:7], v[168:171], v[68:71], v[4:7]
    v_mfma_f32_16x16x32_bf16 v[16:19], v[168:171], v[72:75], v[16:19]
    v_mfma_f32_16x16x32_bf16 v[28:31], v[168:171], v[76:79], v[28:31]
    v_mfma_f32_16x16x32_bf16 v[40:43], v[168:171], v[80:83], v[40:43]
    v_mfma_f32_16x16x32_bf16 v[8:11], v[172:175], v[68:71], v[8:11]
    v_mfma_f32_16x16x32_bf16 v[20:23], v[172:175], v[72:75], v[20:23]
    v_mfma_f32_16x16x32_bf16 v[32:35], v[172:175], v[76:79], v[32:35]
    v_mfma_f32_16x16x32_bf16 v[44:47], v[172:175], v[80:83], v[44:47]
    s_waitcnt vmcnt(4)
    s_barrier
    ds_read_b128 v[68:71], v84 offset:16384
    ds_read_b128 v[72:75], v85 offset:16384
    ds_read_b128 v[76:79], v86 offset:16384
    ds_read_b128 v[80:83], v87 offset:16384
    s_waitcnt lgkmcnt(4)
    v_mfma_f32_16x16x32_bf16 v[4:7], v[176:179], v[52:55], v[4:7]
    v_mfma_f32_16x16x32_bf16 v[16:19], v[176:179], v[56:59], v[16:19]
    v_mfma_f32_16x16x32_bf16 v[28:31], v[176:179], v[60:63], v[28:31]
    v_mfma_f32_16x16x32_bf16 v[40:43], v[176:179], v[64:67], v[40:43]
    v_mfma_f32_16x16x32_bf16 v[8:11], v[180:183], v[52:55], v[8:11]
    v_mfma_f32_16x16x32_bf16 v[20:23], v[180:183], v[56:59], v[20:23]
    v_mfma_f32_16x16x32_bf16 v[32:35], v[180:183], v[60:63], v[32:35]
    v_mfma_f32_16x16x32_bf16 v[44:47], v[180:183], v[64:67], v[44:47]
    s_add_u32 m0, s62, 32768
    s_add_u32 s58, s62, 163840
    buffer_load_dwordx4 v2, s[28:31], s58 offen sc1 lds
    s_add_u32 m0, s62, 40960
    s_add_u32 s58, s62, 172032
    buffer_load_dwordx4 v2, s[28:31], s58 offen sc1 lds
    s_add_u32 m0, s62, 49152
    s_add_u32 s58, s62, 180224
    buffer_load_dwordx4 v2, s[28:31], s58 offen sc1 lds
    s_add_u32 m0, s62, 57344
    s_add_u32 s58, s62, 188416
    buffer_load_dwordx4 v2, s[28:31], s58 offen sc1 lds
    ds_read_b128 v[52:55], v84 offset:32768
    ds_read_b128 v[56:59], v85 offset:32768
    ds_read_b128 v[60:63], v86 offset:32768
    ds_read_b128 v[64:67], v87 offset:32768
    s_waitcnt lgkmcnt(4)
    v_mfma_f32_16x16x32_bf16 v[4:7], v[184:187], v[68:71], v[4:7]
    v_mfma_f32_16x16x32_bf16 v[16:19], v[184:187], v[72:75], v[16:19]
    v_mfma_f32_16x16x32_bf16 v[28:31], v[184:187], v[76:79], v[28:31]
    v_mfma_f32_16x16x32_bf16 v[40:43], v[184:187], v[80:83], v[40:43]
    v_mfma_f32_16x16x32_bf16 v[8:11], v[188:191], v[68:71], v[8:11]
    v_mfma_f32_16x16x32_bf16 v[20:23], v[188:191], v[72:75], v[20:23]
    v_mfma_f32_16x16x32_bf16 v[32:35], v[188:191], v[76:79], v[32:35]
    v_mfma_f32_16x16x32_bf16 v[44:47], v[188:191], v[80:83], v[44:47]
    s_waitcnt vmcnt(4)
    s_barrier
    ds_read_b128 v[68:71], v84 offset:49152
    ds_read_b128 v[72:75], v85 offset:49152
    ds_read_b128 v[76:79], v86 offset:49152
    ds_read_b128 v[80:83], v87 offset:49152
    s_waitcnt lgkmcnt(4)
    v_mfma_f32_16x16x32_bf16 v[4:7], v[192:195], v[52:55], v[4:7]
    v_mfma_f32_16x16x32_bf16 v[16:19], v[192:195], v[56:59], v[16:19]
    v_mfma_f32_16x16x32_bf16 v[28:31], v[192:195], v[60:63], v[28:31]
    v_mfma_f32_16x16x32_bf16 v[40:43], v[192:195], v[64:67], v[40:43]
    v_mfma_f32_16x16x32_bf16 v[8:11], v[196:199], v[52:55], v[8:11]
    v_mfma_f32_16x16x32_bf16 v[20:23], v[196:199], v[56:59], v[20:23]
    v_mfma_f32_16x16x32_bf16 v[32:35], v[196:199], v[60:63], v[32:35]
    v_mfma_f32_16x16x32_bf16 v[44:47], v[196:199], v[64:67], v[44:47]
    s_add_u32 m0, s62, 65536
    s_add_u32 s58, s62, 196608
    buffer_load_dwordx4 v2, s[28:31], s58 offen sc1 lds
    s_add_u32 m0, s62, 73728
    s_add_u32 s58, s62, 204800
    buffer_load_dwordx4 v2, s[28:31], s58 offen sc1 lds
    s_add_u32 m0, s62, 81920
    s_add_u32 s58, s62, 212992
    buffer_load_dwordx4 v2, s[28:31], s58 offen sc1 lds
    s_add_u32 m0, s62, 90112
    s_add_u32 s58, s62, 221184
    buffer_load_dwordx4 v2, s[28:31], s58 offen sc1 lds
    v_subrev_u32 v84, 0x10000, v84
    v_subrev_u32 v85, 0x10000, v85
    v_subrev_u32 v86, 0x10000, v86
    v_subrev_u32 v87, 0x10000, v87
    ds_read_b128 v[52:55], v84 offset:0
    ds_read_b128 v[56:59], v85 offset:0
    ds_read_b128 v[60:63], v86 offset:0
    ds_read_b128 v[64:67], v87 offset:0
    s_waitcnt lgkmcnt(4)
    v_mfma_f32_16x16x32_bf16 v[4:7], v[200:203], v[68:71], v[4:7]
    v_mfma_f32_16x16x32_bf16 v[16:19], v[200:203], v[72:75], v[16:19]
    v_mfma_f32_16x16x32_bf16 v[28:31], v[200:203], v[76:79], v[28:31]
    v_mfma_f32_16x16x32_bf16 v[40:43], v[200:203], v[80:83], v[40:43]
    v_mfma_f32_16x16x32_bf16 v[8:11], v[204:207], v[68:71], v[8:11]
    v_mfma_f32_16x16x32_bf16 v[20:23], v[204:207], v[72:75], v[20:23]
    v_mfma_f32_16x16x32_bf16 v[32:35], v[204:207], v[76:79], v[32:35]
    v_mfma_f32_16x16x32_bf16 v[44:47], v[204:207], v[80:83], v[44:47]
    s_waitcnt vmcnt(4)
    s_barrier
    ds_read_b128 v[68:71], v84 offset:16384
    ds_read_b128 v[72:75], v85 offset:16384
    ds_read_b128 v[76:79], v86 offset:16384
    ds_read_b128 v[80:83], v87 offset:16384
    s_waitcnt lgkmcnt(4)
    v_mfma_f32_16x16x32_bf16 v[4:7], v[208:211], v[52:55], v[4:7]
    v_mfma_f32_16x16x32_bf16 v[16:19], v[208:211], v[56:59], v[16:19]
    v_mfma_f32_16x16x32_bf16 v[28:31], v[208:211], v[60:63], v[28:31]
    v_mfma_f32_16x16x32_bf16 v[40:43], v[208:211], v[64:67], v[40:43]
    v_mfma_f32_16x16x32_bf16 v[8:11], v[212:215], v[52:55], v[8:11]
    v_mfma_f32_16x16x32_bf16 v[20:23], v[212:215], v[56:59], v[20:23]
    v_mfma_f32_16x16x32_bf16 v[32:35], v[212:215], v[60:63], v[32:35]
    v_mfma_f32_16x16x32_bf16 v[44:47], v[212:215], v[64:67], v[44:47]
    ds_read_b128 v[52:55], v84 offset:32768
    ds_read_b128 v[56:59], v85 offset:32768
    ds_read_b128 v[60:63], v86 offset:32768
    ds_read_b128 v[64:67], v87 offset:32768
    s_waitcnt lgkmcnt(4)
    v_mfma_f32_16x16x32_bf16 v[4:7], v[216:219], v[68:71], v[4:7]
    v_mfma_f32_16x16x32_bf16 v[16:19], v[216:219], v[72:75], v[16:19]
    v_mfma_f32_16x16x32_bf16 v[28:31], v[216:219], v[76:79], v[28:31]
    v_mfma_f32_16x16x32_bf16 v[40:43], v[216:219], v[80:83], v[40:43]
    v_mfma_f32_16x16x32_bf16 v[8:11], v[220:223], v[68:71], v[8:11]
    v_mfma_f32_16x16x32_bf16 v[20:23], v[220:223], v[72:75], v[20:23]
    v_mfma_f32_16x16x32_bf16 v[32:35], v[220:223], v[76:79], v[32:35]
    v_mfma_f32_16x16x32_bf16 v[44:47], v[220:223], v[80:83], v[44:47]
    s_waitcnt vmcnt(0)
    s_barrier
    ds_read_b128 v[68:71], v84 offset:49152
    ds_read_b128 v[72:75], v85 offset:49152
    ds_read_b128 v[76:79], v86 offset:49152
    ds_read_b128 v[80:83], v87 offset:49152
    s_waitcnt lgkmcnt(4)
    v_mfma_f32_16x16x32_bf16 v[4:7], v[224:227], v[52:55], v[4:7]
    v_mfma_f32_16x16x32_bf16 v[16:19], v[224:227], v[56:59], v[16:19]
    v_mfma_f32_16x16x32_bf16 v[28:31], v[224:227], v[60:63], v[28:31]
    v_mfma_f32_16x16x32_bf16 v[40:43], v[224:227], v[64:67], v[40:43]
    v_mfma_f32_16x16x32_bf16 v[8:11], v[228:231], v[52:55], v[8:11]
    v_mfma_f32_16x16x32_bf16 v[20:23], v[228:231], v[56:59], v[20:23]
    v_mfma_f32_16x16x32_bf16 v[32:35], v[228:231], v[60:63], v[32:35]
    v_mfma_f32_16x16x32_bf16 v[44:47], v[228:231], v[64:67], v[44:47]
    v_add_u32 v84, 0x10000, v84
    v_add_u32 v85, 0x10000, v85
    v_add_u32 v86, 0x10000, v86
    v_add_u32 v87, 0x10000, v87
    ds_read_b128 v[52:55], v84 offset:0
    ds_read_b128 v[56:59], v85 offset:0
    ds_read_b128 v[60:63], v86 offset:0
    ds_read_b128 v[64:67], v87 offset:0
    s_waitcnt lgkmcnt(4)
    v_mfma_f32_16x16x32_bf16 v[4:7], v[232:235], v[68:71], v[4:7]
    v_mfma_f32_16x16x32_bf16 v[16:19], v[232:235], v[72:75], v[16:19]
    v_mfma_f32_16x16x32_bf16 v[28:31], v[232:235], v[76:79], v[28:31]
    v_mfma_f32_16x16x32_bf16 v[40:43], v[232:235], v[80:83], v[40:43]
    v_mfma_f32_16x16x32_bf16 v[8:11], v[236:239], v[68:71], v[8:11]
    v_mfma_f32_16x16x32_bf16 v[20:23], v[236:239], v[72:75], v[20:23]
    v_mfma_f32_16x16x32_bf16 v[32:35], v[236:239], v[76:79], v[32:35]
    v_mfma_f32_16x16x32_bf16 v[44:47], v[236:239], v[80:83], v[44:47]
    ds_read_b128 v[68:71], v84 offset:16384
    ds_read_b128 v[72:75], v85 offset:16384
    ds_read_b128 v[76:79], v86 offset:16384
    ds_read_b128 v[80:83], v87 offset:16384
    s_waitcnt lgkmcnt(4)
    v_mfma_f32_16x16x32_bf16 v[4:7], v[240:243], v[52:55], v[4:7]
    v_mfma_f32_16x16x32_bf16 v[16:19], v[240:243], v[56:59], v[16:19]
    v_mfma_f32_16x16x32_bf16 v[28:31], v[240:243], v[60:63], v[28:31]
    v_mfma_f32_16x16x32_bf16 v[40:43], v[240:243], v[64:67], v[40:43]
    v_mfma_f32_16x16x32_bf16 v[8:11], v[244:247], v[52:55], v[8:11]
    v_mfma_f32_16x16x32_bf16 v[20:23], v[244:247], v[56:59], v[20:23]
    v_mfma_f32_16x16x32_bf16 v[32:35], v[244:247], v[60:63], v[32:35]
    v_mfma_f32_16x16x32_bf16 v[44:47], v[244:247], v[64:67], v[44:47]
    s_waitcnt lgkmcnt(0)
    v_mfma_f32_16x16x32_bf16 v[4:7], v[248:251], v[68:71], v[4:7]
    v_mfma_f32_16x16x32_bf16 v[16:19], v[248:251], v[72:75], v[16:19]
    v_mfma_f32_16x16x32_bf16 v[28:31], v[248:251], v[76:79], v[28:31]
    v_mfma_f32_16x16x32_bf16 v[40:43], v[248:251], v[80:83], v[40:43]
    v_mfma_f32_16x16x32_bf16 v[8:11], v[252:255], v[68:71], v[8:11]
    v_mfma_f32_16x16x32_bf16 v[20:23], v[252:255], v[72:75], v[20:23]
    v_mfma_f32_16x16x32_bf16 v[32:35], v[252:255], v[76:79], v[32:35]
    v_mfma_f32_16x16x32_bf16 v[44:47], v[252:255], v[80:83], v[44:47]
    s_nop 7
    s_and_b32 s57, s3, 3
    s_add_u32 s58, s57, 1
    s_and_b32 s58, s58, 3
    s_mul_i32 s58, s58, 6144
    s_add_u32 s58, s58, 135168
    v_add_u32 v53, s58, v2
    s_add_u32 s58, s57, 2
    s_and_b32 s58, s58, 3
    s_mul_i32 s58, s58, 6144
    s_add_u32 s58, s58, 137216
    v_add_u32 v54, s58, v2
    s_add_u32 s58, s57, 3
    s_and_b32 s58, s58, 3
    s_mul_i32 s58, s58, 6144
    s_add_u32 s58, s58, 139264
    v_add_u32 v55, s58, v2
    s_mul_i32 s58, s57, 6144
    s_add_u32 s58, s58, 135168
    v_add_u32 v52, s58, v2
    ds_write_b128 v53, v[16:19] offset:0
    ds_write_b128 v53, v[20:23] offset:1024
    ds_write_b128 v54, v[28:31] offset:0
    ds_write_b128 v54, v[32:35] offset:1024
    ds_write_b128 v55, v[40:43] offset:0
    ds_write_b128 v55, v[44:47] offset:1024
    s_waitcnt lgkmcnt(0)
    s_barrier
    ds_read_b128 v[16:19], v52 offset:0
    ds_read_b128 v[20:23], v52 offset:1024
    ds_read_b128 v[28:31], v52 offset:2048
    ds_read_b128 v[32:35], v52 offset:3072
    ds_read_b128 v[40:43], v52 offset:4096
    ds_read_b128 v[44:47], v52 offset:5120
    s_waitcnt lgkmcnt(0)
    v_add_f32 v4, v4, v16
    v_add_f32 v28, v28, v40
    v_add_f32 v5, v5, v17
    v_add_f32 v29, v29, v41
    v_add_f32 v6, v6, v18
    v_add_f32 v30, v30, v42
    v_add_f32 v7, v7, v19
    v_add_f32 v31, v31, v43
    v_add_f32 v4, v4, v28
    v_add_f32 v5, v5, v29
    v_add_f32 v6, v6, v30
    v_add_f32 v7, v7, v31
    v_add_f32 v8, v8, v20
    v_add_f32 v32, v32, v44
    v_add_f32 v9, v9, v21
    v_add_f32 v33, v33, v45
    v_add_f32 v10, v10, v22
    v_add_f32 v34, v34, v46
    v_add_f32 v11, v11, v23
    v_add_f32 v35, v35, v47
    v_add_f32 v8, v8, v32
    v_add_f32 v9, v9, v33
    v_add_f32 v10, v10, v34
    v_add_f32 v11, v11, v35
    s_mov_b32 s36, s20
    s_mov_b32 s37, s21
    s_mov_b32 s38, 0x280000
    s_mov_b32 s39, 0x20000
    v_cvt_pk_bf16_f32 v4, v4, v5
    v_cvt_pk_bf16_f32 v5, v6, v7
    buffer_store_dwordx2 v[4:5], v3, s[36:39], 0 offen offset:0
    v_cvt_pk_bf16_f32 v8, v8, v9
    v_cvt_pk_bf16_f32 v9, v10, v11
    buffer_store_dwordx2 v[8:9], v3, s[36:39], 0 offen offset:32
L_g2p5_j:
    s_waitcnt vmcnt(0)
    s_or_b32 s56, s2, s3
    s_cmp_lg_u32 s56, 0
    s_cbranch_scc1 L_noepoch
    v_mov_b32 v2, 0
    v_mov_b32 v3, s26
    s_mov_b64 exec, 1
    buffer_store_dword v3, v2, s[40:43], 0 offen sc1
    s_mov_b64 exec, -1
L_noepoch:
    s_waitcnt vmcnt(0)
L_end:
    s_endpgm

.section .rodata,"a"
.p2align 6
.amdhsa_kernel sequential_preLN__mha_block__dense_activation_squared_relu__prompt_kernel
  .amdhsa_next_free_vgpr 256
  .amdhsa_next_free_sgpr 102
  .amdhsa_accum_offset 256
  .amdhsa_group_segment_fixed_size 0
  .amdhsa_kernarg_size 88
  .amdhsa_user_sgpr_count 2
  .amdhsa_user_sgpr_kernarg_segment_ptr 1
  .amdhsa_system_sgpr_workgroup_id_x 1
.end_amdhsa_kernel
```
